```python
import torch

def _softmax(x, axis=-1):
    return torch.softmax(x, dim=axis)
def _gelu(x):
    return torch.nn.functional.gelu(x, approximate="tanh")
def _silu(x):
    return torch.nn.functional.silu(x)
def _sigmoid(x):
    return torch.sigmoid(x)
def _layernorm(x, axis=-1, eps=1e-5):
    m = x.mean(dim=axis, keepdim=True)
    v = x.var(dim=axis, keepdim=True, unbiased=False)
    return (x - m) / torch.sqrt(v + eps)
def _scatter_add(tgt, idx, src, axis=0):
    return tgt.clone().index_add_(axis, idx, src)
def _segment_sum(src, seg, n):
    out = torch.zeros((n,) + src.shape[1:], dtype=src.dtype)
    return out.index_add_(0, seg, src)
def _pad(x, pw):
    flat = tuple(v for pair in reversed(pw) for v in pair)
    return torch.nn.functional.pad(x, flat)

kernel_name = 'interleave_layers__linear_kernel_hedgehog__geglu_ffn__prompt'

def setup_inputs():

    _w = (lambda a: (lambda t: t.to(torch.bfloat16) if t.is_floating_point() else t)(torch.as_tensor(a)))
    def _A_setup():
        B, S, D, H = 1, 2048, 512, 32
        Dh = D // H
        return {
            "x": _w((lambda *s: torch.randn(*s, dtype=torch.bfloat16) * 0.05)(B, S, D)),
            "wqkv": _w((lambda *s: torch.randn(*s, dtype=torch.bfloat16) * 0.2)(D, 3 * D)),
            "w_phi": _w((lambda *s: torch.randn(*s, dtype=torch.bfloat16) * 0.2)(H, Dh, Dh) * (Dh ** -0.5)),
            "wo": _w((lambda *s: torch.randn(*s, dtype=torch.bfloat16) * 0.05)(D, D)),
        }
    _A_in = _A_setup()

    def _B_setup():
        B, S, D, F = 1, 2048, 512, 1376
        return {
            "x": _w((lambda *s: torch.randn(*s, dtype=torch.bfloat16) * 0.05)(B, S, D)),
            "w_gate": _w((lambda *s: torch.randn(*s, dtype=torch.bfloat16) * 0.05)(D, F)),
            "w_up": _w((lambda *s: torch.randn(*s, dtype=torch.bfloat16) * 0.05)(D, F)),
            "w_down": _w((lambda *s: torch.randn(*s, dtype=torch.bfloat16) * 0.05)(F, D)),
        }
    _B_in = _B_setup()

    return {
        "A_x": _A_in["x"],
        "A_wqkv": _A_in["wqkv"],
        "A_w_phi": _A_in["w_phi"],
        "A_wo": _A_in["wo"],
        "B_x": _B_in["x"],
        "B_w_gate": _B_in["w_gate"],
        "B_w_up": _B_in["w_up"],
        "B_w_down": _B_in["w_down"],
    }

def reference(A_x, A_wqkv, A_w_phi, A_wo, B_x, B_w_gate, B_w_up, B_w_down):
    def _A_ref(x, wqkv, w_phi, wo):
        B, S, D = x.shape
        H = 32; Dh = D // H
        qkv = (lambda x, *d: x.permute(*d))((x @ wqkv).reshape(B, S, 3, H, Dh), 2, 0, 3, 1, 4)
        q, k, v = qkv[0], qkv[1], qkv[2]
        pq = torch.einsum("bhsd,hdf->bhsf", q, w_phi)
        pk = torch.einsum("bhsd,hdf->bhsf", k, w_phi)
        phi_q = torch.concatenate([_softmax(pq, axis=-1), _softmax(-pq, axis=-1)], axis=-1)
        phi_k = torch.concatenate([_softmax(pk, axis=-1), _softmax(-pk, axis=-1)], axis=-1)
        kv = torch.einsum("bhsf,bhsd->bhfd", phi_k, v)
        z  = torch.einsum("bhsf->bhf", phi_k)
        num = torch.einsum("bhqf,bhfd->bhqd", phi_q, kv)
        den = torch.einsum("bhqf,bhf->bhq", phi_q, z)[..., None] + 1e-6
        o = num / den
        return (lambda x, *d: x.permute(*d))(o, 0, 2, 1, 3).reshape(B, S, D) @ wo

    def _B_ref(x, w_gate, w_up, w_down):
        return (_gelu(x @ w_gate) * (x @ w_up)) @ w_down

    x = A_x
    x = x + _A_ref(_layernorm(x, axis=-1), A_wqkv, A_w_phi, A_wo)
    x = x + _B_ref(_layernorm(x, axis=-1), B_w_gate, B_w_up, B_w_down)
    x = x + _A_ref(_layernorm(x, axis=-1), A_wqkv, A_w_phi, A_wo)
    x = x + _B_ref(_layernorm(x, axis=-1), B_w_gate, B_w_up, B_w_down)
    return x
```

```asm
; @launch grid=(256,1,1) block=(512,1,1) lds=163840
.amdgcn_target "amdgcn-amd-amdhsa--gfx950"
.text
.globl interleave_layers__linear_kernel_hedgehog__geglu_ffn__prompt_kernel
.p2align 8
.type interleave_layers__linear_kernel_hedgehog__geglu_ffn__prompt_kernel,@function
interleave_layers__linear_kernel_hedgehog__geglu_ffn__prompt_kernel:
    s_cmp_ge_u32 s2, 256
    s_cbranch_scc1 .Lend
    s_load_dwordx16 s[44:59], s[0:1], 0
    s_load_dwordx4 s[60:63], s[0:1], 64
    s_load_dwordx2 s[64:65], s[0:1], 80
    v_lshrrev_b32 v13, 6, v0
    v_and_b32 v0, 63, v0
    v_readfirstlane_b32 s3, v13
    v_lshlrev_b32 v1, 4, v0
    v_and_b32 v3, 15, v0
    v_lshlrev_b32 v3, 2, v3
    s_and_b32 s92, s2, 7
    s_lshr_b32 s93, s2, 3
    s_lshr_b32 s66, s93, 4
    s_lshl_b32 s92, s92, 1
    s_add_u32 s66, s66, s92
    s_and_b32 s67, s93, 15
    s_lshr_b32 s68, s67, 3
    s_and_b32 s69, s67, 7
    s_and_b32 s70, s3, 3
    s_mov_b32 s72, 262144
    s_mov_b32 s73, 0
    s_cmp_lt_u32 s67, 6
    s_cselect_b32 s99, 1, 0
    s_getreg_b32 s40, hwreg(HW_REG_XCC_ID, 0, 4)
    s_mov_b32 s7, 131072
    s_mov_b32 s11, 131072
    s_mov_b32 s15, 131072
    s_mov_b32 s19, 131072
    s_mov_b32 s23, 131072
    s_mov_b32 s27, 131072
    s_mov_b32 s31, 131072
    s_mov_b32 s35, 131072
    s_mov_b32 s39, 131072
    s_branch .Lal0
    .p2align 9
.Lal0:
    s_nop 0
    s_mov_b32 s10, 2097152
    s_mov_b32 s18, 1572864
    s_mov_b32 s6, 268435456
    s_mov_b32 s22, 16384
    s_mov_b32 s26, 524288
    s_mov_b32 s30, 1409024
    s_mov_b32 s34, 1409024
    s_mov_b32 s38, 1409024
    s_mov_b32 s14, 2097152
    s_cmp_ge_u32 s3, 4
    s_cbranch_scc1 .Lld0
    v_lshrrev_b32 v13, 3, v0
    v_and_b32 v15, 7, v0
    v_lshlrev_b32 v118, 10, v13
    v_lshl_add_u32 v118, v15, 4, v118
    s_lshl_b32 s92, s66, 2
    s_add_u32 s92, s92, s70
    s_lshl_b32 s92, s92, 15
    v_lshlrev_b32 v119, 5, v3
    s_lshl_b32 s93, s67, 11
    s_add_u32 s93, s93, s92
    v_add_u32 v48, s92, v118
    s_add_u32 s92, s92, 8192
    v_add_u32 v49, s92, v118
    s_add_u32 s92, s92, 8192
    v_add_u32 v50, s92, v118
    s_add_u32 s92, s92, 8192
    v_add_u32 v51, s92, v118
    s_mov_b32 s41, 0
    s_add_u32 s83, s41, 0
    s_and_b32 s83, s83, 7
    s_lshl_b32 s83, s83, 7
    s_waitcnt lgkmcnt(0)
    s_mov_b32 s8, s44
    s_and_b32 s9, s45, 65535
    buffer_load_dword v126, v119, s[8:11], s93 offen
    buffer_load_dwordx4 v[128:131], v48, s[8:11], s83 offen
    buffer_load_dwordx4 v[132:135], v49, s[8:11], s83 offen
    buffer_load_dwordx4 v[136:139], v50, s[8:11], s83 offen
    buffer_load_dwordx4 v[140:143], v51, s[8:11], s83 offen
    s_add_u32 s83, s41, 1
    s_and_b32 s83, s83, 7
    s_lshl_b32 s83, s83, 7
    buffer_load_dwordx4 v[144:147], v48, s[8:11], s83 offen
    buffer_load_dwordx4 v[148:151], v49, s[8:11], s83 offen
    buffer_load_dwordx4 v[152:155], v50, s[8:11], s83 offen
    buffer_load_dwordx4 v[156:159], v51, s[8:11], s83 offen
    s_mov_b32 s4, s64
    s_and_b32 s5, s65, 65535
    s_mov_b32 s12, s60
    s_and_b32 s13, s61, 65535
    buffer_load_dword v12, off, s[4:7], 0 offset:0 sc1
    s_and_b32 s45, s70, 1
    s_lshr_b32 s46, s70, 1
    v_and_b32 v117, 31, v0
    v_lshlrev_b32 v117, 10, v117
    v_lshrrev_b32 v13, 5, v0
    v_lshl_add_u32 v117, v13, 4, v117
    s_lshl_b32 s98, s66, 17
    s_lshl_b32 s93, s68, 16
    s_add_u32 s98, s98, s93
    s_lshl_b32 s93, s46, 15
    s_add_u32 s98, s98, s93
    s_lshl_b32 s93, s69, 7
    s_add_u32 s98, s98, s93
    s_lshl_b32 s93, s45, 6
    s_add_u32 s98, s98, s93
    s_lshl_b32 s92, s66, 2
    s_add_u32 s93, s92, s70
    s_lshl_b32 s74, s93, 15
    s_add_u32 s74, s74, 1048576
    s_lshr_b32 s91, s66, 1
    s_lshl_b32 s91, s91, 12
    s_xor_b32 s91, s91, s74
    s_lshl_b32 s75, s93, 12
    s_add_u32 s75, s75, 3145728
    s_lshl_b32 s76, s93, 10
    s_add_u32 s76, s76, 65536
    s_lshl_b32 s94, s67, 2
    s_add_u32 s82, s76, s94
    s_mul_i32 s85, s93, 88064
    s_add_u32 s85, s85, 3407872
    s_lshl_b32 s94, s67, 11
    s_add_u32 s80, s85, s94
    s_lshl_b32 s94, s67, 10
    s_add_u32 s85, s85, s94
    s_lshl_b32 s93, s68, 1
    s_add_u32 s93, s93, s92
    s_add_u32 s93, s93, s46
    s_lshl_b32 s95, s69, 1
    s_add_u32 s95, s95, s45
    s_lshl_b32 s77, s93, 15
    s_lshl_b32 s94, s95, 11
    s_add_u32 s77, s77, s94
    s_add_u32 s77, s77, 1048576
    s_nop 0
    s_lshl_b32 s78, s93, 12
    s_lshl_b32 s94, s69, 9
    s_add_u32 s78, s78, s94
    s_lshl_b32 s94, s45, 3
    s_add_u32 s78, s78, s94
    s_add_u32 s78, s78, 3145728
    s_lshl_b32 s81, s93, 10
    s_add_u32 s81, s81, 65536
    s_lshl_b32 s94, s95, 2
    s_add_u32 s79, s81, s94
    s_lshl_b32 s94, s45, 10
    s_mul_i32 s84, s93, 88064
    s_add_u32 s84, s84, s94
    s_add_u32 s84, s84, 3407872
    s_lshl_b32 s93, s67, 2
    s_add_u32 s93, s93, s70
    s_mul_i32 s89, s93, 12288
    s_add_u32 s89, s89, 9043968
    s_mul_i32 s88, s66, 768
    s_add_u32 s88, s88, s89
    v_mov_b32 v96, 0
    v_mov_b32 v97, 0
    v_mov_b32 v98, 0
    v_mov_b32 v99, 0
    v_and_b32 v13, 3, v0
    v_mul_u32_u24 v13, 576, v13
    v_add_u32 v13, 160288, v13
    ds_write_b128 v13, v[96:99]
    v_and_b32 v13, 112, v1
    v_add_u32 v13, 163200, v13
    ds_write_b128 v13, v[96:99]
    v_bfe_u32 v13, v0, 4, 1
    v_and_b32 v14, 1, v0
    v_cmp_eq_u32 vcc, v13, v14
    v_mov_b32 v15, 1065369472
    s_nop 0
    v_cndmask_b32 v92, 0, v15, vcc
    v_cndmask_b32 v93, 0, v15, vcc
    v_cndmask_b32 v94, 0, v15, vcc
    v_cndmask_b32 v95, 0, v15, vcc
    s_lshl_b32 s92, s70, 12
    s_add_u32 s92, s92, 131072
    v_and_b32 v13, 48, v0
    v_xor_b32 v13, v13, v1
    v_add_u32 v120, s92, v13
    v_xor_b32 v119, 64, v120
    v_and_b32 v13, 31, v0
    v_lshrrev_b32 v14, 5, v0
    v_bfe_u32 v15, v0, 1, 3
    v_xor_b32 v14, v14, v15
    v_lshlrev_b32 v13, 7, v13
    v_lshl_add_u32 v13, v14, 4, v13
    v_add_u32 v88, s92, v13
    v_xor_b32 v89, 32, v88
    v_xor_b32 v90, 64, v88
    v_xor_b32 v91, 96, v88
    v_bfe_u32 v122, v0, 2, 2
    v_lshlrev_b32 v122, 7, v122
    v_lshrrev_b32 v13, 5, v0
    v_lshl_add_u32 v122, v13, 10, v122
    v_and_b32 v13, 1, v0
    v_lshl_add_u32 v122, v13, 5, v122
    v_bfe_u32 v13, v0, 1, 1
    v_lshl_add_u32 v122, v13, 3, v122
    v_bfe_u32 v13, v0, 4, 1
    v_lshl_add_u32 v122, v13, 4, v122
    v_bfe_u32 v13, v0, 3, 1
    v_lshl_add_u32 v122, v13, 6, v122
    s_mov_b32 s44, 0
    s_mov_b32 s96, 0x3fb8aa3b
    s_mov_b32 s97, 1065369472
    s_mov_b32 s60, 0
    s_mov_b32 s61, -1
    s_lshl_b32 s47, s76, 1
    s_add_u32 s47, s47, 65536
    v_add_u32 v2, s44, v122
    v_xor_b32 v121, 64, v2
    s_add_u32 s83, s41, 2
    s_and_b32 s83, s83, 7
    s_lshl_b32 s83, s83, 7
    buffer_load_dwordx4 v[160:163], v48, s[8:11], s83 offen
    buffer_load_dwordx4 v[164:167], v49, s[8:11], s83 offen
    buffer_load_dwordx4 v[168:171], v50, s[8:11], s83 offen
    buffer_load_dwordx4 v[172:175], v51, s[8:11], s83 offen
    s_add_u32 s83, s41, 3
    s_and_b32 s83, s83, 7
    s_lshl_b32 s83, s83, 7
    buffer_load_dwordx4 v[176:179], v48, s[8:11], s83 offen
    buffer_load_dwordx4 v[180:183], v49, s[8:11], s83 offen
    s_nop 0
    buffer_load_dwordx4 v[184:187], v50, s[8:11], s83 offen
    buffer_load_dwordx4 v[188:191], v51, s[8:11], s83 offen
    s_waitcnt vmcnt(16)
    ds_write_b128 v120, v[128:131] offset:0
    s_waitcnt vmcnt(15)
    ds_write_b128 v119, v[132:135] offset:1024
    s_waitcnt vmcnt(14)
    ds_write_b128 v120, v[136:139] offset:2048
    s_waitcnt vmcnt(13)
    ds_write_b128 v119, v[140:143] offset:3072
    ds_read_b128 v[128:131], v88
    ds_read_b128 v[132:135], v89
    ds_read_b128 v[136:139], v90
    ds_read_b128 v[140:143], v91
    s_add_u32 s83, s41, 4
    s_and_b32 s83, s83, 7
    s_lshl_b32 s83, s83, 7
    buffer_load_dwordx4 v[192:195], v48, s[8:11], s83 offen
    buffer_load_dwordx4 v[196:199], v49, s[8:11], s83 offen
    buffer_load_dwordx4 v[200:203], v50, s[8:11], s83 offen
    buffer_load_dwordx4 v[204:207], v51, s[8:11], s83 offen
    s_waitcnt vmcnt(16)
    ds_write_b128 v120, v[144:147] offset:0
    s_waitcnt vmcnt(15)
    ds_write_b128 v119, v[148:151] offset:1024
    s_waitcnt vmcnt(14)
    ds_write_b128 v120, v[152:155] offset:2048
    s_waitcnt vmcnt(13)
    ds_write_b128 v119, v[156:159] offset:3072
    ds_read_b128 v[144:147], v88
    ds_read_b128 v[148:151], v89
    ds_read_b128 v[152:155], v90
    ds_read_b128 v[156:159], v91
    s_waitcnt lgkmcnt(11)
    v_mfma_f32_32x32x16_bf16 v[96:111], v[128:131], v[128:131], 0
    v_mfma_f32_16x16x32_bf16 v[112:115], v[92:95], v[128:131], 0
    s_waitcnt lgkmcnt(10)
    v_mfma_f32_32x32x16_bf16 v[96:111], v[132:135], v[132:135], v[96:111]
    v_mfma_f32_16x16x32_bf16 v[112:115], v[92:95], v[132:135], v[112:115]
    s_waitcnt lgkmcnt(9)
    v_mfma_f32_32x32x16_bf16 v[96:111], v[136:139], v[136:139], v[96:111]
    v_mfma_f32_16x16x32_bf16 v[112:115], v[92:95], v[136:139], v[112:115]
    s_waitcnt lgkmcnt(8)
    v_mfma_f32_32x32x16_bf16 v[96:111], v[140:143], v[140:143], v[96:111]
    v_mfma_f32_16x16x32_bf16 v[112:115], v[92:95], v[140:143], v[112:115]
    s_add_u32 s83, s41, 5
    s_and_b32 s83, s83, 7
    s_lshl_b32 s83, s83, 7
    buffer_load_dwordx4 v[208:211], v48, s[8:11], s83 offen
    buffer_load_dwordx4 v[212:215], v49, s[8:11], s83 offen
    buffer_load_dwordx4 v[216:219], v50, s[8:11], s83 offen
    buffer_load_dwordx4 v[220:223], v51, s[8:11], s83 offen
    s_waitcnt vmcnt(15)
    ds_write_b128 v120, v[160:163] offset:0
    s_waitcnt vmcnt(14)
    ds_write_b128 v119, v[164:167] offset:1024
    s_waitcnt vmcnt(13)
    ds_write_b128 v120, v[168:171] offset:2048
    s_waitcnt vmcnt(12)
    ds_write_b128 v119, v[172:175] offset:3072
    ds_read_b128 v[160:163], v88
    ds_read_b128 v[164:167], v89
    ds_read_b128 v[168:171], v90
    ds_read_b128 v[172:175], v91
    s_waitcnt lgkmcnt(11)
    v_mfma_f32_32x32x16_bf16 v[96:111], v[144:147], v[144:147], v[96:111]
    v_mfma_f32_16x16x32_bf16 v[112:115], v[92:95], v[144:147], v[112:115]
    s_waitcnt lgkmcnt(10)
    v_mfma_f32_32x32x16_bf16 v[96:111], v[148:151], v[148:151], v[96:111]
    v_mfma_f32_16x16x32_bf16 v[112:115], v[92:95], v[148:151], v[112:115]
    s_waitcnt lgkmcnt(9)
    v_mfma_f32_32x32x16_bf16 v[96:111], v[152:155], v[152:155], v[96:111]
    v_mfma_f32_16x16x32_bf16 v[112:115], v[92:95], v[152:155], v[112:115]
    s_waitcnt lgkmcnt(8)
    v_mfma_f32_32x32x16_bf16 v[96:111], v[156:159], v[156:159], v[96:111]
    v_mfma_f32_16x16x32_bf16 v[112:115], v[92:95], v[156:159], v[112:115]
    s_add_u32 s83, s41, 6
    s_nop 0
    s_and_b32 s83, s83, 7
    s_lshl_b32 s83, s83, 7
    buffer_load_dwordx4 v[224:227], v48, s[8:11], s83 offen
    buffer_load_dwordx4 v[228:231], v49, s[8:11], s83 offen
    buffer_load_dwordx4 v[232:235], v50, s[8:11], s83 offen
    buffer_load_dwordx4 v[236:239], v51, s[8:11], s83 offen
    s_waitcnt vmcnt(15)
    ds_write_b128 v120, v[176:179] offset:0
    s_waitcnt vmcnt(14)
    ds_write_b128 v119, v[180:183] offset:1024
    s_waitcnt vmcnt(13)
    ds_write_b128 v120, v[184:187] offset:2048
    s_waitcnt vmcnt(12)
    ds_write_b128 v119, v[188:191] offset:3072
    ds_read_b128 v[176:179], v88
    ds_read_b128 v[180:183], v89
    ds_read_b128 v[184:187], v90
    ds_read_b128 v[188:191], v91
    s_waitcnt lgkmcnt(11)
    v_mfma_f32_32x32x16_bf16 v[96:111], v[160:163], v[160:163], v[96:111]
    v_mfma_f32_16x16x32_bf16 v[112:115], v[92:95], v[160:163], v[112:115]
    s_waitcnt lgkmcnt(10)
    v_mfma_f32_32x32x16_bf16 v[96:111], v[164:167], v[164:167], v[96:111]
    v_mfma_f32_16x16x32_bf16 v[112:115], v[92:95], v[164:167], v[112:115]
    s_waitcnt lgkmcnt(9)
    v_mfma_f32_32x32x16_bf16 v[96:111], v[168:171], v[168:171], v[96:111]
    v_mfma_f32_16x16x32_bf16 v[112:115], v[92:95], v[168:171], v[112:115]
    s_waitcnt lgkmcnt(8)
    v_mfma_f32_32x32x16_bf16 v[96:111], v[172:175], v[172:175], v[96:111]
    v_mfma_f32_16x16x32_bf16 v[112:115], v[92:95], v[172:175], v[112:115]
    s_add_u32 s83, s41, 7
    s_and_b32 s83, s83, 7
    s_lshl_b32 s83, s83, 7
    buffer_load_dwordx4 v[240:243], v48, s[8:11], s83 offen
    buffer_load_dwordx4 v[244:247], v49, s[8:11], s83 offen
    buffer_load_dwordx4 v[248:251], v50, s[8:11], s83 offen
    buffer_load_dwordx4 v[252:255], v51, s[8:11], s83 offen
    s_waitcnt vmcnt(15)
    ds_write_b128 v120, v[192:195] offset:0
    s_waitcnt vmcnt(14)
    ds_write_b128 v119, v[196:199] offset:1024
    s_waitcnt vmcnt(13)
    ds_write_b128 v120, v[200:203] offset:2048
    s_waitcnt vmcnt(12)
    ds_write_b128 v119, v[204:207] offset:3072
    ds_read_b128 v[192:195], v88
    ds_read_b128 v[196:199], v89
    ds_read_b128 v[200:203], v90
    ds_read_b128 v[204:207], v91
    s_waitcnt lgkmcnt(11)
    v_mfma_f32_32x32x16_bf16 v[96:111], v[176:179], v[176:179], v[96:111]
    v_mfma_f32_16x16x32_bf16 v[112:115], v[92:95], v[176:179], v[112:115]
    s_waitcnt lgkmcnt(10)
    v_mfma_f32_32x32x16_bf16 v[96:111], v[180:183], v[180:183], v[96:111]
    v_mfma_f32_16x16x32_bf16 v[112:115], v[92:95], v[180:183], v[112:115]
    s_waitcnt lgkmcnt(9)
    v_mfma_f32_32x32x16_bf16 v[96:111], v[184:187], v[184:187], v[96:111]
    v_mfma_f32_16x16x32_bf16 v[112:115], v[92:95], v[184:187], v[112:115]
    s_waitcnt lgkmcnt(8)
    v_mfma_f32_32x32x16_bf16 v[96:111], v[188:191], v[188:191], v[96:111]
    v_mfma_f32_16x16x32_bf16 v[112:115], v[92:95], v[188:191], v[112:115]
    s_waitcnt vmcnt(11)
    ds_write_b128 v120, v[208:211] offset:0
    s_waitcnt vmcnt(10)
    ds_write_b128 v119, v[212:215] offset:1024
    s_waitcnt vmcnt(9)
    ds_write_b128 v120, v[216:219] offset:2048
    s_waitcnt vmcnt(8)
    ds_write_b128 v119, v[220:223] offset:3072
    ds_read_b128 v[208:211], v88
    ds_read_b128 v[212:215], v89
    ds_read_b128 v[216:219], v90
    ds_read_b128 v[220:223], v91
    s_waitcnt lgkmcnt(11)
    v_mfma_f32_32x32x16_bf16 v[96:111], v[192:195], v[192:195], v[96:111]
    v_mfma_f32_16x16x32_bf16 v[112:115], v[92:95], v[192:195], v[112:115]
    s_waitcnt lgkmcnt(10)
    s_nop 0
    v_mfma_f32_32x32x16_bf16 v[96:111], v[196:199], v[196:199], v[96:111]
    v_mfma_f32_16x16x32_bf16 v[112:115], v[92:95], v[196:199], v[112:115]
    s_waitcnt lgkmcnt(9)
    v_mfma_f32_32x32x16_bf16 v[96:111], v[200:203], v[200:203], v[96:111]
    v_mfma_f32_16x16x32_bf16 v[112:115], v[92:95], v[200:203], v[112:115]
    s_waitcnt lgkmcnt(8)
    v_mfma_f32_32x32x16_bf16 v[96:111], v[204:207], v[204:207], v[96:111]
    v_mfma_f32_16x16x32_bf16 v[112:115], v[92:95], v[204:207], v[112:115]
    s_waitcnt vmcnt(7)
    ds_write_b128 v120, v[224:227] offset:0
    s_waitcnt vmcnt(6)
    ds_write_b128 v119, v[228:231] offset:1024
    s_waitcnt vmcnt(5)
    ds_write_b128 v120, v[232:235] offset:2048
    s_waitcnt vmcnt(4)
    ds_write_b128 v119, v[236:239] offset:3072
    ds_read_b128 v[224:227], v88
    ds_read_b128 v[228:231], v89
    ds_read_b128 v[232:235], v90
    ds_read_b128 v[236:239], v91
    s_waitcnt lgkmcnt(11)
    v_mfma_f32_32x32x16_bf16 v[96:111], v[208:211], v[208:211], v[96:111]
    v_mfma_f32_16x16x32_bf16 v[112:115], v[92:95], v[208:211], v[112:115]
    s_waitcnt lgkmcnt(10)
    v_mfma_f32_32x32x16_bf16 v[96:111], v[212:215], v[212:215], v[96:111]
    v_mfma_f32_16x16x32_bf16 v[112:115], v[92:95], v[212:215], v[112:115]
    s_waitcnt lgkmcnt(9)
    v_mfma_f32_32x32x16_bf16 v[96:111], v[216:219], v[216:219], v[96:111]
    v_mfma_f32_16x16x32_bf16 v[112:115], v[92:95], v[216:219], v[112:115]
    s_waitcnt lgkmcnt(8)
    v_mfma_f32_32x32x16_bf16 v[96:111], v[220:223], v[220:223], v[96:111]
    v_mfma_f32_16x16x32_bf16 v[112:115], v[92:95], v[220:223], v[112:115]
    s_waitcnt vmcnt(3)
    ds_write_b128 v120, v[240:243] offset:0
    s_waitcnt vmcnt(2)
    ds_write_b128 v119, v[244:247] offset:1024
    s_waitcnt vmcnt(1)
    ds_write_b128 v120, v[248:251] offset:2048
    s_waitcnt vmcnt(0)
    ds_write_b128 v119, v[252:255] offset:3072
    ds_read_b128 v[240:243], v88
    ds_read_b128 v[244:247], v89
    ds_read_b128 v[248:251], v90
    ds_read_b128 v[252:255], v91
    s_waitcnt lgkmcnt(11)
    v_mfma_f32_32x32x16_bf16 v[96:111], v[224:227], v[224:227], v[96:111]
    v_mfma_f32_16x16x32_bf16 v[112:115], v[92:95], v[224:227], v[112:115]
    s_waitcnt lgkmcnt(10)
    v_mfma_f32_32x32x16_bf16 v[96:111], v[228:231], v[228:231], v[96:111]
    v_mfma_f32_16x16x32_bf16 v[112:115], v[92:95], v[228:231], v[112:115]
    s_waitcnt lgkmcnt(9)
    v_mfma_f32_32x32x16_bf16 v[96:111], v[232:235], v[232:235], v[96:111]
    v_mfma_f32_16x16x32_bf16 v[112:115], v[92:95], v[232:235], v[112:115]
    s_waitcnt lgkmcnt(8)
    v_mfma_f32_32x32x16_bf16 v[96:111], v[236:239], v[236:239], v[96:111]
    v_mfma_f32_16x16x32_bf16 v[112:115], v[92:95], v[236:239], v[112:115]
    s_waitcnt lgkmcnt(3)
    v_mfma_f32_32x32x16_bf16 v[96:111], v[240:243], v[240:243], v[96:111]
    v_mfma_f32_16x16x32_bf16 v[112:115], v[92:95], v[240:243], v[112:115]
    s_waitcnt lgkmcnt(2)
    v_mfma_f32_32x32x16_bf16 v[96:111], v[244:247], v[244:247], v[96:111]
    v_mfma_f32_16x16x32_bf16 v[112:115], v[92:95], v[244:247], v[112:115]
    s_waitcnt lgkmcnt(1)
    v_mfma_f32_32x32x16_bf16 v[96:111], v[248:251], v[248:251], v[96:111]
    v_mfma_f32_16x16x32_bf16 v[112:115], v[92:95], v[248:251], v[112:115]
    s_waitcnt lgkmcnt(0)
    v_mfma_f32_32x32x16_bf16 v[96:111], v[252:255], v[252:255], v[96:111]
    v_mfma_f32_16x16x32_bf16 v[112:115], v[92:95], v[252:255], v[112:115]
    s_waitcnt lgkmcnt(0)
    s_barrier
    ds_read_b64_tr_b16 v[64:65], v2 offset:0
    ds_read_b64_tr_b16 v[66:67], v2 offset:512
    ds_read_b64_tr_b16 v[68:69], v121 offset:0
    ds_read_b64_tr_b16 v[70:71], v121 offset:512
    ds_read_b64_tr_b16 v[72:73], v2 offset:2048
    ds_read_b64_tr_b16 v[74:75], v2 offset:2560
    s_nop 0
    ds_read_b64_tr_b16 v[76:77], v121 offset:2048
    ds_read_b64_tr_b16 v[78:79], v121 offset:2560
    ds_read_b64_tr_b16 v[80:81], v2 offset:4096
    ds_read_b64_tr_b16 v[82:83], v2 offset:4608
    s_waitcnt lgkmcnt(8)
    v_mfma_f32_32x32x16_bf16 v[16:31], v[64:67], v[128:131], 0
    ds_read_b64_tr_b16 v[84:85], v121 offset:4096
    ds_read_b64_tr_b16 v[86:87], v121 offset:4608
    s_waitcnt lgkmcnt(8)
    v_mfma_f32_32x32x16_bf16 v[32:47], v[68:71], v[128:131], 0
    ds_read_b64_tr_b16 v[64:65], v2 offset:6144
    ds_read_b64_tr_b16 v[66:67], v2 offset:6656
    s_waitcnt lgkmcnt(8)
    v_mfma_f32_32x32x16_bf16 v[16:31], v[72:75], v[132:135], v[16:31]
    ds_read_b64_tr_b16 v[68:69], v121 offset:6144
    ds_read_b64_tr_b16 v[70:71], v121 offset:6656
    v_and_b32 v13, 16, v0
    v_cmp_ne_u32 s[50:51], 0, v13
    s_waitcnt lgkmcnt(8)
    v_mfma_f32_32x32x16_bf16 v[32:47], v[76:79], v[132:135], v[32:47]
    ds_read_b64_tr_b16 v[72:73], v2 offset:8192
    ds_read_b64_tr_b16 v[74:75], v2 offset:8704
    v_and_b32 v13, 8, v0
    v_cmp_ne_u32 s[52:53], 0, v13
    s_waitcnt lgkmcnt(8)
    v_mfma_f32_32x32x16_bf16 v[16:31], v[80:83], v[136:139], v[16:31]
    ds_read_b64_tr_b16 v[76:77], v121 offset:8192
    ds_read_b64_tr_b16 v[78:79], v121 offset:8704
    v_and_b32 v13, 2, v0
    v_cmp_ne_u32 s[54:55], 0, v13
    s_waitcnt lgkmcnt(8)
    v_mfma_f32_32x32x16_bf16 v[32:47], v[84:87], v[136:139], v[32:47]
    ds_read_b64_tr_b16 v[80:81], v2 offset:10240
    ds_read_b64_tr_b16 v[82:83], v2 offset:10752
    v_and_b32 v13, 1, v0
    v_cmp_ne_u32 s[56:57], 0, v13
    s_waitcnt lgkmcnt(8)
    v_mfma_f32_32x32x16_bf16 v[16:31], v[64:67], v[140:143], v[16:31]
    ds_read_b64_tr_b16 v[84:85], v121 offset:10240
    ds_read_b64_tr_b16 v[86:87], v121 offset:10752
    v_bfe_u32 v13, v0, 2, 1
    v_lshrrev_b32 v14, 5, v0
    s_waitcnt lgkmcnt(8)
    v_mfma_f32_32x32x16_bf16 v[32:47], v[68:71], v[140:143], v[32:47]
    ds_read_b64_tr_b16 v[64:65], v2 offset:12288
    ds_read_b64_tr_b16 v[66:67], v2 offset:12800
    v_cmp_eq_u32 s[58:59], v13, v14
    v_cndmask_b32 v112, v112, v113, s[50:51]
    s_waitcnt lgkmcnt(8)
    v_mfma_f32_32x32x16_bf16 v[16:31], v[72:75], v[144:147], v[16:31]
    ds_read_b64_tr_b16 v[68:69], v121 offset:12288
    ds_read_b64_tr_b16 v[70:71], v121 offset:12800
    v_cndmask_b32 v96, v96, v104, s[50:51]
    v_cndmask_b32 v97, v97, v105, s[50:51]
    s_waitcnt lgkmcnt(8)
    v_mfma_f32_32x32x16_bf16 v[32:47], v[76:79], v[144:147], v[32:47]
    ds_read_b64_tr_b16 v[72:73], v2 offset:14336
    ds_read_b64_tr_b16 v[74:75], v2 offset:14848
    v_cndmask_b32 v98, v98, v106, s[50:51]
    v_cndmask_b32 v99, v99, v107, s[50:51]
    s_waitcnt lgkmcnt(8)
    v_mfma_f32_32x32x16_bf16 v[16:31], v[80:83], v[148:151], v[16:31]
    ds_read_b64_tr_b16 v[76:77], v121 offset:14336
    ds_read_b64_tr_b16 v[78:79], v121 offset:14848
    v_cndmask_b32 v100, v100, v108, s[50:51]
    v_cndmask_b32 v101, v101, v109, s[50:51]
    s_waitcnt lgkmcnt(8)
    v_mfma_f32_32x32x16_bf16 v[32:47], v[84:87], v[148:151], v[32:47]
    ds_read_b64_tr_b16 v[80:81], v2 offset:16384
    ds_read_b64_tr_b16 v[82:83], v2 offset:16896
    v_cndmask_b32 v102, v102, v110, s[50:51]
    v_cndmask_b32 v103, v103, v111, s[50:51]
    s_nop 0
    s_waitcnt lgkmcnt(8)
    v_mfma_f32_32x32x16_bf16 v[16:31], v[64:67], v[152:155], v[16:31]
    ds_read_b64_tr_b16 v[84:85], v121 offset:16384
    ds_read_b64_tr_b16 v[86:87], v121 offset:16896
    v_cndmask_b32 v96, v96, v100, s[52:53]
    v_cndmask_b32 v97, v97, v101, s[52:53]
    s_waitcnt lgkmcnt(8)
    v_mfma_f32_32x32x16_bf16 v[32:47], v[68:71], v[152:155], v[32:47]
    ds_read_b64_tr_b16 v[64:65], v2 offset:18432
    ds_read_b64_tr_b16 v[66:67], v2 offset:18944
    v_cndmask_b32 v98, v98, v102, s[52:53]
    v_cndmask_b32 v99, v99, v103, s[52:53]
    s_waitcnt lgkmcnt(8)
    v_mfma_f32_32x32x16_bf16 v[16:31], v[72:75], v[156:159], v[16:31]
    ds_read_b64_tr_b16 v[68:69], v121 offset:18432
    ds_read_b64_tr_b16 v[70:71], v121 offset:18944
    v_cndmask_b32 v96, v96, v98, s[54:55]
    v_cndmask_b32 v97, v97, v99, s[54:55]
    s_waitcnt lgkmcnt(8)
    v_mfma_f32_32x32x16_bf16 v[32:47], v[76:79], v[156:159], v[32:47]
    ds_read_b64_tr_b16 v[72:73], v2 offset:20480
    ds_read_b64_tr_b16 v[74:75], v2 offset:20992
    v_cndmask_b32 v96, v96, v97, s[56:57]
    v_cndmask_b32 v96, 0, v96, s[58:59]
    s_waitcnt lgkmcnt(8)
    v_mfma_f32_32x32x16_bf16 v[16:31], v[80:83], v[160:163], v[16:31]
    ds_read_b64_tr_b16 v[76:77], v121 offset:20480
    ds_read_b64_tr_b16 v[78:79], v121 offset:20992
    v_mov_b32 v97, v96
    s_nop 1
    v_permlane32_swap_b32 v96, v97
    s_waitcnt lgkmcnt(8)
    v_mfma_f32_32x32x16_bf16 v[32:47], v[84:87], v[160:163], v[32:47]
    ds_read_b64_tr_b16 v[80:81], v2 offset:22528
    ds_read_b64_tr_b16 v[82:83], v2 offset:23040
    v_add_f32 v96, v96, v97
    v_mul_f32 v112, 0xbb000000, v112
    s_waitcnt lgkmcnt(8)
    v_mfma_f32_32x32x16_bf16 v[16:31], v[64:67], v[164:167], v[16:31]
    ds_read_b64_tr_b16 v[84:85], v121 offset:22528
    ds_read_b64_tr_b16 v[86:87], v121 offset:23040
    v_mul_f32 v96, 0x3b000000, v96
    v_fma_f32 v114, -v112, v112, v96
    s_waitcnt lgkmcnt(8)
    v_mfma_f32_32x32x16_bf16 v[32:47], v[68:71], v[164:167], v[32:47]
    ds_read_b64_tr_b16 v[64:65], v2 offset:24576
    ds_read_b64_tr_b16 v[66:67], v2 offset:25088
    v_max_f32 v114, 0, v114
    v_add_f32 v114, 0x3727c5ac, v114
    s_waitcnt lgkmcnt(8)
    v_mfma_f32_32x32x16_bf16 v[16:31], v[72:75], v[168:171], v[16:31]
    s_barrier
    ds_read_b64_tr_b16 v[68:69], v121 offset:24576
    ds_read_b64_tr_b16 v[70:71], v121 offset:25088
    v_rsq_f32 v113, v114
    s_waitcnt lgkmcnt(8)
    v_mfma_f32_32x32x16_bf16 v[32:47], v[76:79], v[168:171], v[32:47]
    ds_read_b64_tr_b16 v[72:73], v2 offset:26624
    ds_read_b64_tr_b16 v[74:75], v2 offset:27136
    v_mul_f32 v115, s96, v113
    s_waitcnt lgkmcnt(8)
    v_mfma_f32_32x32x16_bf16 v[16:31], v[80:83], v[172:175], v[16:31]
    ds_read_b64_tr_b16 v[76:77], v121 offset:26624
    ds_read_b64_tr_b16 v[78:79], v121 offset:27136
    s_waitcnt lgkmcnt(8)
    v_mfma_f32_32x32x16_bf16 v[32:47], v[84:87], v[172:175], v[32:47]
    ds_read_b64_tr_b16 v[80:81], v2 offset:28672
    ds_read_b64_tr_b16 v[82:83], v2 offset:29184
    buffer_load_dwordx4 v[4:7], v117, s[8:11], s98 offen
    buffer_load_dwordx4 v[8:11], v117, s[8:11], s98 offen offset:32
    s_waitcnt lgkmcnt(8)
    v_mfma_f32_32x32x16_bf16 v[16:31], v[64:67], v[176:179], v[16:31]
    ds_read_b64_tr_b16 v[84:85], v121 offset:28672
    ds_read_b64_tr_b16 v[86:87], v121 offset:29184
    s_nop 0
    s_waitcnt lgkmcnt(8)
    v_mfma_f32_32x32x16_bf16 v[32:47], v[68:71], v[176:179], v[32:47]
    ds_read_b64_tr_b16 v[64:65], v2 offset:30720
    ds_read_b64_tr_b16 v[66:67], v2 offset:31232
    v_lshrrev_b32 v14, 5, v0
    v_and_b32 v13, 1, v0
    s_waitcnt lgkmcnt(8)
    v_mfma_f32_32x32x16_bf16 v[16:31], v[72:75], v[180:183], v[16:31]
    ds_read_b64_tr_b16 v[68:69], v121 offset:30720
    ds_read_b64_tr_b16 v[70:71], v121 offset:31232
    v_cmp_eq_u32 vcc, v13, v14
    v_lshlrev_b32 v116, 6, v14
    s_waitcnt lgkmcnt(8)
    v_mfma_f32_32x32x16_bf16 v[32:47], v[76:79], v[180:183], v[32:47]
    s_add_u32 s44, s44, 32768
    s_and_b32 s44, s44, 131071
    v_add_u32 v2, s44, v122
    v_xor_b32 v121, 64, v2
    ds_read_b64_tr_b16 v[72:73], v2 offset:0
    ds_read_b64_tr_b16 v[74:75], v2 offset:512
    v_add_u32 v116, 162048, v116
    v_lshlrev_b32 v119, 7, v14
    s_waitcnt lgkmcnt(8)
    v_mfma_f32_32x32x16_bf16 v[16:31], v[80:83], v[184:187], v[16:31]
    ds_read_b64_tr_b16 v[76:77], v121 offset:0
    ds_read_b64_tr_b16 v[78:79], v121 offset:512
    v_and_b32 v13, 12, v0
    v_lshl_add_u32 v119, v13, 3, v119
    s_waitcnt lgkmcnt(8)
    v_mfma_f32_32x32x16_bf16 v[32:47], v[84:87], v[184:187], v[32:47]
    ds_read_b64_tr_b16 v[80:81], v2 offset:2048
    ds_read_b64_tr_b16 v[82:83], v2 offset:2560
    v_and_b32 v13, 16, v0
    v_add_u32 v119, v119, v13
    s_waitcnt lgkmcnt(8)
    v_mfma_f32_32x32x16_bf16 v[16:31], v[64:67], v[188:191], v[16:31]
    ds_read_b64_tr_b16 v[84:85], v121 offset:2048
    ds_read_b64_tr_b16 v[86:87], v121 offset:2560
    v_and_b32 v13, 2, v0
    v_lshl_add_u32 v119, v13, 2, v119
    s_waitcnt lgkmcnt(8)
    v_mfma_f32_32x32x16_bf16 v[32:47], v[68:71], v[188:191], v[32:47]
    ds_read_b64_tr_b16 v[64:65], v2 offset:4096
    ds_read_b64_tr_b16 v[66:67], v2 offset:4608
    v_mov_b32 v13, 544
    v_cndmask_b32 v119, v13, v119, vcc
    s_waitcnt lgkmcnt(8)
    v_mfma_f32_32x32x16_bf16 v[16:31], v[72:75], v[192:195], v[16:31]
    ds_read_b64_tr_b16 v[68:69], v121 offset:4096
    ds_read_b64_tr_b16 v[70:71], v121 offset:4608
    v_add_u32 v119, 159744, v119
    v_and_b32 v13, 31, v0
    s_waitcnt lgkmcnt(8)
    v_mfma_f32_32x32x16_bf16 v[32:47], v[76:79], v[192:195], v[32:47]
    ds_read_b64_tr_b16 v[72:73], v2 offset:6144
    ds_read_b64_tr_b16 v[74:75], v2 offset:6656
    s_lshl_b32 s92, s70, 5
    v_add_u32 v13, s92, v13
    s_waitcnt lgkmcnt(8)
    v_mfma_f32_32x32x16_bf16 v[16:31], v[80:83], v[196:199], v[16:31]
    ds_read_b64_tr_b16 v[76:77], v121 offset:6144
    ds_read_b64_tr_b16 v[78:79], v121 offset:6656
    v_mul_u32_u24 v117, 144, v13
    v_lshl_add_u32 v117, v14, 6, v117
    s_waitcnt lgkmcnt(8)
    v_mfma_f32_32x32x16_bf16 v[32:47], v[84:87], v[196:199], v[32:47]
    ds_read_b64_tr_b16 v[80:81], v2 offset:8192
    ds_read_b64_tr_b16 v[82:83], v2 offset:8704
    v_add_u32 v117, 131072, v117
    v_mul_u32_u24 v118, 80, v13
    s_waitcnt lgkmcnt(8)
    v_mfma_f32_32x32x16_bf16 v[16:31], v[64:67], v[200:203], v[16:31]
    ds_read_b64_tr_b16 v[84:85], v121 offset:8192
    ds_read_b64_tr_b16 v[86:87], v121 offset:8704
    v_lshl_add_u32 v118, v14, 5, v118
    v_add_u32 v118, 149504, v118
    s_waitcnt lgkmcnt(8)
    s_nop 0
    v_mfma_f32_32x32x16_bf16 v[32:47], v[68:71], v[200:203], v[32:47]
    ds_read_b64_tr_b16 v[64:65], v2 offset:10240
    ds_read_b64_tr_b16 v[66:67], v2 offset:10752
    v_bfe_u32 v123, v0, 2, 2
    v_lshlrev_b32 v123, 7, v123
    s_waitcnt lgkmcnt(8)
    v_mfma_f32_32x32x16_bf16 v[16:31], v[72:75], v[204:207], v[16:31]
    ds_read_b64_tr_b16 v[68:69], v121 offset:10240
    ds_read_b64_tr_b16 v[70:71], v121 offset:10752
    v_lshrrev_b32 v13, 5, v0
    v_lshl_add_u32 v123, v13, 10, v123
    s_waitcnt lgkmcnt(8)
    v_mfma_f32_32x32x16_bf16 v[32:47], v[76:79], v[204:207], v[32:47]
    ds_read_b64_tr_b16 v[72:73], v2 offset:12288
    ds_read_b64_tr_b16 v[74:75], v2 offset:12800
    v_and_b32 v13, 1, v0
    v_lshl_add_u32 v123, v13, 4, v123
    s_waitcnt lgkmcnt(8)
    v_mfma_f32_32x32x16_bf16 v[16:31], v[80:83], v[208:211], v[16:31]
    ds_read_b64_tr_b16 v[76:77], v121 offset:12288
    ds_read_b64_tr_b16 v[78:79], v121 offset:12800
    v_bfe_u32 v13, v0, 1, 1
    v_lshl_add_u32 v123, v13, 3, v123
    s_waitcnt lgkmcnt(8)
    v_mfma_f32_32x32x16_bf16 v[32:47], v[84:87], v[208:211], v[32:47]
    ds_read_b64_tr_b16 v[80:81], v2 offset:14336
    ds_read_b64_tr_b16 v[82:83], v2 offset:14848
    v_bfe_u32 v13, v0, 4, 1
    v_lshl_add_u32 v123, v13, 5, v123
    s_waitcnt lgkmcnt(8)
    v_mfma_f32_32x32x16_bf16 v[16:31], v[64:67], v[212:215], v[16:31]
    ds_read_b64_tr_b16 v[84:85], v121 offset:14336
    ds_read_b64_tr_b16 v[86:87], v121 offset:14848
    v_bfe_u32 v13, v0, 3, 1
    v_lshl_add_u32 v123, v13, 6, v123
    s_waitcnt lgkmcnt(8)
    v_mfma_f32_32x32x16_bf16 v[32:47], v[68:71], v[212:215], v[32:47]
    ds_read_b64_tr_b16 v[64:65], v2 offset:16384
    ds_read_b64_tr_b16 v[66:67], v2 offset:16896
    s_lshl_b32 s94, s45, 6
    v_xor_b32 v123, s94, v123
    s_waitcnt lgkmcnt(8)
    v_mfma_f32_32x32x16_bf16 v[16:31], v[72:75], v[216:219], v[16:31]
    ds_read_b64_tr_b16 v[68:69], v121 offset:16384
    ds_read_b64_tr_b16 v[70:71], v121 offset:16896
    s_lshl_b32 s94, s45, 11
    v_add_u32 v123, s94, v123
    s_waitcnt lgkmcnt(8)
    v_mfma_f32_32x32x16_bf16 v[32:47], v[76:79], v[216:219], v[32:47]
    ds_read_b64_tr_b16 v[72:73], v2 offset:18432
    ds_read_b64_tr_b16 v[74:75], v2 offset:18944
    s_waitcnt lgkmcnt(8)
    v_mfma_f32_32x32x16_bf16 v[16:31], v[80:83], v[220:223], v[16:31]
    ds_read_b64_tr_b16 v[76:77], v121 offset:18432
    ds_read_b64_tr_b16 v[78:79], v121 offset:18944
    s_waitcnt lgkmcnt(8)
    v_mfma_f32_32x32x16_bf16 v[32:47], v[84:87], v[220:223], v[32:47]
    ds_read_b64_tr_b16 v[80:81], v2 offset:20480
    ds_read_b64_tr_b16 v[82:83], v2 offset:20992
    s_waitcnt lgkmcnt(8)
    v_mfma_f32_32x32x16_bf16 v[16:31], v[64:67], v[224:227], v[16:31]
    ds_read_b64_tr_b16 v[84:85], v121 offset:20480
    ds_read_b64_tr_b16 v[86:87], v121 offset:20992
    s_waitcnt lgkmcnt(8)
    v_mfma_f32_32x32x16_bf16 v[32:47], v[68:71], v[224:227], v[32:47]
    ds_read_b64_tr_b16 v[64:65], v2 offset:22528
    ds_read_b64_tr_b16 v[66:67], v2 offset:23040
    s_waitcnt lgkmcnt(8)
    v_mfma_f32_32x32x16_bf16 v[16:31], v[72:75], v[228:231], v[16:31]
    ds_read_b64_tr_b16 v[68:69], v121 offset:22528
    ds_read_b64_tr_b16 v[70:71], v121 offset:23040
    s_waitcnt lgkmcnt(8)
    v_mfma_f32_32x32x16_bf16 v[32:47], v[76:79], v[228:231], v[32:47]
    ds_read_b64_tr_b16 v[72:73], v2 offset:24576
    s_nop 0
    ds_read_b64_tr_b16 v[74:75], v2 offset:25088
    s_waitcnt lgkmcnt(8)
    v_mfma_f32_32x32x16_bf16 v[16:31], v[80:83], v[232:235], v[16:31]
    ds_read_b64_tr_b16 v[76:77], v121 offset:24576
    ds_read_b64_tr_b16 v[78:79], v121 offset:25088
    s_waitcnt lgkmcnt(8)
    v_mfma_f32_32x32x16_bf16 v[32:47], v[84:87], v[232:235], v[32:47]
    ds_read_b64_tr_b16 v[80:81], v2 offset:26624
    ds_read_b64_tr_b16 v[82:83], v2 offset:27136
    s_waitcnt lgkmcnt(8)
    v_mfma_f32_32x32x16_bf16 v[16:31], v[64:67], v[236:239], v[16:31]
    ds_read_b64_tr_b16 v[84:85], v121 offset:26624
    ds_read_b64_tr_b16 v[86:87], v121 offset:27136
    s_waitcnt lgkmcnt(8)
    v_mfma_f32_32x32x16_bf16 v[32:47], v[68:71], v[236:239], v[32:47]
    ds_read_b64_tr_b16 v[64:65], v2 offset:28672
    ds_read_b64_tr_b16 v[66:67], v2 offset:29184
    s_waitcnt lgkmcnt(8)
    v_mfma_f32_32x32x16_bf16 v[16:31], v[72:75], v[240:243], v[16:31]
    ds_read_b64_tr_b16 v[68:69], v121 offset:28672
    ds_read_b64_tr_b16 v[70:71], v121 offset:29184
    s_waitcnt lgkmcnt(8)
    v_mfma_f32_32x32x16_bf16 v[32:47], v[76:79], v[240:243], v[32:47]
    ds_read_b64_tr_b16 v[72:73], v2 offset:30720
    ds_read_b64_tr_b16 v[74:75], v2 offset:31232
    s_waitcnt lgkmcnt(8)
    v_mfma_f32_32x32x16_bf16 v[16:31], v[80:83], v[244:247], v[16:31]
    ds_read_b64_tr_b16 v[76:77], v121 offset:30720
    ds_read_b64_tr_b16 v[78:79], v121 offset:31232
    s_waitcnt lgkmcnt(8)
    v_mfma_f32_32x32x16_bf16 v[32:47], v[84:87], v[244:247], v[32:47]
    s_waitcnt lgkmcnt(6)
    v_mfma_f32_32x32x16_bf16 v[16:31], v[64:67], v[248:251], v[16:31]
    s_waitcnt lgkmcnt(4)
    v_mfma_f32_32x32x16_bf16 v[32:47], v[68:71], v[248:251], v[32:47]
    s_waitcnt lgkmcnt(2)
    v_mfma_f32_32x32x16_bf16 v[16:31], v[72:75], v[252:255], v[16:31]
    s_waitcnt lgkmcnt(0)
    v_mfma_f32_32x32x16_bf16 v[32:47], v[76:79], v[252:255], v[32:47]
    v_add_u32 v12, 1, v12
    v_mov_b32 v125, 1
    v_and_b32 v124, 12, v3
    v_add_u32 v124, 163232, v124
.Lsig_1:
    ds_read_b32 v126, v124
    s_waitcnt lgkmcnt(0)
    v_cmp_gt_u32 vcc, v125, v126
    s_cbranch_vccz .Lsigd_2
    s_sub_u32 s72, s72, 1
    s_cbranch_scc0 .Lsig_1
    s_mov_b32 s72, 0
.Lsigd_2:
    ds_read_b128 v[48:51], v116 offset:0
    ds_read_b128 v[52:55], v116 offset:16
    ds_read_b128 v[56:59], v116 offset:32
    ds_read_b128 v[60:63], v116 offset:48
    ds_read_b64_tr_b16 v[88:89], v119 offset:0
    ds_read_b64_tr_b16 v[90:91], v119 offset:576
    ds_read_b64_tr_b16 v[92:93], v119 offset:1152
    ds_read_b64_tr_b16 v[94:95], v119 offset:1728
    ds_read_b128 v[96:99], v116 offset:128
    ds_read_b128 v[100:103], v116 offset:144
    ds_read_b128 v[104:107], v116 offset:160
    ds_read_b128 v[108:111], v116 offset:176
    v_readfirstlane_b32 s71, v12
    s_lshl_b32 s95, s3, 2
    s_add_u32 s95, s95, 163232
    v_mov_b32 v13, s95
    v_mov_b32 v14, 2
    ds_write_b32 v13, v14
    s_add_u32 s49, s85, 81920
    s_add_u32 s83, s47, 1024
    s_cmp_eq_u32 s99, 1
    s_cselect_b32 s49, s49, s47
    s_cselect_b32 s83, s82, s83
    s_branch .Lk_f
.Lpair_f:
.Lpoll_3:
    buffer_load_dword v13, v3, s[4:7], s76 offen offset:0 sc1
    s_waitcnt vmcnt(0)
    v_cmp_ne_u32 vcc, s71, v13
    s_cbranch_vccz .Lpdone_4
    s_sub_u32 s72, s72, 1
    s_cbranch_scc0 .Lpoll_3
    s_mov_b32 s72, 0
.Lpdone_4:
.Lhp_10:
    s_cbranch_execz .Lhp_11
    s_add_u32 s48, s74, 0
    buffer_load_dwordx4 v[128:131], v1, s[4:7], s48 offen offset:0 sc1
    buffer_load_dwordx4 v[132:135], v1, s[4:7], s48 offen offset:1024 sc1
    buffer_load_dwordx4 v[136:139], v1, s[4:7], s48 offen offset:2048 sc1
    buffer_load_dwordx4 v[140:143], v1, s[4:7], s48 offen offset:3072 sc1
    s_add_u32 s48, s74, 4096
    buffer_load_dwordx4 v[144:147], v1, s[4:7], s48 offen offset:0 sc1
    buffer_load_dwordx4 v[148:151], v1, s[4:7], s48 offen offset:1024 sc1
    buffer_load_dwordx4 v[152:155], v1, s[4:7], s48 offen offset:2048 sc1
    buffer_load_dwordx4 v[156:159], v1, s[4:7], s48 offen offset:3072 sc1
    s_add_u32 s48, s74, 8192
    buffer_load_dwordx4 v[160:163], v1, s[4:7], s48 offen offset:0 sc1
    buffer_load_dwordx4 v[164:167], v1, s[4:7], s48 offen offset:1024 sc1
    s_add_u32 s71, s71, 1
    v_add_u32 v12, 1, v12
    s_barrier
    ds_read_b64_tr_b16 v[64:65], v2 offset:0
    ds_read_b64_tr_b16 v[66:67], v2 offset:512
    ds_read_b64_tr_b16 v[68:69], v121 offset:0
    ds_read_b64_tr_b16 v[70:71], v121 offset:512
    ds_read_b64_tr_b16 v[72:73], v2 offset:2048
    ds_read_b64_tr_b16 v[74:75], v2 offset:2560
    ds_read_b64_tr_b16 v[76:77], v121 offset:2048
    ds_read_b64_tr_b16 v[78:79], v121 offset:2560
    ds_read_b64_tr_b16 v[80:81], v2 offset:4096
    ds_read_b64_tr_b16 v[82:83], v2 offset:4608
    s_waitcnt vmcnt(9) lgkmcnt(8)
    v_mfma_f32_32x32x16_bf16 v[16:31], v[64:67], v[128:131], 0
    ds_read_b64_tr_b16 v[84:85], v121 offset:4096
    ds_read_b64_tr_b16 v[86:87], v121 offset:4608
    s_waitcnt lgkmcnt(8)
    v_mfma_f32_32x32x16_bf16 v[32:47], v[68:71], v[128:131], 0
    ds_read_b64_tr_b16 v[64:65], v2 offset:6144
    ds_read_b64_tr_b16 v[66:67], v2 offset:6656
    buffer_load_dwordx4 v[168:171], v1, s[4:7], s48 offen offset:2048 sc1
    s_waitcnt vmcnt(9) lgkmcnt(8)
    v_mfma_f32_32x32x16_bf16 v[16:31], v[72:75], v[132:135], v[16:31]
    ds_read_b64_tr_b16 v[68:69], v121 offset:6144
    ds_read_b64_tr_b16 v[70:71], v121 offset:6656
    v_lshrrev_b32 v14, 5, v0
    v_and_b32 v13, 1, v0
    s_waitcnt lgkmcnt(8)
    v_mfma_f32_32x32x16_bf16 v[32:47], v[76:79], v[132:135], v[32:47]
    ds_read_b64_tr_b16 v[72:73], v2 offset:8192
    ds_read_b64_tr_b16 v[74:75], v2 offset:8704
    buffer_load_dwordx4 v[172:175], v1, s[4:7], s48 offen offset:3072 sc1
    v_cmp_eq_u32 vcc, v13, v14
    v_lshlrev_b32 v116, 6, v14
    s_waitcnt vmcnt(9) lgkmcnt(8)
    v_mfma_f32_32x32x16_bf16 v[16:31], v[80:83], v[136:139], v[16:31]
    ds_read_b64_tr_b16 v[76:77], v121 offset:8192
    ds_read_b64_tr_b16 v[78:79], v121 offset:8704
    v_add_u32 v116, 162048, v116
    v_lshlrev_b32 v119, 7, v14
    s_waitcnt lgkmcnt(8)
    v_mfma_f32_32x32x16_bf16 v[32:47], v[84:87], v[136:139], v[32:47]
    ds_read_b64_tr_b16 v[80:81], v2 offset:10240
    ds_read_b64_tr_b16 v[82:83], v2 offset:10752
    s_add_u32 s48, s74, 12288
    buffer_load_dwordx4 v[176:179], v1, s[4:7], s48 offen offset:0 sc1
    v_and_b32 v13, 12, v0
    v_lshl_add_u32 v119, v13, 3, v119
    s_waitcnt vmcnt(9) lgkmcnt(8)
    v_mfma_f32_32x32x16_bf16 v[16:31], v[64:67], v[140:143], v[16:31]
    ds_read_b64_tr_b16 v[84:85], v121 offset:10240
    ds_read_b64_tr_b16 v[86:87], v121 offset:10752
    v_and_b32 v13, 16, v0
    v_add_u32 v119, v119, v13
    s_waitcnt lgkmcnt(8)
    v_mfma_f32_32x32x16_bf16 v[32:47], v[68:71], v[140:143], v[32:47]
    ds_read_b64_tr_b16 v[64:65], v2 offset:12288
    ds_read_b64_tr_b16 v[66:67], v2 offset:12800
    buffer_load_dwordx4 v[180:183], v1, s[4:7], s48 offen offset:1024 sc1
    v_and_b32 v13, 2, v0
.Lhsc_2_4:
.Lhp_11:
    s_cbranch_execz .Lhp_12
    v_lshl_add_u32 v119, v13, 2, v119
    s_waitcnt vmcnt(9) lgkmcnt(8)
    v_mfma_f32_32x32x16_bf16 v[16:31], v[72:75], v[144:147], v[16:31]
    ds_read_b64_tr_b16 v[68:69], v121 offset:12288
    ds_read_b64_tr_b16 v[70:71], v121 offset:12800
    v_mov_b32 v13, 544
    v_cndmask_b32 v119, v13, v119, vcc
    s_waitcnt lgkmcnt(8)
    v_mfma_f32_32x32x16_bf16 v[32:47], v[76:79], v[144:147], v[32:47]
    ds_read_b64_tr_b16 v[72:73], v2 offset:14336
    ds_read_b64_tr_b16 v[74:75], v2 offset:14848
    buffer_load_dwordx4 v[184:187], v1, s[4:7], s48 offen offset:2048 sc1
    v_add_u32 v119, 159744, v119
    v_and_b32 v13, 31, v0
    s_waitcnt vmcnt(9) lgkmcnt(8)
    v_mfma_f32_32x32x16_bf16 v[16:31], v[80:83], v[148:151], v[16:31]
    ds_read_b64_tr_b16 v[76:77], v121 offset:14336
    ds_read_b64_tr_b16 v[78:79], v121 offset:14848
    s_lshl_b32 s92, s70, 5
    v_add_u32 v13, s92, v13
    s_waitcnt lgkmcnt(8)
    v_mfma_f32_32x32x16_bf16 v[32:47], v[84:87], v[148:151], v[32:47]
    ds_read_b64_tr_b16 v[80:81], v2 offset:16384
    ds_read_b64_tr_b16 v[82:83], v2 offset:16896
    buffer_load_dwordx4 v[188:191], v1, s[4:7], s48 offen offset:3072 sc1
    v_mul_u32_u24 v117, 144, v13
    v_lshl_add_u32 v117, v14, 6, v117
    s_waitcnt vmcnt(9) lgkmcnt(8)
    v_mfma_f32_32x32x16_bf16 v[16:31], v[64:67], v[152:155], v[16:31]
    ds_read_b64_tr_b16 v[84:85], v121 offset:16384
    ds_read_b64_tr_b16 v[86:87], v121 offset:16896
    v_add_u32 v117, 131072, v117
    v_mul_u32_u24 v118, 80, v13
    s_waitcnt lgkmcnt(8)
    v_mfma_f32_32x32x16_bf16 v[32:47], v[68:71], v[152:155], v[32:47]
    ds_read_b64_tr_b16 v[64:65], v2 offset:18432
    ds_read_b64_tr_b16 v[66:67], v2 offset:18944
    s_add_u32 s48, s74, 16384
    buffer_load_dwordx4 v[192:195], v1, s[4:7], s48 offen offset:0 sc1
    v_lshl_add_u32 v118, v14, 5, v118
    v_add_u32 v118, 149504, v118
    s_waitcnt vmcnt(9) lgkmcnt(8)
    v_mfma_f32_32x32x16_bf16 v[16:31], v[72:75], v[156:159], v[16:31]
    ds_read_b64_tr_b16 v[68:69], v121 offset:18432
    ds_read_b64_tr_b16 v[70:71], v121 offset:18944
    ds_read_b128 v[48:51], v116 offset:0
    ds_read_b128 v[52:55], v116 offset:16
    s_waitcnt lgkmcnt(10)
    v_mfma_f32_32x32x16_bf16 v[32:47], v[76:79], v[156:159], v[32:47]
    ds_read_b64_tr_b16 v[72:73], v2 offset:20480
    ds_read_b64_tr_b16 v[74:75], v2 offset:20992
    buffer_load_dwordx4 v[196:199], v1, s[4:7], s48 offen offset:1024 sc1
    ds_read_b128 v[56:59], v116 offset:32
    ds_read_b128 v[60:63], v116 offset:48
    s_waitcnt vmcnt(9) lgkmcnt(12)
    v_mfma_f32_32x32x16_bf16 v[16:31], v[80:83], v[160:163], v[16:31]
    ds_read_b64_tr_b16 v[76:77], v121 offset:20480
    ds_read_b64_tr_b16 v[78:79], v121 offset:20992
    ds_read_b64_tr_b16 v[88:89], v119 offset:0
    ds_read_b64_tr_b16 v[90:91], v119 offset:576
    s_waitcnt lgkmcnt(14)
    v_mfma_f32_32x32x16_bf16 v[32:47], v[84:87], v[160:163], v[32:47]
    ds_read_b64_tr_b16 v[80:81], v2 offset:22528
    ds_read_b64_tr_b16 v[82:83], v2 offset:23040
    buffer_load_dwordx4 v[200:203], v1, s[4:7], s48 offen offset:2048 sc1
    ds_read_b64_tr_b16 v[92:93], v119 offset:1152
    ds_read_b64_tr_b16 v[94:95], v119 offset:1728
    s_waitcnt vmcnt(9) lgkmcnt(15)
    v_mfma_f32_32x32x16_bf16 v[16:31], v[64:67], v[164:167], v[16:31]
    ds_read_b64_tr_b16 v[84:85], v121 offset:22528
    ds_read_b64_tr_b16 v[86:87], v121 offset:23040
.Lhsc_2_5:
.Lhp_12:
    s_cbranch_execz .Lhp_13
    s_waitcnt lgkmcnt(15)
    v_mfma_f32_32x32x16_bf16 v[32:47], v[68:71], v[164:167], v[32:47]
    ds_read_b64_tr_b16 v[64:65], v2 offset:24576
    ds_read_b64_tr_b16 v[66:67], v2 offset:25088
    buffer_load_dwordx4 v[204:207], v1, s[4:7], s48 offen offset:3072 sc1
    s_waitcnt vmcnt(9) lgkmcnt(14)
    v_mfma_f32_32x32x16_bf16 v[16:31], v[72:75], v[168:171], v[16:31]
    s_barrier
    ds_read_b64_tr_b16 v[68:69], v121 offset:24576
    ds_read_b64_tr_b16 v[70:71], v121 offset:25088
    s_waitcnt lgkmcnt(12)
    v_mfma_f32_32x32x16_bf16 v[32:47], v[76:79], v[168:171], v[32:47]
    ds_read_b64_tr_b16 v[72:73], v2 offset:26624
    ds_read_b64_tr_b16 v[74:75], v2 offset:27136
    s_add_u32 s48, s74, 20480
    buffer_load_dwordx4 v[208:211], v1, s[4:7], s48 offen offset:0 sc1
    s_waitcnt vmcnt(9) lgkmcnt(10)
    v_mfma_f32_32x32x16_bf16 v[16:31], v[80:83], v[172:175], v[16:31]
    ds_read_b64_tr_b16 v[76:77], v121 offset:26624
    ds_read_b64_tr_b16 v[78:79], v121 offset:27136
    s_waitcnt lgkmcnt(8)
    v_mfma_f32_32x32x16_bf16 v[32:47], v[84:87], v[172:175], v[32:47]
    ds_read_b64_tr_b16 v[80:81], v2 offset:28672
    ds_read_b64_tr_b16 v[82:83], v2 offset:29184
    buffer_load_dwordx4 v[212:215], v1, s[4:7], s48 offen offset:1024 sc1
    s_waitcnt vmcnt(9) lgkmcnt(8)
    v_mfma_f32_32x32x16_bf16 v[16:31], v[64:67], v[176:179], v[16:31]
    ds_read_b64_tr_b16 v[84:85], v121 offset:28672
    ds_read_b64_tr_b16 v[86:87], v121 offset:29184
    s_waitcnt lgkmcnt(8)
    v_mfma_f32_32x32x16_bf16 v[32:47], v[68:71], v[176:179], v[32:47]
    ds_read_b64_tr_b16 v[64:65], v2 offset:30720
    ds_read_b64_tr_b16 v[66:67], v2 offset:31232
    buffer_load_dwordx4 v[96:99], v15, s[4:7], s75 offen offset:0 sc1
    buffer_load_dwordx4 v[100:103], v15, s[4:7], s75 offen offset:512 sc1
    buffer_load_dwordx4 v[104:107], v15, s[4:7], s75 offen offset:1024 sc1
    buffer_load_dwordx4 v[108:111], v15, s[4:7], s75 offen offset:1536 sc1
    s_waitcnt vmcnt(12) lgkmcnt(8)
    v_mfma_f32_32x32x16_bf16 v[16:31], v[72:75], v[180:183], v[16:31]
    ds_read_b64_tr_b16 v[68:69], v121 offset:30720
    ds_read_b64_tr_b16 v[70:71], v121 offset:31232
    s_waitcnt lgkmcnt(8)
    v_mfma_f32_32x32x16_bf16 v[32:47], v[76:79], v[180:183], v[32:47]
    s_add_u32 s44, s44, 32768
    s_and_b32 s44, s44, 131071
    v_add_u32 v2, s44, v122
    v_xor_b32 v121, 64, v2
    ds_read_b64_tr_b16 v[72:73], v2 offset:0
    ds_read_b64_tr_b16 v[74:75], v2 offset:512
    buffer_load_dwordx4 v[216:219], v1, s[4:7], s48 offen offset:2048 sc1
    s_waitcnt vmcnt(12) lgkmcnt(8)
    v_mfma_f32_32x32x16_bf16 v[16:31], v[80:83], v[184:187], v[16:31]
    ds_read_b64_tr_b16 v[76:77], v121 offset:0
    ds_read_b64_tr_b16 v[78:79], v121 offset:512
    s_waitcnt lgkmcnt(8)
    v_mfma_f32_32x32x16_bf16 v[32:47], v[84:87], v[184:187], v[32:47]
    ds_read_b64_tr_b16 v[80:81], v2 offset:2048
    ds_read_b64_tr_b16 v[82:83], v2 offset:2560
    buffer_load_dwordx4 v[220:223], v1, s[4:7], s48 offen offset:3072 sc1
    s_waitcnt vmcnt(12) lgkmcnt(8)
    v_mfma_f32_32x32x16_bf16 v[16:31], v[64:67], v[188:191], v[16:31]
    ds_read_b64_tr_b16 v[84:85], v121 offset:2048
    ds_read_b64_tr_b16 v[86:87], v121 offset:2560
    s_waitcnt lgkmcnt(8)
    v_mfma_f32_32x32x16_bf16 v[32:47], v[68:71], v[188:191], v[32:47]
    ds_read_b64_tr_b16 v[64:65], v2 offset:4096
    ds_read_b64_tr_b16 v[66:67], v2 offset:4608
    s_add_u32 s48, s74, 24576
    buffer_load_dwordx4 v[224:227], v1, s[4:7], s48 offen offset:0 sc1
    s_waitcnt vmcnt(12) lgkmcnt(8)
    v_mfma_f32_32x32x16_bf16 v[16:31], v[72:75], v[192:195], v[16:31]
    ds_read_b64_tr_b16 v[68:69], v121 offset:4096
.Lhsc_2_6:
.Lhp_13:
    s_cbranch_execz .Lhp_14
    ds_read_b64_tr_b16 v[70:71], v121 offset:4608
    s_waitcnt lgkmcnt(8)
    v_mfma_f32_32x32x16_bf16 v[32:47], v[76:79], v[192:195], v[32:47]
    ds_read_b64_tr_b16 v[72:73], v2 offset:6144
    ds_read_b64_tr_b16 v[74:75], v2 offset:6656
    buffer_load_dwordx4 v[228:231], v1, s[4:7], s48 offen offset:1024 sc1
    s_waitcnt vmcnt(12) lgkmcnt(8)
    v_mfma_f32_32x32x16_bf16 v[16:31], v[80:83], v[196:199], v[16:31]
    ds_read_b64_tr_b16 v[76:77], v121 offset:6144
    ds_read_b64_tr_b16 v[78:79], v121 offset:6656
    s_waitcnt lgkmcnt(8)
    v_mfma_f32_32x32x16_bf16 v[32:47], v[84:87], v[196:199], v[32:47]
    ds_read_b64_tr_b16 v[80:81], v2 offset:8192
    ds_read_b64_tr_b16 v[82:83], v2 offset:8704
    buffer_load_dwordx4 v[232:235], v1, s[4:7], s48 offen offset:2048 sc1
    s_waitcnt vmcnt(12) lgkmcnt(8)
    v_mfma_f32_32x32x16_bf16 v[16:31], v[64:67], v[200:203], v[16:31]
    ds_read_b64_tr_b16 v[84:85], v121 offset:8192
    ds_read_b64_tr_b16 v[86:87], v121 offset:8704
    s_waitcnt lgkmcnt(8)
    v_mfma_f32_32x32x16_bf16 v[32:47], v[68:71], v[200:203], v[32:47]
    ds_read_b64_tr_b16 v[64:65], v2 offset:10240
    ds_read_b64_tr_b16 v[66:67], v2 offset:10752
    buffer_load_dwordx4 v[236:239], v1, s[4:7], s48 offen offset:3072 sc1
    s_waitcnt vmcnt(12) lgkmcnt(8)
    v_mfma_f32_32x32x16_bf16 v[16:31], v[72:75], v[204:207], v[16:31]
    ds_read_b64_tr_b16 v[68:69], v121 offset:10240
    ds_read_b64_tr_b16 v[70:71], v121 offset:10752
    s_waitcnt lgkmcnt(8)
    v_mfma_f32_32x32x16_bf16 v[32:47], v[76:79], v[204:207], v[32:47]
    ds_read_b64_tr_b16 v[72:73], v2 offset:12288
    ds_read_b64_tr_b16 v[74:75], v2 offset:12800
    s_add_u32 s48, s74, 28672
    buffer_load_dwordx4 v[240:243], v1, s[4:7], s48 offen offset:0 sc1
    s_waitcnt vmcnt(12) lgkmcnt(8)
    v_mfma_f32_32x32x16_bf16 v[16:31], v[80:83], v[208:211], v[16:31]
    ds_read_b64_tr_b16 v[76:77], v121 offset:12288
    ds_read_b64_tr_b16 v[78:79], v121 offset:12800
    s_waitcnt lgkmcnt(8)
    v_mfma_f32_32x32x16_bf16 v[32:47], v[84:87], v[208:211], v[32:47]
    ds_read_b64_tr_b16 v[80:81], v2 offset:14336
    ds_read_b64_tr_b16 v[82:83], v2 offset:14848
    buffer_load_dwordx4 v[244:247], v1, s[4:7], s48 offen offset:1024 sc1
    s_waitcnt vmcnt(12) lgkmcnt(8)
    v_mfma_f32_32x32x16_bf16 v[16:31], v[64:67], v[212:215], v[16:31]
    ds_read_b64_tr_b16 v[84:85], v121 offset:14336
    ds_read_b64_tr_b16 v[86:87], v121 offset:14848
    s_waitcnt lgkmcnt(8)
    v_mfma_f32_32x32x16_bf16 v[32:47], v[68:71], v[212:215], v[32:47]
    ds_read_b64_tr_b16 v[64:65], v2 offset:16384
    ds_read_b64_tr_b16 v[66:67], v2 offset:16896
    buffer_load_dwordx4 v[248:251], v1, s[4:7], s48 offen offset:2048 sc1
    s_waitcnt vmcnt(8) lgkmcnt(8)
    v_mfma_f32_32x32x16_bf16 v[16:31], v[72:75], v[216:219], v[16:31]
    ds_read_b64_tr_b16 v[68:69], v121 offset:16384
    ds_read_b64_tr_b16 v[70:71], v121 offset:16896
    s_waitcnt lgkmcnt(8)
    v_mfma_f32_32x32x16_bf16 v[32:47], v[76:79], v[216:219], v[32:47]
    ds_read_b64_tr_b16 v[72:73], v2 offset:18432
    ds_read_b64_tr_b16 v[74:75], v2 offset:18944
    buffer_load_dwordx4 v[252:255], v1, s[4:7], s48 offen offset:3072 sc1
    s_waitcnt vmcnt(8) lgkmcnt(8)
    v_mfma_f32_32x32x16_bf16 v[16:31], v[80:83], v[220:223], v[16:31]
    ds_read_b64_tr_b16 v[76:77], v121 offset:18432
    ds_read_b64_tr_b16 v[78:79], v121 offset:18944
    v_add_f32 v96, v96, v100
    v_add_f32 v97, v97, v101
    s_waitcnt lgkmcnt(8)
    v_mfma_f32_32x32x16_bf16 v[32:47], v[84:87], v[220:223], v[32:47]
    ds_read_b64_tr_b16 v[80:81], v2 offset:20480
    ds_read_b64_tr_b16 v[82:83], v2 offset:20992
    v_add_f32 v98, v98, v102
    v_add_f32 v99, v99, v103
.Lhsc_2_7:
.Lhp_14:
    s_cbranch_execz .Lhp_65
    s_waitcnt vmcnt(7) lgkmcnt(8)
    v_mfma_f32_32x32x16_bf16 v[16:31], v[64:67], v[224:227], v[16:31]
    ds_read_b64_tr_b16 v[84:85], v121 offset:20480
    ds_read_b64_tr_b16 v[86:87], v121 offset:20992
    v_add_f32 v104, v104, v108
    v_add_f32 v105, v105, v109
    s_waitcnt lgkmcnt(8)
    v_mfma_f32_32x32x16_bf16 v[32:47], v[68:71], v[224:227], v[32:47]
    ds_read_b64_tr_b16 v[64:65], v2 offset:22528
    ds_read_b64_tr_b16 v[66:67], v2 offset:23040
    v_add_f32 v106, v106, v110
    v_add_f32 v107, v107, v111
    s_waitcnt vmcnt(6) lgkmcnt(8)
    v_mfma_f32_32x32x16_bf16 v[16:31], v[72:75], v[228:231], v[16:31]
    ds_read_b64_tr_b16 v[68:69], v121 offset:22528
    ds_read_b64_tr_b16 v[70:71], v121 offset:23040
    v_add_f32 v96, v96, v104
    v_add_f32 v97, v97, v105
    s_waitcnt lgkmcnt(8)
    v_mfma_f32_32x32x16_bf16 v[32:47], v[76:79], v[228:231], v[32:47]
    ds_read_b64_tr_b16 v[72:73], v2 offset:24576
    ds_read_b64_tr_b16 v[74:75], v2 offset:25088
    v_add_f32 v98, v98, v106
    v_add_f32 v99, v99, v107
    s_waitcnt vmcnt(5) lgkmcnt(8)
    v_mfma_f32_32x32x16_bf16 v[16:31], v[80:83], v[232:235], v[16:31]
    ds_read_b64_tr_b16 v[76:77], v121 offset:24576
    ds_read_b64_tr_b16 v[78:79], v121 offset:25088
    v_add_f32 v96, v96, v98
    v_add_f32 v97, v97, v99
    s_waitcnt lgkmcnt(8)
    v_mfma_f32_32x32x16_bf16 v[32:47], v[84:87], v[232:235], v[32:47]
    ds_read_b64_tr_b16 v[80:81], v2 offset:26624
    ds_read_b64_tr_b16 v[82:83], v2 offset:27136
    v_mov_b32 v98, v96
    v_mov_b32 v99, v97
    s_waitcnt vmcnt(4) lgkmcnt(8)
    v_mfma_f32_32x32x16_bf16 v[16:31], v[64:67], v[236:239], v[16:31]
    ds_read_b64_tr_b16 v[84:85], v121 offset:26624
    ds_read_b64_tr_b16 v[86:87], v121 offset:27136
    v_permlane32_swap_b32 v96, v98
    v_permlane32_swap_b32 v97, v99
    s_waitcnt lgkmcnt(8)
    v_mfma_f32_32x32x16_bf16 v[32:47], v[68:71], v[236:239], v[32:47]
    ds_read_b64_tr_b16 v[64:65], v2 offset:28672
    ds_read_b64_tr_b16 v[66:67], v2 offset:29184
    v_add_f32 v96, v96, v98
    v_add_f32 v97, v97, v99
    s_waitcnt vmcnt(3) lgkmcnt(8)
    v_mfma_f32_32x32x16_bf16 v[16:31], v[72:75], v[240:243], v[16:31]
    s_barrier
    ds_read_b64_tr_b16 v[68:69], v121 offset:28672
    ds_read_b64_tr_b16 v[70:71], v121 offset:29184
    v_mul_f32 v112, 0xbb000000, v96
    v_mul_f32 v97, 0x3b000000, v97
    s_waitcnt lgkmcnt(8)
    v_mfma_f32_32x32x16_bf16 v[32:47], v[76:79], v[240:243], v[32:47]
    ds_read_b64_tr_b16 v[72:73], v2 offset:30720
    ds_read_b64_tr_b16 v[74:75], v2 offset:31232
    v_fma_f32 v114, -v112, v112, v97
    v_max_f32 v114, 0, v114
    s_waitcnt vmcnt(2) lgkmcnt(8)
    v_mfma_f32_32x32x16_bf16 v[16:31], v[80:83], v[244:247], v[16:31]
    ds_read_b64_tr_b16 v[76:77], v121 offset:30720
    ds_read_b64_tr_b16 v[78:79], v121 offset:31232
    v_add_f32 v114, 0x3727c5ac, v114
    s_waitcnt lgkmcnt(8)
    v_mfma_f32_32x32x16_bf16 v[32:47], v[84:87], v[244:247], v[32:47]
    v_rsq_f32 v113, v114
    s_waitcnt vmcnt(1) lgkmcnt(6)
    v_mfma_f32_32x32x16_bf16 v[16:31], v[64:67], v[248:251], v[16:31]
    v_mul_f32 v115, s96, v113
    ds_read_b128 v[96:99], v116 offset:128
    s_waitcnt lgkmcnt(5)
    v_mfma_f32_32x32x16_bf16 v[32:47], v[68:71], v[248:251], v[32:47]
    ds_read_b128 v[100:103], v116 offset:144
    ds_read_b128 v[104:107], v116 offset:160
    s_waitcnt vmcnt(0) lgkmcnt(5)
    v_mfma_f32_32x32x16_bf16 v[16:31], v[72:75], v[252:255], v[16:31]
    ds_read_b128 v[108:111], v116 offset:176
    s_waitcnt lgkmcnt(4)
    v_mfma_f32_32x32x16_bf16 v[32:47], v[76:79], v[252:255], v[32:47]
.Lk_f:
    s_nop 0
    s_waitcnt lgkmcnt(12)
    s_nop 7
    v_pk_fma_f32 v[16:17], v[48:49], v[112:113], v[16:17] op_sel:[0,0,0] op_sel_hi:[1,0,1]
    v_pk_fma_f32 v[18:19], v[50:51], v[112:113], v[18:19] op_sel:[0,0,0] op_sel_hi:[1,0,1]
    s_waitcnt lgkmcnt(11)
    v_pk_fma_f32 v[20:21], v[52:53], v[112:113], v[20:21] op_sel:[0,0,0] op_sel_hi:[1,0,1]
    v_pk_fma_f32 v[22:23], v[54:55], v[112:113], v[22:23] op_sel:[0,0,0] op_sel_hi:[1,0,1]
    s_waitcnt lgkmcnt(10)
    v_pk_fma_f32 v[24:25], v[56:57], v[112:113], v[24:25] op_sel:[0,0,0] op_sel_hi:[1,0,1]
    v_pk_fma_f32 v[26:27], v[58:59], v[112:113], v[26:27] op_sel:[0,0,0] op_sel_hi:[1,0,1]
    s_waitcnt lgkmcnt(9)
    v_pk_fma_f32 v[28:29], v[60:61], v[112:113], v[28:29] op_sel:[0,0,0] op_sel_hi:[1,0,1]
    v_pk_fma_f32 v[30:31], v[62:63], v[112:113], v[30:31] op_sel:[0,0,0] op_sel_hi:[1,0,1]
    v_cvt_pk_bf16_f32 v64, v16, v17
    v_cvt_pk_bf16_f32 v65, v18, v19
    v_cvt_pk_bf16_f32 v66, v20, v21
    v_cvt_pk_bf16_f32 v67, v22, v23
    v_cvt_pk_bf16_f32 v68, v24, v25
    v_cvt_pk_bf16_f32 v69, v26, v27
    v_cvt_pk_bf16_f32 v70, v28, v29
    v_cvt_pk_bf16_f32 v71, v30, v31
    s_waitcnt lgkmcnt(7)
    v_mfma_f32_32x32x16_bf16 v[16:31], v[88:91], v[64:67], 0
    s_waitcnt lgkmcnt(5)
    v_mfma_f32_32x32x16_bf16 v[16:31], v[92:95], v[68:71], v[16:31]
    s_waitcnt lgkmcnt(3)
    v_fma_f32 v32, v96, v112, v32
    v_fma_f32 v33, v97, v112, v33
    v_fma_f32 v34, v98, v112, v34
    v_fma_f32 v35, v99, v112, v35
    s_waitcnt lgkmcnt(2)
    v_fma_f32 v36, v100, v112, v36
    v_fma_f32 v37, v101, v112, v37
    v_fma_f32 v38, v102, v112, v38
    v_fma_f32 v39, v103, v112, v39
    s_waitcnt lgkmcnt(1)
    v_fma_f32 v40, v104, v112, v40
    v_fma_f32 v41, v105, v112, v41
    v_fma_f32 v42, v106, v112, v42
    v_fma_f32 v43, v107, v112, v43
    s_waitcnt lgkmcnt(0)
    v_fma_f32 v44, v108, v112, v44
    v_fma_f32 v45, v109, v112, v45
    v_fma_f32 v46, v110, v112, v46
    v_fma_f32 v47, v111, v112, v47
    v_pk_mul_f32 v[32:33], v[112:113], v[32:33] op_sel:[1,0] op_sel_hi:[1,1]
    v_pk_mul_f32 v[34:35], v[112:113], v[34:35] op_sel:[1,0] op_sel_hi:[1,1]
    v_pk_mul_f32 v[36:37], v[112:113], v[36:37] op_sel:[1,0] op_sel_hi:[1,1]
    v_pk_mul_f32 v[38:39], v[112:113], v[38:39] op_sel:[1,0] op_sel_hi:[1,1]
    v_pk_mul_f32 v[40:41], v[112:113], v[40:41] op_sel:[1,0] op_sel_hi:[1,1]
    v_pk_mul_f32 v[42:43], v[112:113], v[42:43] op_sel:[1,0] op_sel_hi:[1,1]
    v_pk_mul_f32 v[44:45], v[112:113], v[44:45] op_sel:[1,0] op_sel_hi:[1,1]
    v_pk_mul_f32 v[46:47], v[112:113], v[46:47] op_sel:[1,0] op_sel_hi:[1,1]
    v_cvt_pk_bf16_f32 v32, v32, v33
    v_cvt_pk_bf16_f32 v33, v34, v35
    v_cvt_pk_bf16_f32 v34, v36, v37
    v_cvt_pk_bf16_f32 v35, v38, v39
    v_cvt_pk_bf16_f32 v36, v40, v41
    v_cvt_pk_bf16_f32 v37, v42, v43
    v_cvt_pk_bf16_f32 v38, v44, v45
    v_cvt_pk_bf16_f32 v39, v46, v47
    ds_write_b128 v118, v[32:35]
    ds_write_b128 v118, v[36:39] offset:16
    v_max3_f32 v64, v16, v17, v18
    v_min3_f32 v65, v16, v17, v18
    v_max3_f32 v64, v64, v19, v20
    v_min3_f32 v65, v65, v19, v20
    v_max3_f32 v64, v64, v21, v22
    v_min3_f32 v65, v65, v21, v22
    s_nop 0
    v_max3_f32 v64, v64, v23, v24
    v_min3_f32 v65, v65, v23, v24
    v_max3_f32 v64, v64, v25, v26
    v_min3_f32 v65, v65, v25, v26
    v_max3_f32 v64, v64, v27, v28
    v_min3_f32 v65, v65, v27, v28
    v_max3_f32 v64, v64, v29, v30
    v_min3_f32 v65, v65, v29, v30
    v_max_f32 v64, v64, v31
    v_min_f32 v65, v65, v31
    v_pk_mul_f32 v[64:65], v[114:115], v[64:65] op_sel:[1,0] op_sel_hi:[1,1]
    v_pk_fma_f32 v[96:97], v[16:17], v[114:115], v[64:65] op_sel:[0,1,0] op_sel_hi:[1,1,0] neg_lo:[0,0,1] neg_hi:[0,0,1]
    v_pk_fma_f32 v[48:49], v[16:17], v[114:115], v[64:65] op_sel:[0,1,1] op_sel_hi:[1,1,1] neg_lo:[1,0,0] neg_hi:[1,0,0]
    v_pk_fma_f32 v[98:99], v[18:19], v[114:115], v[64:65] op_sel:[0,1,0] op_sel_hi:[1,1,0] neg_lo:[0,0,1] neg_hi:[0,0,1]
    v_pk_fma_f32 v[50:51], v[18:19], v[114:115], v[64:65] op_sel:[0,1,1] op_sel_hi:[1,1,1] neg_lo:[1,0,0] neg_hi:[1,0,0]
    v_pk_fma_f32 v[100:101], v[20:21], v[114:115], v[64:65] op_sel:[0,1,0] op_sel_hi:[1,1,0] neg_lo:[0,0,1] neg_hi:[0,0,1]
    v_pk_fma_f32 v[52:53], v[20:21], v[114:115], v[64:65] op_sel:[0,1,1] op_sel_hi:[1,1,1] neg_lo:[1,0,0] neg_hi:[1,0,0]
    v_pk_fma_f32 v[102:103], v[22:23], v[114:115], v[64:65] op_sel:[0,1,0] op_sel_hi:[1,1,0] neg_lo:[0,0,1] neg_hi:[0,0,1]
    v_pk_fma_f32 v[54:55], v[22:23], v[114:115], v[64:65] op_sel:[0,1,1] op_sel_hi:[1,1,1] neg_lo:[1,0,0] neg_hi:[1,0,0]
    v_pk_fma_f32 v[104:105], v[24:25], v[114:115], v[64:65] op_sel:[0,1,0] op_sel_hi:[1,1,0] neg_lo:[0,0,1] neg_hi:[0,0,1]
    v_pk_fma_f32 v[56:57], v[24:25], v[114:115], v[64:65] op_sel:[0,1,1] op_sel_hi:[1,1,1] neg_lo:[1,0,0] neg_hi:[1,0,0]
    v_pk_fma_f32 v[106:107], v[26:27], v[114:115], v[64:65] op_sel:[0,1,0] op_sel_hi:[1,1,0] neg_lo:[0,0,1] neg_hi:[0,0,1]
    v_pk_fma_f32 v[58:59], v[26:27], v[114:115], v[64:65] op_sel:[0,1,1] op_sel_hi:[1,1,1] neg_lo:[1,0,0] neg_hi:[1,0,0]
    v_pk_fma_f32 v[108:109], v[28:29], v[114:115], v[64:65] op_sel:[0,1,0] op_sel_hi:[1,1,0] neg_lo:[0,0,1] neg_hi:[0,0,1]
    v_pk_fma_f32 v[60:61], v[28:29], v[114:115], v[64:65] op_sel:[0,1,1] op_sel_hi:[1,1,1] neg_lo:[1,0,0] neg_hi:[1,0,0]
    v_pk_fma_f32 v[110:111], v[30:31], v[114:115], v[64:65] op_sel:[0,1,0] op_sel_hi:[1,1,0] neg_lo:[0,0,1] neg_hi:[0,0,1]
    v_pk_fma_f32 v[62:63], v[30:31], v[114:115], v[64:65] op_sel:[0,1,1] op_sel_hi:[1,1,1] neg_lo:[1,0,0] neg_hi:[1,0,0]
    v_exp_f32 v96, v96
    v_exp_f32 v48, v48
    v_exp_f32 v97, v97
    v_exp_f32 v49, v49
    v_exp_f32 v98, v98
    v_exp_f32 v50, v50
    v_exp_f32 v99, v99
    v_exp_f32 v51, v51
    v_exp_f32 v100, v100
    v_exp_f32 v52, v52
    v_exp_f32 v101, v101
    v_exp_f32 v53, v53
    v_exp_f32 v102, v102
    v_exp_f32 v54, v54
    v_exp_f32 v103, v103
    v_exp_f32 v55, v55
    v_exp_f32 v104, v104
    v_exp_f32 v56, v56
    v_exp_f32 v105, v105
    v_exp_f32 v57, v57
    v_exp_f32 v106, v106
    v_exp_f32 v58, v58
    v_exp_f32 v107, v107
    v_exp_f32 v59, v59
    v_exp_f32 v108, v108
    v_exp_f32 v60, v60
    v_exp_f32 v109, v109
    v_exp_f32 v61, v61
    v_exp_f32 v110, v110
    v_exp_f32 v62, v62
    v_exp_f32 v111, v111
    v_exp_f32 v63, v63
    v_pk_add_f32 v[66:67], v[96:97], v[98:99] op_sel:[0,0] op_sel_hi:[1,1]
    v_pk_add_f32 v[68:69], v[48:49], v[50:51] op_sel:[0,0] op_sel_hi:[1,1]
    v_pk_add_f32 v[66:67], v[66:67], v[100:101] op_sel:[0,0] op_sel_hi:[1,1]
    v_pk_add_f32 v[68:69], v[68:69], v[52:53] op_sel:[0,0] op_sel_hi:[1,1]
    v_pk_add_f32 v[66:67], v[66:67], v[102:103] op_sel:[0,0] op_sel_hi:[1,1]
    v_pk_add_f32 v[68:69], v[68:69], v[54:55] op_sel:[0,0] op_sel_hi:[1,1]
    v_pk_add_f32 v[66:67], v[66:67], v[104:105] op_sel:[0,0] op_sel_hi:[1,1]
    v_pk_add_f32 v[68:69], v[68:69], v[56:57] op_sel:[0,0] op_sel_hi:[1,1]
    v_pk_add_f32 v[66:67], v[66:67], v[106:107] op_sel:[0,0] op_sel_hi:[1,1]
    v_pk_add_f32 v[68:69], v[68:69], v[58:59] op_sel:[0,0] op_sel_hi:[1,1]
    v_pk_add_f32 v[66:67], v[66:67], v[108:109] op_sel:[0,0] op_sel_hi:[1,1]
    v_pk_add_f32 v[68:69], v[68:69], v[60:61] op_sel:[0,0] op_sel_hi:[1,1]
    v_pk_add_f32 v[66:67], v[66:67], v[110:111] op_sel:[0,0] op_sel_hi:[1,1]
    v_pk_add_f32 v[68:69], v[68:69], v[62:63] op_sel:[0,0] op_sel_hi:[1,1]
    v_add_f32 v66, v66, v67
    v_add_f32 v68, v68, v69
    v_rcp_f32 v66, v66
    v_rcp_f32 v68, v68
    v_pk_mul_f32 v[96:97], v[66:67], v[96:97] op_sel:[0,0] op_sel_hi:[0,1]
    v_pk_mul_f32 v[48:49], v[68:69], v[48:49] op_sel:[0,0] op_sel_hi:[0,1]
    v_pk_mul_f32 v[98:99], v[66:67], v[98:99] op_sel:[0,0] op_sel_hi:[0,1]
    v_pk_mul_f32 v[50:51], v[68:69], v[50:51] op_sel:[0,0] op_sel_hi:[0,1]
    v_pk_mul_f32 v[100:101], v[66:67], v[100:101] op_sel:[0,0] op_sel_hi:[0,1]
    s_nop 0
    v_pk_mul_f32 v[52:53], v[68:69], v[52:53] op_sel:[0,0] op_sel_hi:[0,1]
    v_pk_mul_f32 v[102:103], v[66:67], v[102:103] op_sel:[0,0] op_sel_hi:[0,1]
    v_pk_mul_f32 v[54:55], v[68:69], v[54:55] op_sel:[0,0] op_sel_hi:[0,1]
    v_pk_mul_f32 v[104:105], v[66:67], v[104:105] op_sel:[0,0] op_sel_hi:[0,1]
    v_pk_mul_f32 v[56:57], v[68:69], v[56:57] op_sel:[0,0] op_sel_hi:[0,1]
    v_pk_mul_f32 v[106:107], v[66:67], v[106:107] op_sel:[0,0] op_sel_hi:[0,1]
    v_pk_mul_f32 v[58:59], v[68:69], v[58:59] op_sel:[0,0] op_sel_hi:[0,1]
    v_pk_mul_f32 v[108:109], v[66:67], v[108:109] op_sel:[0,0] op_sel_hi:[0,1]
    v_pk_mul_f32 v[60:61], v[68:69], v[60:61] op_sel:[0,0] op_sel_hi:[0,1]
    v_pk_mul_f32 v[110:111], v[66:67], v[110:111] op_sel:[0,0] op_sel_hi:[0,1]
    v_pk_mul_f32 v[62:63], v[68:69], v[62:63] op_sel:[0,0] op_sel_hi:[0,1]
    v_cvt_pk_bf16_f32 v96, v96, v97
    v_cvt_pk_bf16_f32 v48, v48, v49
    v_cvt_pk_bf16_f32 v97, v98, v99
    v_cvt_pk_bf16_f32 v49, v50, v51
    v_cvt_pk_bf16_f32 v98, v100, v101
    v_cvt_pk_bf16_f32 v50, v52, v53
    v_cvt_pk_bf16_f32 v99, v102, v103
    v_cvt_pk_bf16_f32 v51, v54, v55
    v_cvt_pk_bf16_f32 v100, v104, v105
    v_cvt_pk_bf16_f32 v52, v56, v57
    v_cvt_pk_bf16_f32 v101, v106, v107
    v_cvt_pk_bf16_f32 v53, v58, v59
    v_cvt_pk_bf16_f32 v102, v108, v109
    v_cvt_pk_bf16_f32 v54, v60, v61
    v_cvt_pk_bf16_f32 v103, v110, v111
    v_cvt_pk_bf16_f32 v55, v62, v63
    ds_write_b128 v117, v[96:99]
    ds_write_b128 v117, v[100:103] offset:16
    ds_write_b128 v117, v[48:51] offset:32
    ds_write_b128 v117, v[52:55] offset:48
    s_lshl_b32 s95, s3, 2
    s_add_u32 s95, s95, 163200
    v_mov_b32 v124, s95
    v_add_u32 v125, 1, s73
    ds_write_b32 v124, v125
    v_and_b32 v124, 12, v3
    v_add_u32 v124, 163200, v124
    ds_read_b32 v126, v124
    v_lshrrev_b32 v13, 4, v0
    v_lshlrev_b32 v13, 3, v13
    v_bfe_u32 v14, v0, 2, 2
    v_add_u32 v13, v13, v14
    v_and_b32 v14, 3, v0
    v_lshlrev_b32 v14, 3, v14
    s_lshl_b32 s92, s70, 5
    s_add_u32 s92, s92, 131072
    v_mul_u32_u24 v119, 144, v13
    v_add3_u32 v119, v119, v14, s92
    s_lshl_b32 s92, s46, 5
    s_add_u32 s92, s92, 149504
    v_mul_u32_u24 v120, 80, v13
    v_add3_u32 v120, v120, v14, s92
    s_add_u32 s44, s44, 32768
    s_and_b32 s44, s44, 131071
    v_add_u32 v2, s44, v122
    v_xor_b32 v121, 64, v2
    s_waitcnt lgkmcnt(0)
    v_cmp_ne_u32 vcc, v125, v126
    s_cbranch_vccz .Lsigd_6
.Lsig_5:
    ds_read_b32 v126, v124
    s_waitcnt lgkmcnt(0)
    v_cmp_ne_u32 vcc, v125, v126
    s_cbranch_vccz .Lsigd_6
    s_sub_u32 s72, s72, 1
    s_cbranch_scc0 .Lsig_5
    s_mov_b32 s72, 0
.Lsigd_6:
    v_and_b32 v124, 12, v3
    v_add_u32 v124, 163216, v124
    ds_read_b32 v126, v124
    ds_read_b64_tr_b16 v[16:17], v119 offset:0
    ds_read_b64_tr_b16 v[32:33], v120 offset:0
    ds_read_b64_tr_b16 v[18:19], v119 offset:576
    ds_read_b64_tr_b16 v[34:35], v120 offset:320
    ds_read_b64_tr_b16 v[20:21], v119 offset:4608
    s_nop 0
    ds_read_b64_tr_b16 v[36:37], v120 offset:2560
    ds_read_b64_tr_b16 v[22:23], v119 offset:5184
    ds_read_b64_tr_b16 v[38:39], v120 offset:2880
    ds_read_b64_tr_b16 v[24:25], v119 offset:9216
    ds_read_b64_tr_b16 v[40:41], v120 offset:5120
    ds_read_b64_tr_b16 v[26:27], v119 offset:9792
    ds_read_b64_tr_b16 v[42:43], v120 offset:5440
    ds_read_b64_tr_b16 v[28:29], v119 offset:13824
    ds_read_b64_tr_b16 v[44:45], v120 offset:7680
    ds_read_b64_tr_b16 v[30:31], v119 offset:14400
    ds_read_b64_tr_b16 v[46:47], v120 offset:8000
    v_mov_b32 v96, s97
    v_mov_b32 v97, s97
    v_mov_b32 v98, s97
    v_mov_b32 v99, s97
    s_waitcnt lgkmcnt(13)
    s_nop 0
    v_mfma_f32_16x16x32_bf16 v[104:107], v[96:99], v[16:19], 0
    s_waitcnt lgkmcnt(12)
    v_mfma_f32_16x16x32_bf16 v[100:103], v[16:19], v[32:35], 0
    s_waitcnt lgkmcnt(9)
    v_mfma_f32_16x16x32_bf16 v[104:107], v[96:99], v[20:23], v[104:107]
    s_waitcnt lgkmcnt(8)
    v_mfma_f32_16x16x32_bf16 v[100:103], v[20:23], v[36:39], v[100:103]
    s_waitcnt lgkmcnt(5)
    v_mfma_f32_16x16x32_bf16 v[104:107], v[96:99], v[24:27], v[104:107]
    s_waitcnt lgkmcnt(4)
    v_mfma_f32_16x16x32_bf16 v[100:103], v[24:27], v[40:43], v[100:103]
    s_waitcnt lgkmcnt(1)
    v_mfma_f32_16x16x32_bf16 v[104:107], v[96:99], v[28:31], v[104:107]
    s_waitcnt lgkmcnt(0)
    v_mfma_f32_16x16x32_bf16 v[100:103], v[28:31], v[44:47], v[100:103]
    v_and_b32 v111, 3221209087, v12
    s_nop 4
    v_and_b32 v105, 4294901760, v104
    v_sub_f32 v104, v104, v105
    v_cvt_pk_bf16_f32 v110, v105, v104
    v_cvt_pk_bf16_f32 v106, v100, v101
    v_cvt_pk_bf16_f32 v107, v102, v103
    v_cvt_pk_bf16_f32 v108, v100, v101
    v_cvt_pk_bf16_f32 v109, v102, v103
    v_permlane16_swap_b32 v106, v107
    s_nop 1
    v_permlane32_swap_b32 v107, v110
    s_mov_b32 exec_hi, 65535
    buffer_store_dwordx4 v[108:111], v1, s[4:7], s88 offen sc1
    s_mov_b32 exec_hi, -1
    s_waitcnt lgkmcnt(0)
    v_cmp_ne_u32 vcc, v125, v126
    s_cbranch_vccz .Lsigd_8
.Lsig_7:
    ds_read_b32 v126, v124
    s_waitcnt lgkmcnt(0)
    v_cmp_ne_u32 vcc, v125, v126
    s_cbranch_vccz .Lsigd_8
    s_sub_u32 s72, s72, 1
    s_cbranch_scc0 .Lsig_7
    s_mov_b32 s72, 0
.Lsigd_8:
    ds_read_b64_tr_b16 v[64:65], v2 offset:0
    ds_read_b64_tr_b16 v[66:67], v2 offset:512
    ds_read_b64_tr_b16 v[68:69], v121 offset:0
    ds_read_b64_tr_b16 v[70:71], v121 offset:512
    ds_read_b64_tr_b16 v[72:73], v2 offset:2048
    ds_read_b64_tr_b16 v[74:75], v2 offset:2560
    ds_read_b64_tr_b16 v[76:77], v121 offset:2048
    ds_read_b64_tr_b16 v[78:79], v121 offset:2560
    ds_read_b64_tr_b16 v[80:81], v2 offset:4096
    ds_read_b64_tr_b16 v[82:83], v2 offset:4608
    s_waitcnt lgkmcnt(8)
    v_mfma_f32_32x32x16_bf16 v[48:63], v[64:67], v[128:131], 0
    ds_read_b64_tr_b16 v[84:85], v121 offset:4096
    ds_read_b64_tr_b16 v[86:87], v121 offset:4608
    s_waitcnt lgkmcnt(8)
    v_mfma_f32_32x32x16_bf16 v[48:63], v[68:71], v[192:195], v[48:63]
    ds_read_b64_tr_b16 v[64:65], v2 offset:6144
    ds_read_b64_tr_b16 v[66:67], v2 offset:6656
    s_waitcnt lgkmcnt(8)
    v_mfma_f32_32x32x16_bf16 v[48:63], v[72:75], v[132:135], v[48:63]
    ds_read_b64_tr_b16 v[68:69], v121 offset:6144
    ds_read_b64_tr_b16 v[70:71], v121 offset:6656
    s_nop 0
    s_waitcnt lgkmcnt(8)
    v_mfma_f32_32x32x16_bf16 v[48:63], v[76:79], v[196:199], v[48:63]
    ds_read_b64_tr_b16 v[72:73], v2 offset:8192
    ds_read_b64_tr_b16 v[74:75], v2 offset:8704
    s_waitcnt lgkmcnt(8)
    v_mfma_f32_32x32x16_bf16 v[48:63], v[80:83], v[136:139], v[48:63]
    ds_read_b64_tr_b16 v[76:77], v121 offset:8192
    ds_read_b64_tr_b16 v[78:79], v121 offset:8704
    ds_read_b128 v[16:19], v116 offset:256
    ds_read_b128 v[20:23], v116 offset:272
    ds_read_b128 v[24:27], v116 offset:288
    s_waitcnt lgkmcnt(11)
    v_mfma_f32_32x32x16_bf16 v[48:63], v[84:87], v[200:203], v[48:63]
    ds_read_b64_tr_b16 v[80:81], v2 offset:10240
    ds_read_b64_tr_b16 v[82:83], v2 offset:10752
    ds_read_b128 v[28:31], v116 offset:304
    v_and_b32 v119, 15, v0
    v_mul_u32_u24 v119, 768, v119
    s_waitcnt lgkmcnt(12)
    v_mfma_f32_32x32x16_bf16 v[48:63], v[64:67], v[140:143], v[48:63]
    ds_read_b64_tr_b16 v[84:85], v121 offset:10240
    ds_read_b64_tr_b16 v[86:87], v121 offset:10752
    v_subrev_u32 v14, 256, v1
    v_cmp_gt_u32 vcc, 48, v0
    s_nop 1
    v_cndmask_b32 v118, v14, v1, vcc
    s_waitcnt lgkmcnt(12)
    v_mfma_f32_32x32x16_bf16 v[48:63], v[68:71], v[204:207], v[48:63]
    ds_read_b64_tr_b16 v[64:65], v2 offset:12288
    ds_read_b64_tr_b16 v[66:67], v2 offset:12800
    s_waitcnt lgkmcnt(12)
    v_mfma_f32_32x32x16_bf16 v[48:63], v[72:75], v[144:147], v[48:63]
    ds_read_b64_tr_b16 v[68:69], v121 offset:12288
    ds_read_b64_tr_b16 v[70:71], v121 offset:12800
    s_waitcnt lgkmcnt(12)
    v_mfma_f32_32x32x16_bf16 v[48:63], v[76:79], v[208:211], v[48:63]
    ds_read_b64_tr_b16 v[72:73], v2 offset:14336
    ds_read_b64_tr_b16 v[74:75], v2 offset:14848
    s_waitcnt lgkmcnt(9)
    v_mfma_f32_32x32x16_bf16 v[48:63], v[80:83], v[148:151], v[48:63]
    ds_read_b64_tr_b16 v[76:77], v121 offset:14336
    ds_read_b64_tr_b16 v[78:79], v121 offset:14848
    v_and_b32 v14, 1, v0
    v_lshlrev_b32 v14, 4, v14
    v_mov_b32 v15, 16256
    s_waitcnt lgkmcnt(8)
    v_mfma_f32_32x32x16_bf16 v[48:63], v[84:87], v[212:215], v[48:63]
    ds_read_b64_tr_b16 v[80:81], v2 offset:16384
    ds_read_b64_tr_b16 v[82:83], v2 offset:16896
    v_lshlrev_b32 v14, v14, v15
    v_bfe_u32 v13, v0, 2, 2
    v_bfe_u32 v15, v0, 1, 1
    s_waitcnt lgkmcnt(8)
    v_mfma_f32_32x32x16_bf16 v[48:63], v[64:67], v[152:155], v[48:63]
    ds_read_b64_tr_b16 v[84:85], v121 offset:16384
    ds_read_b64_tr_b16 v[86:87], v121 offset:16896
    v_cmp_eq_u32 vcc, 3, v13
    s_nop 1
    v_cndmask_b32 v13, v13, v15, vcc
    v_cndmask_b32 v15, v15, 2, vcc
    s_waitcnt lgkmcnt(8)
    v_mfma_f32_32x32x16_bf16 v[48:63], v[68:71], v[216:219], v[48:63]
    ds_read_b64_tr_b16 v[64:65], v2 offset:18432
    ds_read_b64_tr_b16 v[66:67], v2 offset:18944
    v_lshrrev_b32 v202, 4, v0
    v_cmp_eq_u32 vcc, v13, v202
    s_nop 1
    v_cndmask_b32 v14, 0, v14, vcc
    s_waitcnt lgkmcnt(8)
    v_mfma_f32_32x32x16_bf16 v[48:63], v[72:75], v[156:159], v[48:63]
    ds_read_b64_tr_b16 v[68:69], v121 offset:18432
    ds_read_b64_tr_b16 v[70:71], v121 offset:18944
    v_cmp_eq_u32 vcc, 0, v15
    s_nop 1
    v_cndmask_b32 v192, 0, v14, vcc
    v_cmp_eq_u32 vcc, 1, v15
    s_waitcnt lgkmcnt(8)
    v_mfma_f32_32x32x16_bf16 v[48:63], v[76:79], v[220:223], v[48:63]
    ds_read_b64_tr_b16 v[72:73], v2 offset:20480
    s_nop 0
    ds_read_b64_tr_b16 v[74:75], v2 offset:20992
    v_cndmask_b32 v193, 0, v14, vcc
    v_cmp_eq_u32 vcc, 2, v15
    s_nop 1
    v_cndmask_b32 v194, 0, v14, vcc
    s_waitcnt lgkmcnt(8)
    v_mfma_f32_32x32x16_bf16 v[48:63], v[80:83], v[160:163], v[48:63]
    ds_read_b64_tr_b16 v[76:77], v121 offset:20480
    ds_read_b64_tr_b16 v[78:79], v121 offset:20992
    v_mov_b32 v195, 0
    s_mul_i32 s92, s45, 1152
    s_add_u32 s92, s92, 159744
    s_waitcnt lgkmcnt(8)
    v_mfma_f32_32x32x16_bf16 v[48:63], v[84:87], v[224:227], v[48:63]
    ds_read_b64_tr_b16 v[80:81], v2 offset:22528
    ds_read_b64_tr_b16 v[82:83], v2 offset:23040
    s_lshl_b32 s93, s46, 6
    s_add_u32 s93, s93, s92
    v_lshrrev_b32 v14, 5, v0
    s_waitcnt lgkmcnt(8)
    v_mfma_f32_32x32x16_bf16 v[48:63], v[64:67], v[164:167], v[48:63]
    ds_read_b64_tr_b16 v[84:85], v121 offset:22528
    ds_read_b64_tr_b16 v[86:87], v121 offset:23040
    v_mul_u32_u24 v117, 576, v14
    v_bfe_u32 v13, v0, 2, 2
    v_lshl_add_u32 v117, v13, 7, v117
    s_waitcnt lgkmcnt(8)
    v_mfma_f32_32x32x16_bf16 v[48:63], v[68:71], v[228:231], v[48:63]
    ds_read_b64_tr_b16 v[64:65], v2 offset:24576
    ds_read_b64_tr_b16 v[66:67], v2 offset:25088
    v_and_b32 v13, 3, v0
    v_lshl_add_u32 v117, v13, 4, v117
    v_bfe_u32 v13, v0, 4, 1
    s_waitcnt lgkmcnt(8)
    v_mfma_f32_32x32x16_bf16 v[48:63], v[72:75], v[168:171], v[48:63]
    ds_read_b64_tr_b16 v[68:69], v121 offset:24576
    ds_read_b64_tr_b16 v[70:71], v121 offset:25088
    v_lshl_add_u32 v117, v13, 3, v117
    v_add_u32 v117, s93, v117
    s_lshl_b32 s93, s46, 4
    s_waitcnt lgkmcnt(8)
    v_mfma_f32_32x32x16_bf16 v[48:63], v[76:79], v[232:235], v[48:63]
    ds_read_b64_tr_b16 v[72:73], v2 offset:26624
    ds_read_b64_tr_b16 v[74:75], v2 offset:27136
    s_add_u32 s93, s93, s92
    s_add_u32 s93, s93, 512
    v_bfe_u32 v13, v0, 3, 1
    s_waitcnt lgkmcnt(8)
    v_mfma_f32_32x32x16_bf16 v[48:63], v[80:83], v[172:175], v[48:63]
    ds_read_b64_tr_b16 v[76:77], v121 offset:26624
    ds_read_b64_tr_b16 v[78:79], v121 offset:27136
    v_mul_u32_u24 v203, 576, v13
    v_and_b32 v13, 7, v0
    v_lshl_add_u32 v203, v13, 1, v203
    s_waitcnt lgkmcnt(8)
    v_mfma_f32_32x32x16_bf16 v[48:63], v[84:87], v[236:239], v[48:63]
    ds_read_b64_tr_b16 v[80:81], v2 offset:28672
    ds_read_b64_tr_b16 v[82:83], v2 offset:29184
    v_add_u32 v203, s93, v203
    v_mov_b32 v15, 160304
    v_cmp_gt_u32 vcc, 32, v0
    s_waitcnt lgkmcnt(8)
    v_mfma_f32_32x32x16_bf16 v[48:63], v[64:67], v[176:179], v[48:63]
    ds_read_b64_tr_b16 v[84:85], v121 offset:28672
    ds_read_b64_tr_b16 v[86:87], v121 offset:29184
    v_cndmask_b32 v203, v203, v15, vcc
    v_and_b32 v13, 31, v0
    v_lshlrev_b32 v13, 4, v13
    s_waitcnt lgkmcnt(8)
    v_mfma_f32_32x32x16_bf16 v[48:63], v[68:71], v[240:243], v[48:63]
    ds_read_b64_tr_b16 v[64:65], v2 offset:30720
    ds_read_b64_tr_b16 v[66:67], v2 offset:31232
    v_bfe_u32 v15, v0, 2, 1
    v_cmp_eq_u32 vcc, v15, v14
    v_mov_b32 v15, 544
    s_waitcnt lgkmcnt(8)
    v_mfma_f32_32x32x16_bf16 v[48:63], v[72:75], v[180:183], v[48:63]
    ds_read_b64_tr_b16 v[68:69], v121 offset:30720
    s_nop 0
    ds_read_b64_tr_b16 v[70:71], v121 offset:31232
    v_cndmask_b32 v13, v15, v13, vcc
    v_add_u32 v120, 159744, v13
    s_waitcnt lgkmcnt(8)
    v_mfma_f32_32x32x16_bf16 v[48:63], v[76:79], v[244:247], v[48:63]
    s_waitcnt lgkmcnt(6)
    v_mfma_f32_32x32x16_bf16 v[48:63], v[80:83], v[184:187], v[48:63]
    s_waitcnt lgkmcnt(4)
    v_mfma_f32_32x32x16_bf16 v[48:63], v[84:87], v[248:251], v[48:63]
    s_waitcnt lgkmcnt(2)
    v_mfma_f32_32x32x16_bf16 v[48:63], v[64:67], v[188:191], v[48:63]
    s_waitcnt lgkmcnt(0)
    v_mfma_f32_32x32x16_bf16 v[48:63], v[68:71], v[252:255], v[48:63]
    s_nop 11
    v_pk_fma_f32 v[48:49], v[16:17], v[112:113], v[48:49] op_sel:[0,0,0] op_sel_hi:[1,0,1]
    v_pk_fma_f32 v[50:51], v[18:19], v[112:113], v[50:51] op_sel:[0,0,0] op_sel_hi:[1,0,1]
    v_pk_fma_f32 v[52:53], v[20:21], v[112:113], v[52:53] op_sel:[0,0,0] op_sel_hi:[1,0,1]
    v_pk_fma_f32 v[54:55], v[22:23], v[112:113], v[54:55] op_sel:[0,0,0] op_sel_hi:[1,0,1]
    v_pk_fma_f32 v[56:57], v[24:25], v[112:113], v[56:57] op_sel:[0,0,0] op_sel_hi:[1,0,1]
    v_pk_fma_f32 v[58:59], v[26:27], v[112:113], v[58:59] op_sel:[0,0,0] op_sel_hi:[1,0,1]
    v_pk_fma_f32 v[60:61], v[28:29], v[112:113], v[60:61] op_sel:[0,0,0] op_sel_hi:[1,0,1]
    v_pk_fma_f32 v[62:63], v[30:31], v[112:113], v[62:63] op_sel:[0,0,0] op_sel_hi:[1,0,1]
    v_cvt_pk_bf16_f32 v64, v48, v49
    v_cvt_pk_bf16_f32 v65, v50, v51
    v_cvt_pk_bf16_f32 v66, v52, v53
    v_cvt_pk_bf16_f32 v67, v54, v55
    v_cvt_pk_bf16_f32 v68, v56, v57
    v_cvt_pk_bf16_f32 v69, v58, v59
    v_cvt_pk_bf16_f32 v70, v60, v61
    v_cvt_pk_bf16_f32 v71, v62, v63
    v_mfma_f32_32x32x16_bf16 v[48:63], v[88:91], v[64:67], 0
    s_nop 0
    v_mfma_f32_32x32x16_bf16 v[48:63], v[92:95], v[68:71], v[48:63]
    s_nop 11
    v_max3_f32 v64, v48, v49, v50
    v_min3_f32 v65, v48, v49, v50
    v_max3_f32 v64, v64, v51, v52
    v_min3_f32 v65, v65, v51, v52
    v_max3_f32 v64, v64, v53, v54
    v_min3_f32 v65, v65, v53, v54
    v_max3_f32 v64, v64, v55, v56
    v_min3_f32 v65, v65, v55, v56
    v_max3_f32 v64, v64, v57, v58
    v_min3_f32 v65, v65, v57, v58
    v_max3_f32 v64, v64, v59, v60
    v_min3_f32 v65, v65, v59, v60
    v_max3_f32 v64, v64, v61, v62
    v_min3_f32 v65, v65, v61, v62
    v_max_f32 v64, v64, v63
    v_min_f32 v65, v65, v63
    v_pk_mul_f32 v[64:65], v[114:115], v[64:65] op_sel:[1,0] op_sel_hi:[1,1]
    v_pk_fma_f32 v[16:17], v[48:49], v[114:115], v[64:65] op_sel:[0,1,0] op_sel_hi:[1,1,0] neg_lo:[0,0,1] neg_hi:[0,0,1]
    buffer_load_dwordx4 v[128:131], v118, s[4:7], s89 offen offset:0 sc1
    v_pk_fma_f32 v[32:33], v[48:49], v[114:115], v[64:65] op_sel:[0,1,1] op_sel_hi:[1,1,1] neg_lo:[1,0,0] neg_hi:[1,0,0]
    v_pk_fma_f32 v[18:19], v[50:51], v[114:115], v[64:65] op_sel:[0,1,0] op_sel_hi:[1,1,0] neg_lo:[0,0,1] neg_hi:[0,0,1]
    v_pk_fma_f32 v[34:35], v[50:51], v[114:115], v[64:65] op_sel:[0,1,1] op_sel_hi:[1,1,1] neg_lo:[1,0,0] neg_hi:[1,0,0]
    buffer_load_dwordx4 v[132:135], v118, s[4:7], s89 offen offset:768 sc1
    v_pk_fma_f32 v[20:21], v[52:53], v[114:115], v[64:65] op_sel:[0,1,0] op_sel_hi:[1,1,0] neg_lo:[0,0,1] neg_hi:[0,0,1]
    v_pk_fma_f32 v[36:37], v[52:53], v[114:115], v[64:65] op_sel:[0,1,1] op_sel_hi:[1,1,1] neg_lo:[1,0,0] neg_hi:[1,0,0]
    v_pk_fma_f32 v[22:23], v[54:55], v[114:115], v[64:65] op_sel:[0,1,0] op_sel_hi:[1,1,0] neg_lo:[0,0,1] neg_hi:[0,0,1]
    buffer_load_dwordx4 v[136:139], v118, s[4:7], s89 offen offset:1536 sc1
    v_pk_fma_f32 v[38:39], v[54:55], v[114:115], v[64:65] op_sel:[0,1,1] op_sel_hi:[1,1,1] neg_lo:[1,0,0] neg_hi:[1,0,0]
    v_pk_fma_f32 v[24:25], v[56:57], v[114:115], v[64:65] op_sel:[0,1,0] op_sel_hi:[1,1,0] neg_lo:[0,0,1] neg_hi:[0,0,1]
    v_pk_fma_f32 v[40:41], v[56:57], v[114:115], v[64:65] op_sel:[0,1,1] op_sel_hi:[1,1,1] neg_lo:[1,0,0] neg_hi:[1,0,0]
    buffer_load_dwordx4 v[140:143], v118, s[4:7], s89 offen offset:2304 sc1
    v_pk_fma_f32 v[26:27], v[58:59], v[114:115], v[64:65] op_sel:[0,1,0] op_sel_hi:[1,1,0] neg_lo:[0,0,1] neg_hi:[0,0,1]
    v_pk_fma_f32 v[42:43], v[58:59], v[114:115], v[64:65] op_sel:[0,1,1] op_sel_hi:[1,1,1] neg_lo:[1,0,0] neg_hi:[1,0,0]
    v_pk_fma_f32 v[28:29], v[60:61], v[114:115], v[64:65] op_sel:[0,1,0] op_sel_hi:[1,1,0] neg_lo:[0,0,1] neg_hi:[0,0,1]
    s_add_u32 s92, s89, 3072
    s_nop 0
    buffer_load_dwordx4 v[144:147], v118, s[4:7], s92 offen offset:0 sc1
    v_pk_fma_f32 v[44:45], v[60:61], v[114:115], v[64:65] op_sel:[0,1,1] op_sel_hi:[1,1,1] neg_lo:[1,0,0] neg_hi:[1,0,0]
    v_pk_fma_f32 v[30:31], v[62:63], v[114:115], v[64:65] op_sel:[0,1,0] op_sel_hi:[1,1,0] neg_lo:[0,0,1] neg_hi:[0,0,1]
    v_pk_fma_f32 v[46:47], v[62:63], v[114:115], v[64:65] op_sel:[0,1,1] op_sel_hi:[1,1,1] neg_lo:[1,0,0] neg_hi:[1,0,0]
    buffer_load_dwordx4 v[148:151], v118, s[4:7], s92 offen offset:768 sc1
    v_exp_f32 v16, v16
    v_exp_f32 v32, v32
    v_exp_f32 v17, v17
    buffer_load_dwordx4 v[152:155], v118, s[4:7], s92 offen offset:1536 sc1
    v_exp_f32 v33, v33
    v_exp_f32 v18, v18
    v_exp_f32 v34, v34
    buffer_load_dwordx4 v[156:159], v118, s[4:7], s92 offen offset:2304 sc1
    v_exp_f32 v19, v19
    v_exp_f32 v35, v35
    v_exp_f32 v20, v20
    s_add_u32 s92, s89, 6144
    buffer_load_dwordx4 v[160:163], v118, s[4:7], s92 offen offset:0 sc1
    v_exp_f32 v36, v36
    v_exp_f32 v21, v21
    v_exp_f32 v37, v37
    buffer_load_dwordx4 v[164:167], v118, s[4:7], s92 offen offset:768 sc1
    v_exp_f32 v22, v22
    v_exp_f32 v38, v38
    v_exp_f32 v23, v23
    buffer_load_dwordx4 v[168:171], v118, s[4:7], s92 offen offset:1536 sc1
    v_exp_f32 v39, v39
    v_exp_f32 v24, v24
    v_exp_f32 v40, v40
    buffer_load_dwordx4 v[172:175], v118, s[4:7], s92 offen offset:2304 sc1
    v_exp_f32 v25, v25
    v_exp_f32 v41, v41
    v_exp_f32 v26, v26
    s_add_u32 s92, s89, 9216
    buffer_load_dwordx4 v[176:179], v118, s[4:7], s92 offen offset:0 sc1
    v_exp_f32 v42, v42
    v_exp_f32 v27, v27
    v_exp_f32 v43, v43
    buffer_load_dwordx4 v[180:183], v118, s[4:7], s92 offen offset:768 sc1
    v_exp_f32 v28, v28
    v_exp_f32 v44, v44
    v_exp_f32 v29, v29
    buffer_load_dwordx4 v[184:187], v118, s[4:7], s92 offen offset:1536 sc1
    v_exp_f32 v45, v45
    v_exp_f32 v30, v30
    v_exp_f32 v46, v46
    buffer_load_dwordx4 v[188:191], v118, s[4:7], s92 offen offset:2304 sc1
    s_lshl_b32 s94, s66, 7
    s_add_u32 s94, s94, 4096
    buffer_load_dword v200, v3, s[4:7], s94 offen sc1
    v_exp_f32 v31, v31
    v_exp_f32 v47, v47
    v_pk_add_f32 v[66:67], v[16:17], v[18:19] op_sel:[0,0] op_sel_hi:[1,1]
    v_pk_add_f32 v[68:69], v[32:33], v[34:35] op_sel:[0,0] op_sel_hi:[1,1]
    v_pk_add_f32 v[66:67], v[66:67], v[20:21] op_sel:[0,0] op_sel_hi:[1,1]
    v_pk_add_f32 v[68:69], v[68:69], v[36:37] op_sel:[0,0] op_sel_hi:[1,1]
    v_pk_add_f32 v[66:67], v[66:67], v[22:23] op_sel:[0,0] op_sel_hi:[1,1]
    v_pk_add_f32 v[68:69], v[68:69], v[38:39] op_sel:[0,0] op_sel_hi:[1,1]
    v_pk_add_f32 v[66:67], v[66:67], v[24:25] op_sel:[0,0] op_sel_hi:[1,1]
    v_pk_add_f32 v[68:69], v[68:69], v[40:41] op_sel:[0,0] op_sel_hi:[1,1]
    v_pk_add_f32 v[66:67], v[66:67], v[26:27] op_sel:[0,0] op_sel_hi:[1,1]
    v_pk_add_f32 v[68:69], v[68:69], v[42:43] op_sel:[0,0] op_sel_hi:[1,1]
    v_pk_add_f32 v[66:67], v[66:67], v[28:29] op_sel:[0,0] op_sel_hi:[1,1]
    v_pk_add_f32 v[68:69], v[68:69], v[44:45] op_sel:[0,0] op_sel_hi:[1,1]
    v_pk_add_f32 v[66:67], v[66:67], v[30:31] op_sel:[0,0] op_sel_hi:[1,1]
    v_pk_add_f32 v[68:69], v[68:69], v[46:47] op_sel:[0,0] op_sel_hi:[1,1]
    v_add_f32 v66, v66, v67
    v_add_f32 v68, v68, v69
    v_rcp_f32 v66, v66
    v_rcp_f32 v68, v68
    v_pk_mul_f32 v[16:17], v[66:67], v[16:17] op_sel:[0,0] op_sel_hi:[0,1]
    v_pk_mul_f32 v[32:33], v[68:69], v[32:33] op_sel:[0,0] op_sel_hi:[0,1]
    v_pk_mul_f32 v[18:19], v[66:67], v[18:19] op_sel:[0,0] op_sel_hi:[0,1]
    v_pk_mul_f32 v[34:35], v[68:69], v[34:35] op_sel:[0,0] op_sel_hi:[0,1]
    v_pk_mul_f32 v[20:21], v[66:67], v[20:21] op_sel:[0,0] op_sel_hi:[0,1]
    v_pk_mul_f32 v[36:37], v[68:69], v[36:37] op_sel:[0,0] op_sel_hi:[0,1]
    v_pk_mul_f32 v[22:23], v[66:67], v[22:23] op_sel:[0,0] op_sel_hi:[0,1]
    v_pk_mul_f32 v[38:39], v[68:69], v[38:39] op_sel:[0,0] op_sel_hi:[0,1]
    v_pk_mul_f32 v[24:25], v[66:67], v[24:25] op_sel:[0,0] op_sel_hi:[0,1]
    v_pk_mul_f32 v[40:41], v[68:69], v[40:41] op_sel:[0,0] op_sel_hi:[0,1]
    v_pk_mul_f32 v[26:27], v[66:67], v[26:27] op_sel:[0,0] op_sel_hi:[0,1]
    v_pk_mul_f32 v[42:43], v[68:69], v[42:43] op_sel:[0,0] op_sel_hi:[0,1]
    s_nop 0
    v_pk_mul_f32 v[28:29], v[66:67], v[28:29] op_sel:[0,0] op_sel_hi:[0,1]
    v_pk_mul_f32 v[44:45], v[68:69], v[44:45] op_sel:[0,0] op_sel_hi:[0,1]
    v_pk_mul_f32 v[30:31], v[66:67], v[30:31] op_sel:[0,0] op_sel_hi:[0,1]
    v_pk_mul_f32 v[46:47], v[68:69], v[46:47] op_sel:[0,0] op_sel_hi:[0,1]
    v_cvt_pk_bf16_f32 v16, v16, v17
    v_cvt_pk_bf16_f32 v32, v32, v33
    v_cvt_pk_bf16_f32 v17, v18, v19
    v_cvt_pk_bf16_f32 v33, v34, v35
    v_cvt_pk_bf16_f32 v18, v20, v21
    v_cvt_pk_bf16_f32 v34, v36, v37
    v_cvt_pk_bf16_f32 v19, v22, v23
    v_cvt_pk_bf16_f32 v35, v38, v39
    v_cvt_pk_bf16_f32 v20, v24, v25
    v_cvt_pk_bf16_f32 v36, v40, v41
    v_cvt_pk_bf16_f32 v21, v26, v27
    v_cvt_pk_bf16_f32 v37, v42, v43
    v_cvt_pk_bf16_f32 v22, v28, v29
    v_cvt_pk_bf16_f32 v38, v44, v45
    v_cvt_pk_bf16_f32 v23, v30, v31
    v_cvt_pk_bf16_f32 v39, v46, v47
    s_and_b32 s95, s71, 3221209087
.Lkvv_9:
    s_waitcnt vmcnt(16)
    v_dot2_f32_bf16 v201, v130, s97, 0
    v_xor_b32 v202, s95, v131
    v_mfma_f32_16x16x32_bf16 v[196:199], v[192:195], v[128:131], 0
    s_waitcnt vmcnt(15)
    v_dot2_f32_bf16 v201, v134, s97, v201
    v_xor_b32 v13, s95, v135
    v_or_b32 v202, v13, v202
    v_mfma_f32_16x16x32_bf16 v[196:199], v[192:195], v[132:135], v[196:199]
    s_waitcnt vmcnt(14)
    v_dot2_f32_bf16 v201, v138, s97, v201
    v_xor_b32 v13, s95, v139
    v_or_b32 v202, v13, v202
    v_mfma_f32_16x16x32_bf16 v[196:199], v[192:195], v[136:139], v[196:199]
    s_waitcnt vmcnt(13)
    v_dot2_f32_bf16 v201, v142, s97, v201
    v_xor_b32 v13, s95, v143
    v_or_b32 v202, v13, v202
    v_mfma_f32_16x16x32_bf16 v[196:199], v[192:195], v[140:143], v[196:199]
    s_waitcnt vmcnt(12)
    v_dot2_f32_bf16 v201, v146, s97, v201
    v_xor_b32 v13, s95, v147
    v_or_b32 v202, v13, v202
    v_mfma_f32_16x16x32_bf16 v[196:199], v[192:195], v[144:147], v[196:199]
    s_waitcnt vmcnt(11)
    v_dot2_f32_bf16 v201, v150, s97, v201
    v_xor_b32 v13, s95, v151
    v_or_b32 v202, v13, v202
    v_mfma_f32_16x16x32_bf16 v[196:199], v[192:195], v[148:151], v[196:199]
    s_waitcnt vmcnt(10)
    v_dot2_f32_bf16 v201, v154, s97, v201
    v_xor_b32 v13, s95, v155
    v_or_b32 v202, v13, v202
    v_mfma_f32_16x16x32_bf16 v[196:199], v[192:195], v[152:155], v[196:199]
    s_waitcnt vmcnt(9)
    v_dot2_f32_bf16 v201, v158, s97, v201
    v_xor_b32 v13, s95, v159
    v_or_b32 v202, v13, v202
    v_mfma_f32_16x16x32_bf16 v[196:199], v[192:195], v[156:159], v[196:199]
    s_waitcnt vmcnt(8)
    v_dot2_f32_bf16 v201, v162, s97, v201
    v_xor_b32 v13, s95, v163
    v_or_b32 v202, v13, v202
    v_mfma_f32_16x16x32_bf16 v[196:199], v[192:195], v[160:163], v[196:199]
    s_waitcnt vmcnt(7)
    v_dot2_f32_bf16 v201, v166, s97, v201
    v_xor_b32 v13, s95, v167
    v_or_b32 v202, v13, v202
    v_mfma_f32_16x16x32_bf16 v[196:199], v[192:195], v[164:167], v[196:199]
    s_waitcnt vmcnt(6)
    v_dot2_f32_bf16 v201, v170, s97, v201
    v_xor_b32 v13, s95, v171
    v_or_b32 v202, v13, v202
    v_mfma_f32_16x16x32_bf16 v[196:199], v[192:195], v[168:171], v[196:199]
    s_waitcnt vmcnt(5)
    v_dot2_f32_bf16 v201, v174, s97, v201
    v_xor_b32 v13, s95, v175
    v_or_b32 v202, v13, v202
    v_mfma_f32_16x16x32_bf16 v[196:199], v[192:195], v[172:175], v[196:199]
    s_waitcnt vmcnt(4)
    v_dot2_f32_bf16 v201, v178, s97, v201
    s_nop 0
    v_xor_b32 v13, s95, v179
    v_or_b32 v202, v13, v202
    v_mfma_f32_16x16x32_bf16 v[196:199], v[192:195], v[176:179], v[196:199]
    s_waitcnt vmcnt(3)
    v_dot2_f32_bf16 v201, v182, s97, v201
    v_xor_b32 v13, s95, v183
    v_or_b32 v202, v13, v202
    v_mfma_f32_16x16x32_bf16 v[196:199], v[192:195], v[180:183], v[196:199]
    s_waitcnt vmcnt(2)
    v_dot2_f32_bf16 v201, v186, s97, v201
    v_xor_b32 v13, s95, v187
    v_or_b32 v202, v13, v202
    v_mfma_f32_16x16x32_bf16 v[196:199], v[192:195], v[184:187], v[196:199]
    s_waitcnt vmcnt(1)
    v_dot2_f32_bf16 v201, v190, s97, v201
    v_xor_b32 v13, s95, v191
    v_or_b32 v202, v13, v202
    v_mfma_f32_16x16x32_bf16 v[196:199], v[192:195], v[188:191], v[196:199]
    v_cmp_ne_u32 vcc, 0, v202
    s_cbranch_vccnz .Lkvx_10
.Lkvd_11:
    s_add_u32 s71, s71, 1
    v_add_u32 v12, 1, v12
    v_mov_b32 v119, v120
    v_lshrrev_b32 v14, 5, v0
    v_lshlrev_b32 v14, 4, v14
    v_add_u32 v120, 160256, v14
    v_cvt_pk_bf16_f32 v201, v201, v201
    ds_write_b16 v203, v201
    v_cvt_pk_bf16_f32 v196, v196, v197
    v_cvt_pk_bf16_f32 v197, v198, v199
    ds_write_b64 v117, v[196:197]
    s_cmp_lg_u32 s73, 0
    s_cbranch_scc1 .Lxok_44
    s_add_u32 s92, s71, 14
    s_add_u32 s93, s92, s40
    s_waitcnt vmcnt(0)
    v_cmp_ne_u32 vcc, s93, v200
    s_cbranch_vccz .Lxok_44
.Lxpoll_45:
    buffer_load_dword v200, v3, s[4:7], s94 offen sc1
    s_waitcnt vmcnt(0)
    v_subrev_u32 v13, s92, v200
    v_cmp_le_u32 vcc, 16, v13
    s_cbranch_vccz .Lxdec_46
    s_sub_u32 s72, s72, 1
    s_cbranch_scc0 .Lxpoll_45
    s_mov_b32 s72, 0
.Lxdec_46:
    v_cmp_ne_u32 vcc, s93, v200
    s_cbranch_vccnz .Lg_s
.Lxok_44:
    s_cmp_lg_u32 s73, 0
    s_cbranch_scc1 .Lhbxc
    s_lshr_b32 s92, s2, 3
    s_and_b32 s92, s92, 7
    s_cmp_eq_u32 s92, 0
    s_cselect_b32 s93, 1, 0
    s_mov_b64 exec, 0
    s_cmp_eq_u32 s70, 1
    s_cbranch_scc1 .Lhqc_1
    s_cmp_eq_u32 s70, 2
    s_cbranch_scc1 .Lhqc_2
    s_cmp_eq_u32 s70, 3
    s_cbranch_scc1 .Lhqc_3
.Lhqc_0:
    s_cmp_eq_u32 s92, 1
    s_cbranch_scc1 .Lhsc_0_1
    s_cmp_eq_u32 s92, 2
    s_cbranch_scc1 .Lhsc_0_2
    s_cmp_eq_u32 s92, 3
    s_cbranch_scc1 .Lhsc_0_3
    s_cmp_eq_u32 s92, 4
    s_cbranch_scc1 .Lhsc_0_4
    s_cmp_eq_u32 s92, 5
    s_cbranch_scc1 .Lhsc_0_5
    s_cmp_eq_u32 s92, 6
    s_cbranch_scc1 .Lhsc_0_6
    s_cmp_eq_u32 s92, 7
    s_cbranch_scc1 .Lhsc_0_7
    s_branch .Lhsc_0_0
.Lhqc_1:
    s_cmp_eq_u32 s92, 1
    s_cbranch_scc1 .Lhsc_1_1
    s_cmp_eq_u32 s92, 2
    s_cbranch_scc1 .Lhsc_1_2
    s_cmp_eq_u32 s92, 3
    s_cbranch_scc1 .Lhsc_1_3
    s_cmp_eq_u32 s92, 4
    s_cbranch_scc1 .Lhsc_1_4
    s_cmp_eq_u32 s92, 5
    s_cbranch_scc1 .Lhsc_1_5
    s_cmp_eq_u32 s92, 6
    s_cbranch_scc1 .Lhsc_1_6
    s_cmp_eq_u32 s92, 7
    s_cbranch_scc1 .Lhsc_1_7
    s_branch .Lhsc_1_0
.Lhqc_2:
    s_cmp_eq_u32 s92, 1
    s_cbranch_scc1 .Lhsc_2_1
    s_cmp_eq_u32 s92, 2
    s_cbranch_scc1 .Lhsc_2_2
    s_cmp_eq_u32 s92, 3
    s_cbranch_scc1 .Lhsc_2_3
    s_cmp_eq_u32 s92, 4
    s_cbranch_scc1 .Lhsc_2_4
    s_cmp_eq_u32 s92, 5
    s_cbranch_scc1 .Lhsc_2_5
    s_cmp_eq_u32 s92, 6
    s_cbranch_scc1 .Lhsc_2_6
    s_cmp_eq_u32 s92, 7
    s_cbranch_scc1 .Lhsc_2_7
    s_branch .Lhsc_2_0
.Lhqc_3:
    s_cmp_eq_u32 s92, 1
    s_cbranch_scc1 .Lhsc_3_1
    s_cmp_eq_u32 s92, 2
    s_cbranch_scc1 .Lhsc_3_2
    s_cmp_eq_u32 s92, 3
    s_cbranch_scc1 .Lhsc_3_3
    s_nop 0
    s_cmp_eq_u32 s92, 4
    s_cbranch_scc1 .Lhsc_3_4
    s_cmp_eq_u32 s92, 5
    s_cbranch_scc1 .Lhsc_3_5
    s_cmp_eq_u32 s92, 6
    s_cbranch_scc1 .Lhsc_3_6
    s_cmp_eq_u32 s92, 7
    s_cbranch_scc1 .Lhsc_3_7
    s_branch .Lhsc_3_0
.Lhbrc:
    s_cmp_eq_u32 s93, 1
    s_cbranch_scc1 .Lhbdc
    s_mov_b32 s93, 1
    s_cmp_eq_u32 s70, 1
    s_cbranch_scc1 .Lhsc_1_0
    s_cmp_eq_u32 s70, 2
    s_cbranch_scc1 .Lhsc_2_0
    s_cmp_eq_u32 s70, 3
    s_cbranch_scc1 .Lhsc_3_0
    s_branch .Lhsc_0_0
.Lhbdc:
    s_mov_b64 exec, -1
.Lhbxc:
    s_waitcnt lgkmcnt(0)
    s_barrier
    ds_read_b128 v[128:131], v119 offset:0
    ds_read_b128 v[132:135], v119 offset:576
    ds_read_b128 v[136:139], v119 offset:1152
    ds_read_b128 v[140:143], v119 offset:1728
    ds_read_b128 v[144:147], v120 offset:0
    ds_read_b128 v[148:151], v120 offset:576
    ds_read_b128 v[152:155], v120 offset:1152
    ds_read_b128 v[156:159], v120 offset:1728
    v_mov_b32 v64, 0x358637bd
    v_mov_b32 v65, 0
    v_lshrrev_b32 v14, 5, v0
    v_lshl_add_u32 v117, v14, 9, v1
    s_waitcnt lgkmcnt(7)
    v_mfma_f32_32x32x16_bf16 v[48:63], v[128:131], v[16:19], 0
    s_waitcnt lgkmcnt(3)
    v_dot2_f32_bf16 v64, v16, v144, v64
    v_dot2_f32_bf16 v65, v17, v145, v65
    v_dot2_f32_bf16 v64, v18, v146, v64
    v_dot2_f32_bf16 v65, v19, v147, v65
    v_mfma_f32_32x32x16_bf16 v[48:63], v[132:135], v[20:23], v[48:63]
    s_waitcnt lgkmcnt(2)
    v_dot2_f32_bf16 v64, v20, v148, v64
    v_dot2_f32_bf16 v65, v21, v149, v65
    v_dot2_f32_bf16 v64, v22, v150, v64
    v_dot2_f32_bf16 v65, v23, v151, v65
    v_mfma_f32_32x32x16_bf16 v[48:63], v[136:139], v[32:35], v[48:63]
    s_waitcnt lgkmcnt(1)
    v_dot2_f32_bf16 v64, v32, v152, v64
    v_dot2_f32_bf16 v65, v33, v153, v65
    v_dot2_f32_bf16 v64, v34, v154, v64
    v_dot2_f32_bf16 v65, v35, v155, v65
    v_mfma_f32_32x32x16_bf16 v[48:63], v[140:143], v[36:39], v[48:63]
    s_waitcnt lgkmcnt(0)
    v_dot2_f32_bf16 v64, v36, v156, v64
    v_dot2_f32_bf16 v65, v37, v157, v65
    v_dot2_f32_bf16 v64, v38, v158, v64
    v_dot2_f32_bf16 v65, v39, v159, v65
    s_nop 2
    v_add_f32 v64, v64, v65
    v_rcp_f32 v64, v64
    s_nop 1
    v_pk_mul_f32 v[48:49], v[64:65], v[48:49] op_sel:[0,0] op_sel_hi:[0,1]
    v_pk_mul_f32 v[50:51], v[64:65], v[50:51] op_sel:[0,0] op_sel_hi:[0,1]
    v_pk_mul_f32 v[52:53], v[64:65], v[52:53] op_sel:[0,0] op_sel_hi:[0,1]
    v_pk_mul_f32 v[54:55], v[64:65], v[54:55] op_sel:[0,0] op_sel_hi:[0,1]
    v_pk_mul_f32 v[56:57], v[64:65], v[56:57] op_sel:[0,0] op_sel_hi:[0,1]
    v_pk_mul_f32 v[58:59], v[64:65], v[58:59] op_sel:[0,0] op_sel_hi:[0,1]
    v_pk_mul_f32 v[60:61], v[64:65], v[60:61] op_sel:[0,0] op_sel_hi:[0,1]
    v_pk_mul_f32 v[62:63], v[64:65], v[62:63] op_sel:[0,0] op_sel_hi:[0,1]
    v_cvt_pk_bf16_f32 v48, v48, v49
    v_cvt_pk_bf16_f32 v49, v50, v51
    v_cvt_pk_bf16_f32 v50, v52, v53
    v_cvt_pk_bf16_f32 v51, v54, v55
    v_cvt_pk_bf16_f32 v52, v56, v57
    v_cvt_pk_bf16_f32 v53, v58, v59
    v_cvt_pk_bf16_f32 v54, v60, v61
    v_cvt_pk_bf16_f32 v55, v62, v63
    buffer_store_dwordx4 v[48:51], v117, s[4:7], s80 offen
.Lhsc_0_0:
.Lhp_26:
    s_cbranch_execz .Lhp_27
    buffer_store_dwordx4 v[52:55], v117, s[4:7], s80 offen offset:512
    s_add_u32 s44, s44, 32768
    s_and_b32 s44, s44, 131071
    v_add_u32 v2, s44, v123
    v_xor_b32 v121, 64, v2
    v_lshlrev_b32 v16, 16, v4
    v_and_b32 v17, 4294901760, v4
    v_lshlrev_b32 v18, 16, v5
    v_and_b32 v19, 4294901760, v5
    v_lshlrev_b32 v20, 16, v6
    v_and_b32 v21, 4294901760, v6
    v_lshlrev_b32 v22, 16, v7
    v_and_b32 v23, 4294901760, v7
    v_lshlrev_b32 v24, 16, v8
    v_and_b32 v25, 4294901760, v8
    v_lshlrev_b32 v26, 16, v9
    v_and_b32 v27, 4294901760, v9
    v_lshlrev_b32 v28, 16, v10
    v_and_b32 v29, 4294901760, v10
    v_lshlrev_b32 v30, 16, v11
    v_and_b32 v31, 4294901760, v11
    s_lshl_b32 s92, s70, 12
    s_add_u32 s92, s92, 131072
    v_add_u32 v126, s92, v1
    s_waitcnt vmcnt(0)
    buffer_store_dword v12, off, s[4:7], s82 offset:128
    s_add_u32 s88, s88, 786432
    s_add_u32 s89, s89, 786432
.Lpoll_47:
    buffer_load_dword v13, v3, s[4:7], s81 offen offset:128 sc1
    s_waitcnt vmcnt(0)
    v_cmp_ne_u32 vcc, s71, v13
    s_cbranch_vccz .Lpdone_48
    s_sub_u32 s72, s72, 1
    s_cbranch_scc0 .Lpoll_47
    s_mov_b32 s72, 0
.Lpdone_48:
    s_add_u32 s48, s84, 0
    buffer_load_dwordx4 v[128:131], v1, s[4:7], s48 offen offset:0 sc1
    buffer_load_dwordx4 v[132:135], v1, s[4:7], s48 offen offset:2048 sc1
    s_add_u32 s48, s84, 4096
    buffer_load_dwordx4 v[136:139], v1, s[4:7], s48 offen offset:0 sc1
    buffer_load_dwordx4 v[140:143], v1, s[4:7], s48 offen offset:2048 sc1
    s_add_u32 s48, s84, 8192
    buffer_load_dwordx4 v[144:147], v1, s[4:7], s48 offen offset:0 sc1
    buffer_load_dwordx4 v[148:151], v1, s[4:7], s48 offen offset:2048 sc1
    s_add_u32 s48, s84, 12288
    buffer_load_dwordx4 v[152:155], v1, s[4:7], s48 offen offset:0 sc1
    buffer_load_dwordx4 v[156:159], v1, s[4:7], s48 offen offset:2048 sc1
    s_add_u32 s48, s84, 16384
    buffer_load_dwordx4 v[160:163], v1, s[4:7], s48 offen offset:0 sc1
    buffer_load_dwordx4 v[164:167], v1, s[4:7], s48 offen offset:2048 sc1
    ds_read_b64_tr_b16 v[48:49], v2 offset:0
    ds_read_b64_tr_b16 v[50:51], v2 offset:512
    ds_read_b64_tr_b16 v[52:53], v121 offset:0
    ds_read_b64_tr_b16 v[54:55], v121 offset:512
    ds_read_b64_tr_b16 v[56:57], v2 offset:4096
    ds_read_b64_tr_b16 v[58:59], v2 offset:4608
    ds_read_b64_tr_b16 v[60:61], v121 offset:4096
    ds_read_b64_tr_b16 v[62:63], v121 offset:4608
    ds_read_b64_tr_b16 v[64:65], v2 offset:8192
    ds_read_b64_tr_b16 v[66:67], v2 offset:8704
    s_waitcnt vmcnt(9) lgkmcnt(8)
    v_mfma_f32_32x32x16_bf16 v[16:31], v[48:51], v[128:131], v[16:31]
    ds_read_b64_tr_b16 v[68:69], v121 offset:8192
    ds_read_b64_tr_b16 v[70:71], v121 offset:8704
    s_add_u32 s71, s71, 1
    v_add_u32 v12, 1, v12
    s_waitcnt lgkmcnt(8)
    v_mfma_f32_32x32x16_bf16 v[32:47], v[52:55], v[128:131], 0
    ds_read_b64_tr_b16 v[48:49], v2 offset:12288
    ds_read_b64_tr_b16 v[50:51], v2 offset:12800
    s_add_u32 s48, s84, 20480
    buffer_load_dwordx4 v[168:171], v1, s[4:7], s48 offen offset:0 sc1
    s_waitcnt vmcnt(9) lgkmcnt(8)
    v_mfma_f32_32x32x16_bf16 v[16:31], v[56:59], v[132:135], v[16:31]
    ds_read_b64_tr_b16 v[52:53], v121 offset:12288
    ds_read_b64_tr_b16 v[54:55], v121 offset:12800
.Lhsc_0_1:
.Lhp_27:
    s_cbranch_execz .Lhp_28
    s_waitcnt lgkmcnt(8)
    v_mfma_f32_32x32x16_bf16 v[32:47], v[60:63], v[132:135], v[32:47]
    ds_read_b64_tr_b16 v[56:57], v2 offset:16384
    ds_read_b64_tr_b16 v[58:59], v2 offset:16896
    buffer_load_dwordx4 v[172:175], v1, s[4:7], s48 offen offset:2048 sc1
    s_waitcnt vmcnt(9) lgkmcnt(8)
    v_mfma_f32_32x32x16_bf16 v[16:31], v[64:67], v[136:139], v[16:31]
    ds_read_b64_tr_b16 v[60:61], v121 offset:16384
    ds_read_b64_tr_b16 v[62:63], v121 offset:16896
    s_waitcnt lgkmcnt(8)
    v_mfma_f32_32x32x16_bf16 v[32:47], v[68:71], v[136:139], v[32:47]
    ds_read_b64_tr_b16 v[64:65], v2 offset:20480
    ds_read_b64_tr_b16 v[66:67], v2 offset:20992
    s_add_u32 s48, s84, 24576
    buffer_load_dwordx4 v[176:179], v1, s[4:7], s48 offen offset:0 sc1
    s_waitcnt vmcnt(9) lgkmcnt(8)
    v_mfma_f32_32x32x16_bf16 v[16:31], v[48:51], v[140:143], v[16:31]
    ds_read_b64_tr_b16 v[68:69], v121 offset:20480
    ds_read_b64_tr_b16 v[70:71], v121 offset:20992
    s_waitcnt lgkmcnt(8)
    v_mfma_f32_32x32x16_bf16 v[32:47], v[52:55], v[140:143], v[32:47]
    ds_read_b64_tr_b16 v[48:49], v2 offset:24576
    ds_read_b64_tr_b16 v[50:51], v2 offset:25088
    buffer_load_dwordx4 v[180:183], v1, s[4:7], s48 offen offset:2048 sc1
    s_waitcnt vmcnt(9) lgkmcnt(8)
    v_mfma_f32_32x32x16_bf16 v[16:31], v[56:59], v[144:147], v[16:31]
    ds_read_b64_tr_b16 v[52:53], v121 offset:24576
    ds_read_b64_tr_b16 v[54:55], v121 offset:25088
    s_waitcnt lgkmcnt(8)
    v_mfma_f32_32x32x16_bf16 v[32:47], v[60:63], v[144:147], v[32:47]
    ds_read_b64_tr_b16 v[56:57], v2 offset:28672
    ds_read_b64_tr_b16 v[58:59], v2 offset:29184
    s_add_u32 s48, s84, 28672
    buffer_load_dwordx4 v[184:187], v1, s[4:7], s48 offen offset:0 sc1
    s_waitcnt vmcnt(9) lgkmcnt(8)
    v_mfma_f32_32x32x16_bf16 v[16:31], v[64:67], v[148:151], v[16:31]
    ds_read_b64_tr_b16 v[60:61], v121 offset:28672
    ds_read_b64_tr_b16 v[62:63], v121 offset:29184
    s_waitcnt lgkmcnt(8)
    v_mfma_f32_32x32x16_bf16 v[32:47], v[68:71], v[148:151], v[32:47]
    s_add_u32 s44, s44, 32768
    s_and_b32 s44, s44, 131071
    v_add_u32 v2, s44, v123
    v_xor_b32 v121, 64, v2
    ds_read_b64_tr_b16 v[64:65], v2 offset:0
    ds_read_b64_tr_b16 v[66:67], v2 offset:512
    buffer_load_dwordx4 v[188:191], v1, s[4:7], s48 offen offset:2048 sc1
    s_waitcnt vmcnt(9) lgkmcnt(8)
    v_mfma_f32_32x32x16_bf16 v[16:31], v[48:51], v[152:155], v[16:31]
    s_barrier
    ds_read_b64_tr_b16 v[68:69], v121 offset:0
    ds_read_b64_tr_b16 v[70:71], v121 offset:512
    s_waitcnt lgkmcnt(8)
    v_mfma_f32_32x32x16_bf16 v[32:47], v[52:55], v[152:155], v[32:47]
    ds_read_b64_tr_b16 v[48:49], v2 offset:4096
    ds_read_b64_tr_b16 v[50:51], v2 offset:4608
    s_waitcnt vmcnt(8) lgkmcnt(8)
    v_mfma_f32_32x32x16_bf16 v[16:31], v[56:59], v[156:159], v[16:31]
    ds_read_b64_tr_b16 v[52:53], v121 offset:4096
    ds_read_b64_tr_b16 v[54:55], v121 offset:4608
    s_waitcnt lgkmcnt(8)
    v_mfma_f32_32x32x16_bf16 v[32:47], v[60:63], v[156:159], v[32:47]
    ds_read_b64_tr_b16 v[56:57], v2 offset:8192
    ds_read_b64_tr_b16 v[58:59], v2 offset:8704
    s_waitcnt vmcnt(7) lgkmcnt(8)
    v_mfma_f32_32x32x16_bf16 v[16:31], v[64:67], v[160:163], v[16:31]
    ds_read_b64_tr_b16 v[60:61], v121 offset:8192
    ds_read_b64_tr_b16 v[62:63], v121 offset:8704
    s_waitcnt lgkmcnt(8)
    v_mfma_f32_32x32x16_bf16 v[32:47], v[68:71], v[160:163], v[32:47]
    ds_read_b64_tr_b16 v[64:65], v2 offset:12288
    ds_read_b64_tr_b16 v[66:67], v2 offset:12800
    s_waitcnt vmcnt(6) lgkmcnt(8)
.Lhsc_0_2:
.Lhp_28:
    s_cbranch_execz .Lhp_29
    v_mfma_f32_32x32x16_bf16 v[16:31], v[48:51], v[164:167], v[16:31]
    ds_read_b64_tr_b16 v[68:69], v121 offset:12288
    ds_read_b64_tr_b16 v[70:71], v121 offset:12800
    s_waitcnt lgkmcnt(8)
    v_mfma_f32_32x32x16_bf16 v[32:47], v[52:55], v[164:167], v[32:47]
    ds_read_b64_tr_b16 v[48:49], v2 offset:16384
    ds_read_b64_tr_b16 v[50:51], v2 offset:16896
    s_waitcnt vmcnt(5) lgkmcnt(8)
    v_mfma_f32_32x32x16_bf16 v[16:31], v[56:59], v[168:171], v[16:31]
    ds_read_b64_tr_b16 v[52:53], v121 offset:16384
    ds_read_b64_tr_b16 v[54:55], v121 offset:16896
    s_waitcnt lgkmcnt(8)
    v_mfma_f32_32x32x16_bf16 v[32:47], v[60:63], v[168:171], v[32:47]
    ds_read_b64_tr_b16 v[56:57], v121 offset:20480
    ds_read_b64_tr_b16 v[58:59], v121 offset:20992
    s_waitcnt vmcnt(4) lgkmcnt(8)
    v_mfma_f32_32x32x16_bf16 v[16:31], v[64:67], v[172:175], v[16:31]
    ds_read_b64_tr_b16 v[60:61], v121 offset:24576
    ds_read_b64_tr_b16 v[62:63], v121 offset:25088
    s_waitcnt lgkmcnt(8)
    v_mfma_f32_32x32x16_bf16 v[32:47], v[68:71], v[172:175], v[32:47]
    ds_read_b64_tr_b16 v[64:65], v121 offset:28672
    ds_read_b64_tr_b16 v[66:67], v121 offset:29184
    s_waitcnt vmcnt(3) lgkmcnt(8)
    v_mfma_f32_32x32x16_bf16 v[16:31], v[48:51], v[176:179], v[16:31]
    ds_read_b64_tr_b16 v[68:69], v2 offset:20480
    ds_read_b64_tr_b16 v[70:71], v2 offset:20992
    s_waitcnt lgkmcnt(8)
    v_mfma_f32_32x32x16_bf16 v[32:47], v[52:55], v[176:179], v[32:47]
    ds_read_b64_tr_b16 v[48:49], v2 offset:24576
    ds_read_b64_tr_b16 v[50:51], v2 offset:25088
    s_waitcnt vmcnt(2) lgkmcnt(8)
    v_mfma_f32_32x32x16_bf16 v[32:47], v[56:59], v[180:183], v[32:47]
    ds_read_b64_tr_b16 v[52:53], v2 offset:28672
    ds_read_b64_tr_b16 v[54:55], v2 offset:29184
    s_waitcnt vmcnt(1) lgkmcnt(8)
    v_mfma_f32_32x32x16_bf16 v[32:47], v[60:63], v[184:187], v[32:47]
    s_waitcnt vmcnt(0) lgkmcnt(6)
    v_mfma_f32_32x32x16_bf16 v[32:47], v[64:67], v[188:191], v[32:47]
    s_waitcnt lgkmcnt(4)
    v_mfma_f32_32x32x16_bf16 v[16:31], v[68:71], v[180:183], v[16:31]
    s_nop 9
    ds_write_b128 v126, v[32:35] offset:0
    ds_write_b128 v126, v[36:39] offset:1024
    ds_write_b128 v126, v[40:43] offset:2048
    ds_write_b128 v126, v[44:47] offset:3072
    s_waitcnt lgkmcnt(6)
    v_mfma_f32_32x32x16_bf16 v[16:31], v[48:51], v[184:187], v[16:31]
    s_waitcnt lgkmcnt(4)
    v_mfma_f32_32x32x16_bf16 v[16:31], v[52:55], v[188:191], v[16:31]
    v_xor_b32 v126, 4096, v126
    s_waitcnt lgkmcnt(0)
    s_barrier
    ds_read_b128 v[48:51], v126 offset:0
    ds_read_b128 v[52:55], v126 offset:1024
    ds_read_b128 v[56:59], v126 offset:2048
    ds_read_b128 v[60:63], v126 offset:3072
    v_and_b32 v126, 31, v0
    v_lshlrev_b32 v126, 4, v126
    v_lshrrev_b32 v13, 5, v0
    v_lshl_add_u32 v126, v13, 2, v126
    s_waitcnt lgkmcnt(3)
    v_pk_add_f32 v[16:17], v[16:17], v[48:49] op_sel:[0,0] op_sel_hi:[1,1]
    v_pk_add_f32 v[18:19], v[18:19], v[50:51] op_sel:[0,0] op_sel_hi:[1,1]
    v_cvt_pk_bf16_f32 v4, v16, v17
    v_cvt_pk_bf16_f32 v5, v18, v19
    s_waitcnt lgkmcnt(2)
    v_pk_add_f32 v[20:21], v[20:21], v[52:53] op_sel:[0,0] op_sel_hi:[1,1]
    v_pk_add_f32 v[22:23], v[22:23], v[54:55] op_sel:[0,0] op_sel_hi:[1,1]
    v_cvt_pk_bf16_f32 v6, v20, v21
    v_cvt_pk_bf16_f32 v7, v22, v23
    s_waitcnt lgkmcnt(1)
    v_pk_add_f32 v[24:25], v[24:25], v[56:57] op_sel:[0,0] op_sel_hi:[1,1]
    v_pk_add_f32 v[26:27], v[26:27], v[58:59] op_sel:[0,0] op_sel_hi:[1,1]
    v_cvt_pk_bf16_f32 v8, v24, v25
.Lhsc_0_3:
.Lhp_29:
    s_cbranch_execz .Lhp_30
    v_cvt_pk_bf16_f32 v9, v26, v27
    s_waitcnt lgkmcnt(0)
    v_pk_add_f32 v[28:29], v[28:29], v[60:61] op_sel:[0,0] op_sel_hi:[1,1]
    v_pk_add_f32 v[30:31], v[30:31], v[62:63] op_sel:[0,0] op_sel_hi:[1,1]
    v_cvt_pk_bf16_f32 v10, v28, v29
    v_cvt_pk_bf16_f32 v11, v30, v31
    buffer_store_dwordx4 v[4:7], v1, s[4:7], s77 offen offset:0
    buffer_store_dwordx4 v[8:11], v1, s[4:7], s77 offen offset:1024
    v_dot2_f32_bf16 v16, v4, s97, 0
    v_dot2_f32_bf16 v17, v4, v4, 0
    v_dot2_f32_bf16 v18, v5, s97, 0
    v_dot2_f32_bf16 v19, v5, v5, 0
    v_dot2_f32_bf16 v16, v6, s97, v16
    v_dot2_f32_bf16 v17, v6, v6, v17
    v_dot2_f32_bf16 v18, v7, s97, v18
    v_dot2_f32_bf16 v19, v7, v7, v19
    v_dot2_f32_bf16 v16, v8, s97, v16
    v_dot2_f32_bf16 v17, v8, v8, v17
    v_dot2_f32_bf16 v18, v9, s97, v18
    v_dot2_f32_bf16 v19, v9, v9, v19
    v_dot2_f32_bf16 v16, v10, s97, v16
    v_dot2_f32_bf16 v17, v10, v10, v17
    v_dot2_f32_bf16 v18, v11, s97, v18
    v_dot2_f32_bf16 v19, v11, v11, v19
    s_nop 2
    v_pk_add_f32 v[16:17], v[16:17], v[18:19] op_sel:[0,0] op_sel_hi:[1,1]
    s_nop 1
    v_permlane32_swap_b32 v16, v17
    v_add_f32 v16, v16, v17
    buffer_store_dword v16, v126, s[4:7], s78 offen
    v_and_b32 v14, 31, v0
    v_lshlrev_b32 v120, 2, v14
    v_add_u32 v120, 162432, v120
    s_add_u32 s44, s44, 32768
    s_and_b32 s44, s44, 131071
    v_add_u32 v2, s44, v1
    v_lshrrev_b32 v15, 5, v0
    v_lshlrev_b32 v15, 11, v15
    v_and_b32 v14, 31, v0
    v_lshl_add_u32 v15, v14, 4, v15
    s_add_u32 s92, s44, 65536
    s_and_b32 s92, s92, 131071
    v_add_u32 v121, s92, v1
    s_lshl_b32 s92, s70, 12
    s_add_u32 s92, s92, 131072
    v_add_u32 v126, s92, v1
    s_waitcnt vmcnt(0)
    buffer_store_dword v12, off, s[4:7], s79
.Lpoll_50:
    buffer_load_dword v13, v3, s[4:7], s76 offen offset:0 sc1
    s_waitcnt vmcnt(0)
    v_cmp_ne_u32 vcc, s71, v13
    s_cbranch_vccz .Lpdone_51
    s_sub_u32 s72, s72, 1
    s_cbranch_scc0 .Lpoll_50
    s_mov_b32 s72, 0
.Lpdone_51:
    s_xor_b32 s48, s91, 0
    buffer_load_dwordx4 v[128:131], v1, s[4:7], s48 offen offset:0 sc1
    buffer_load_dwordx4 v[132:135], v1, s[4:7], s48 offen offset:1024 sc1
    buffer_load_dwordx4 v[136:139], v1, s[4:7], s48 offen offset:2048 sc1
    buffer_load_dwordx4 v[140:143], v1, s[4:7], s48 offen offset:3072 sc1
    s_xor_b32 s48, s91, 4096
    buffer_load_dwordx4 v[144:147], v1, s[4:7], s48 offen offset:0 sc1
    buffer_load_dwordx4 v[148:151], v1, s[4:7], s48 offen offset:1024 sc1
    buffer_load_dwordx4 v[152:155], v1, s[4:7], s48 offen offset:2048 sc1
    buffer_load_dwordx4 v[156:159], v1, s[4:7], s48 offen offset:3072 sc1
    s_xor_b32 s48, s91, 8192
    buffer_load_dwordx4 v[160:163], v1, s[4:7], s48 offen offset:0 sc1
    buffer_load_dwordx4 v[164:167], v1, s[4:7], s48 offen offset:1024 sc1
    s_add_u32 s71, s71, 1
    v_add_u32 v12, 1, v12
    s_barrier
    ds_read_b128 v[64:67], v2 offset:0
    ds_read_b128 v[68:71], v2 offset:16384
    ds_read_b128 v[72:75], v2 offset:1024
    ds_read_b128 v[76:79], v2 offset:17408
    ds_read_b128 v[80:83], v2 offset:2048
.Lhsc_0_4:
.Lhp_30:
    s_cbranch_execz .Lhp_31
    s_waitcnt vmcnt(9) lgkmcnt(3)
    v_mfma_f32_32x32x16_bf16 v[16:31], v[64:67], v[128:131], 0
    ds_read_b128 v[84:87], v2 offset:18432
    v_mfma_f32_32x32x16_bf16 v[32:47], v[68:71], v[128:131], 0
    buffer_load_dwordx4 v[168:171], v1, s[4:7], s48 offen offset:2048 sc1
    ds_read_b128 v[64:67], v2 offset:3072
    s_waitcnt vmcnt(9) lgkmcnt(3)
    v_mfma_f32_32x32x16_bf16 v[16:31], v[72:75], v[132:135], v[16:31]
    ds_read_b128 v[68:71], v2 offset:19456
    v_mov_b32 v89, 0
    v_mov_b32 v90, 0
    v_mov_b32 v91, 0
    v_min_u32 v124, 20, v3
    v_mfma_f32_32x32x16_bf16 v[32:47], v[76:79], v[132:135], v[32:47]
    buffer_load_dwordx4 v[172:175], v1, s[4:7], s48 offen offset:3072 sc1
    ds_read_b128 v[72:75], v121 offset:0
    s_waitcnt vmcnt(9) lgkmcnt(3)
    v_mfma_f32_32x32x16_bf16 v[16:31], v[80:83], v[136:139], v[16:31]
    ds_read_b128 v[76:79], v2 offset:4096
    v_mfma_f32_32x32x16_bf16 v[32:47], v[84:87], v[136:139], v[32:47]
    s_xor_b32 s48, s91, 12288
    buffer_load_dwordx4 v[176:179], v1, s[4:7], s48 offen offset:0 sc1
    ds_read_b128 v[80:83], v2 offset:20480
    s_waitcnt vmcnt(9) lgkmcnt(3)
    v_mfma_f32_32x32x16_bf16 v[16:31], v[64:67], v[140:143], v[16:31]
    ds_read_b128 v[84:87], v2 offset:5120
    v_mfma_f32_32x32x16_bf16 v[32:47], v[68:71], v[140:143], v[32:47]
    buffer_load_dwordx4 v[180:183], v1, s[4:7], s48 offen offset:1024 sc1
    ds_read_b128 v[64:67], v2 offset:21504
    s_waitcnt lgkmcnt(3)
    v_mfma_f32_32x32x16_bf16 v[48:63], v[72:75], v[128:131], 0
    ds_read_b128 v[68:71], v2 offset:6144
    s_waitcnt vmcnt(9)
    v_mfma_f32_32x32x16_bf16 v[16:31], v[76:79], v[144:147], v[16:31]
    buffer_load_dwordx4 v[184:187], v1, s[4:7], s48 offen offset:2048 sc1
    ds_read_b128 v[72:75], v2 offset:22528
    s_waitcnt lgkmcnt(3)
    v_mfma_f32_32x32x16_bf16 v[32:47], v[80:83], v[144:147], v[32:47]
    ds_read_b128 v[76:79], v121 offset:1024
    s_waitcnt vmcnt(9)
    v_mfma_f32_32x32x16_bf16 v[16:31], v[84:87], v[148:151], v[16:31]
    buffer_load_dwordx4 v[188:191], v1, s[4:7], s48 offen offset:3072 sc1
    ds_read_b128 v[80:83], v2 offset:7168
    s_waitcnt lgkmcnt(3)
    v_mfma_f32_32x32x16_bf16 v[32:47], v[64:67], v[148:151], v[32:47]
    ds_read_b128 v[84:87], v2 offset:23552
    s_waitcnt vmcnt(9)
    v_mfma_f32_32x32x16_bf16 v[16:31], v[68:71], v[152:155], v[16:31]
    s_xor_b32 s48, s91, 16384
    buffer_load_dwordx4 v[192:195], v1, s[4:7], s48 offen offset:0 sc1
    ds_read_b128 v[64:67], v2 offset:8192
    s_waitcnt lgkmcnt(3)
    v_mfma_f32_32x32x16_bf16 v[32:47], v[72:75], v[152:155], v[32:47]
    ds_read_b128 v[68:71], v2 offset:24576
    v_mfma_f32_32x32x16_bf16 v[48:63], v[76:79], v[132:135], v[48:63]
    buffer_load_dwordx4 v[196:199], v1, s[4:7], s48 offen offset:1024 sc1
    ds_read_b128 v[72:75], v2 offset:9216
    s_waitcnt vmcnt(10) lgkmcnt(3)
    v_mfma_f32_32x32x16_bf16 v[16:31], v[80:83], v[156:159], v[16:31]
    ds_read_b128 v[76:79], v2 offset:25600
    v_mfma_f32_32x32x16_bf16 v[32:47], v[84:87], v[156:159], v[32:47]
    buffer_load_dwordx4 v[200:203], v1, s[4:7], s48 offen offset:2048 sc1
    ds_read_b128 v[80:83], v121 offset:2048
    s_waitcnt vmcnt(10) lgkmcnt(3)
    v_mfma_f32_32x32x16_bf16 v[16:31], v[64:67], v[160:163], v[16:31]
    ds_read_b128 v[84:87], v2 offset:10240
    v_mfma_f32_32x32x16_bf16 v[32:47], v[68:71], v[160:163], v[32:47]
    buffer_load_dwordx4 v[204:207], v1, s[4:7], s48 offen offset:3072 sc1
    ds_read_b128 v[64:67], v2 offset:26624
    s_waitcnt vmcnt(10) lgkmcnt(3)
    v_mfma_f32_32x32x16_bf16 v[16:31], v[72:75], v[164:167], v[16:31]
    ds_read_b128 v[68:71], v2 offset:11264
.Lhsc_0_5:
.Lhp_31:
    s_cbranch_execz .Lhp_32
    v_mfma_f32_32x32x16_bf16 v[32:47], v[76:79], v[164:167], v[32:47]
    buffer_load_dwordx4 v[96:99], v15, s[4:7], s75 offen offset:0 sc1
    buffer_load_dwordx4 v[100:103], v15, s[4:7], s75 offen offset:512 sc1
    buffer_load_dwordx4 v[104:107], v15, s[4:7], s75 offen offset:1024 sc1
    buffer_load_dwordx4 v[108:111], v15, s[4:7], s75 offen offset:1536 sc1
    ds_read_b128 v[72:75], v2 offset:27648
    s_waitcnt lgkmcnt(3)
    v_mfma_f32_32x32x16_bf16 v[48:63], v[80:83], v[136:139], v[48:63]
    ds_read_b128 v[76:79], v2 offset:12288
    s_waitcnt vmcnt(13)
    v_mfma_f32_32x32x16_bf16 v[16:31], v[84:87], v[168:171], v[16:31]
    s_xor_b32 s48, s91, 20480
    buffer_load_dwordx4 v[208:211], v1, s[4:7], s48 offen offset:0 sc1
    ds_read_b128 v[80:83], v2 offset:28672
    s_waitcnt lgkmcnt(3)
    v_mfma_f32_32x32x16_bf16 v[32:47], v[64:67], v[168:171], v[32:47]
    ds_read_b128 v[84:87], v121 offset:3072
    s_waitcnt vmcnt(13)
    v_mfma_f32_32x32x16_bf16 v[16:31], v[68:71], v[172:175], v[16:31]
    buffer_load_dwordx4 v[212:215], v1, s[4:7], s48 offen offset:1024 sc1
    ds_read_b128 v[64:67], v2 offset:13312
    s_waitcnt lgkmcnt(3)
    v_mfma_f32_32x32x16_bf16 v[32:47], v[72:75], v[172:175], v[32:47]
    ds_read_b128 v[68:71], v2 offset:29696
    s_waitcnt vmcnt(13)
    v_mfma_f32_32x32x16_bf16 v[16:31], v[76:79], v[176:179], v[16:31]
    buffer_load_dwordx4 v[216:219], v1, s[4:7], s48 offen offset:2048 sc1
    ds_read_b128 v[72:75], v2 offset:14336
    s_waitcnt lgkmcnt(3)
    v_mfma_f32_32x32x16_bf16 v[32:47], v[80:83], v[176:179], v[32:47]
    ds_read_b128 v[76:79], v2 offset:30720
    v_mfma_f32_32x32x16_bf16 v[48:63], v[84:87], v[140:143], v[48:63]
    buffer_load_dwordx4 v[220:223], v1, s[4:7], s48 offen offset:3072 sc1
    ds_read_b128 v[80:83], v2 offset:15360
    s_waitcnt vmcnt(14) lgkmcnt(3)
    v_mfma_f32_32x32x16_bf16 v[16:31], v[64:67], v[180:183], v[16:31]
    ds_read_b128 v[84:87], v2 offset:31744
    v_mfma_f32_32x32x16_bf16 v[32:47], v[68:71], v[180:183], v[32:47]
    s_xor_b32 s48, s91, 24576
    buffer_load_dwordx4 v[224:227], v1, s[4:7], s48 offen offset:0 sc1
    ds_read_b128 v[64:67], v121 offset:4096
    s_waitcnt vmcnt(14) lgkmcnt(3)
    v_mfma_f32_32x32x16_bf16 v[16:31], v[72:75], v[184:187], v[16:31]
    s_add_u32 s44, s44, 32768
    s_and_b32 s44, s44, 131071
    v_add_u32 v2, s44, v1
    ds_read_b128 v[68:71], v2 offset:0
    v_mfma_f32_32x32x16_bf16 v[32:47], v[76:79], v[184:187], v[32:47]
    buffer_load_dwordx4 v[228:231], v1, s[4:7], s48 offen offset:1024 sc1
    ds_read_b128 v[72:75], v2 offset:16384
    s_waitcnt vmcnt(14) lgkmcnt(3)
    v_mfma_f32_32x32x16_bf16 v[16:31], v[80:83], v[188:191], v[16:31]
    ds_read_b128 v[76:79], v2 offset:1024
    v_mfma_f32_32x32x16_bf16 v[32:47], v[84:87], v[188:191], v[32:47]
    buffer_load_dwordx4 v[232:235], v1, s[4:7], s48 offen offset:2048 sc1
    ds_read_b128 v[80:83], v2 offset:17408
    s_waitcnt lgkmcnt(3)
    v_mfma_f32_32x32x16_bf16 v[48:63], v[64:67], v[144:147], v[48:63]
    ds_read_b128 v[84:87], v2 offset:2048
    s_waitcnt vmcnt(14)
    v_mfma_f32_32x32x16_bf16 v[16:31], v[68:71], v[192:195], v[16:31]
    buffer_load_dwordx4 v[236:239], v1, s[4:7], s48 offen offset:3072 sc1
    ds_read_b128 v[64:67], v2 offset:18432
    s_waitcnt lgkmcnt(3)
    v_mfma_f32_32x32x16_bf16 v[32:47], v[72:75], v[192:195], v[32:47]
    ds_read_b128 v[68:71], v2 offset:3072
    s_waitcnt vmcnt(14)
    v_mfma_f32_32x32x16_bf16 v[16:31], v[76:79], v[196:199], v[16:31]
    s_xor_b32 s48, s91, 28672
    buffer_load_dwordx4 v[240:243], v1, s[4:7], s48 offen offset:0 sc1
    s_barrier
    ds_read_b128 v[72:75], v2 offset:19456
.Lhsc_0_6:
.Lhp_32:
    s_cbranch_execz .Lhp_33
    s_waitcnt lgkmcnt(3)
    v_mfma_f32_32x32x16_bf16 v[32:47], v[80:83], v[196:199], v[32:47]
    ds_read_b128 v[76:79], v121 offset:5120
    s_waitcnt vmcnt(14)
    v_mfma_f32_32x32x16_bf16 v[16:31], v[84:87], v[200:203], v[16:31]
    buffer_load_dwordx4 v[244:247], v1, s[4:7], s48 offen offset:1024 sc1
    ds_read_b128 v[80:83], v2 offset:4096
    s_waitcnt lgkmcnt(3)
    v_mfma_f32_32x32x16_bf16 v[32:47], v[64:67], v[200:203], v[32:47]
    ds_read_b128 v[84:87], v2 offset:20480
    s_waitcnt vmcnt(14)
    v_mfma_f32_32x32x16_bf16 v[16:31], v[68:71], v[204:207], v[16:31]
    buffer_load_dwordx4 v[248:251], v1, s[4:7], s48 offen offset:2048 sc1
    ds_read_b128 v[64:67], v2 offset:5120
    s_waitcnt lgkmcnt(3)
    v_mfma_f32_32x32x16_bf16 v[32:47], v[72:75], v[204:207], v[32:47]
    ds_read_b128 v[68:71], v2 offset:21504
    v_mfma_f32_32x32x16_bf16 v[48:63], v[76:79], v[148:151], v[48:63]
    buffer_load_dwordx4 v[252:255], v1, s[4:7], s48 offen offset:3072 sc1
    ds_read_b128 v[72:75], v2 offset:6144
    s_waitcnt vmcnt(11) lgkmcnt(3)
    v_mfma_f32_32x32x16_bf16 v[16:31], v[80:83], v[208:211], v[16:31]
    ds_read_b128 v[76:79], v2 offset:22528
    v_mfma_f32_32x32x16_bf16 v[32:47], v[84:87], v[208:211], v[32:47]
    ds_read_b128 v[80:83], v121 offset:6144
    s_waitcnt vmcnt(10) lgkmcnt(3)
    v_mfma_f32_32x32x16_bf16 v[16:31], v[64:67], v[212:215], v[16:31]
    ds_read_b128 v[84:87], v2 offset:7168
    v_mfma_f32_32x32x16_bf16 v[32:47], v[68:71], v[212:215], v[32:47]
    ds_read_b128 v[64:67], v2 offset:23552
    s_waitcnt vmcnt(9) lgkmcnt(3)
    v_mfma_f32_32x32x16_bf16 v[16:31], v[72:75], v[216:219], v[16:31]
    ds_read_b128 v[68:71], v2 offset:8192
    v_add_f32 v96, v96, v100
    v_add_f32 v97, v97, v101
    v_add_f32 v98, v98, v102
    v_add_f32 v99, v99, v103
    v_add_f32 v104, v104, v108
    v_mfma_f32_32x32x16_bf16 v[32:47], v[76:79], v[216:219], v[32:47]
    ds_read_b128 v[72:75], v2 offset:24576
    v_add_f32 v105, v105, v109
    v_add_f32 v106, v106, v110
    v_add_f32 v107, v107, v111
    v_add_f32 v96, v96, v104
    s_waitcnt lgkmcnt(3)
    v_mfma_f32_32x32x16_bf16 v[48:63], v[80:83], v[152:155], v[48:63]
    ds_read_b128 v[76:79], v2 offset:9216
    v_add_f32 v97, v97, v105
    v_add_f32 v98, v98, v106
    v_add_f32 v99, v99, v107
    v_add_f32 v96, v96, v98
    v_add_f32 v97, v97, v99
    s_waitcnt vmcnt(8)
    v_mfma_f32_32x32x16_bf16 v[16:31], v[84:87], v[220:223], v[16:31]
    ds_read_b128 v[80:83], v2 offset:25600
    v_mov_b32 v98, v96
    v_mov_b32 v99, v97
    s_nop 0
    v_permlane32_swap_b32 v96, v98
    v_permlane32_swap_b32 v97, v99
    s_waitcnt lgkmcnt(3)
    v_mfma_f32_32x32x16_bf16 v[32:47], v[64:67], v[220:223], v[32:47]
    ds_read_b128 v[84:87], v121 offset:7168
    v_add_f32 v96, v96, v98
    v_add_f32 v97, v97, v99
    v_mul_f32 v95, 0xbb000000, v96
    v_mul_f32 v97, 0x3b000000, v97
    v_fma_f32 v94, -v95, v95, v97
    s_waitcnt vmcnt(7)
    v_mfma_f32_32x32x16_bf16 v[16:31], v[68:71], v[224:227], v[16:31]
    ds_read_b128 v[64:67], v2 offset:10240
    v_max_f32 v94, 0, v94
    v_add_f32 v94, 0x3727c5ac, v94
    v_rsq_f32 v92, v94
    s_waitcnt lgkmcnt(3)
    v_mfma_f32_32x32x16_bf16 v[32:47], v[72:75], v[224:227], v[32:47]
    ds_read_b128 v[68:71], v2 offset:26624
    v_and_b32 v14, 4294901760, v95
    v_sub_f32 v95, v95, v14
    v_cndmask_b32 v14, v14, v95, s[60:61]
    v_cvt_pk_bf16_f32 v88, v14, v14
    v_mul_f32 v93, v92, v92
.Lhsc_0_7:
.Lhp_33:
    s_cbranch_execz .Lhp_34
    s_waitcnt vmcnt(6)
    v_mfma_f32_32x32x16_bf16 v[16:31], v[76:79], v[228:231], v[16:31]
    ds_read_b128 v[72:75], v2 offset:11264
    v_mul_f32 v92, 0xc0135761, v92
    v_mul_f32 v93, 0x3d372713, v93
    v_mul_f32 v93, v93, v92
    s_waitcnt lgkmcnt(3)
    v_mfma_f32_32x32x16_bf16 v[32:47], v[80:83], v[228:231], v[32:47]
    ds_read_b128 v[76:79], v2 offset:27648
    v_mfma_f32_32x32x16_bf16 v[48:63], v[84:87], v[156:159], v[48:63]
    ds_read_b128 v[80:83], v2 offset:12288
    s_waitcnt vmcnt(5) lgkmcnt(3)
    v_mfma_f32_32x32x16_bf16 v[16:31], v[64:67], v[232:235], v[16:31]
    ds_read_b128 v[84:87], v2 offset:28672
    v_mfma_f32_32x32x16_bf16 v[32:47], v[68:71], v[232:235], v[32:47]
    ds_read_b128 v[64:67], v121 offset:8192
    s_waitcnt vmcnt(4) lgkmcnt(3)
    v_mfma_f32_32x32x16_bf16 v[16:31], v[72:75], v[236:239], v[16:31]
    ds_read_b128 v[68:71], v2 offset:13312
    v_mfma_f32_32x32x16_bf16 v[32:47], v[76:79], v[236:239], v[32:47]
    ds_read_b128 v[72:75], v2 offset:29696
    s_waitcnt vmcnt(3) lgkmcnt(3)
    v_mfma_f32_32x32x16_bf16 v[16:31], v[80:83], v[240:243], v[16:31]
    ds_read_b128 v[76:79], v2 offset:14336
    v_mfma_f32_32x32x16_bf16 v[32:47], v[84:87], v[240:243], v[32:47]
    ds_read_b128 v[80:83], v2 offset:30720
    s_waitcnt lgkmcnt(3)
    v_mfma_f32_32x32x16_bf16 v[48:63], v[64:67], v[160:163], v[48:63]
    ds_read_b128 v[84:87], v2 offset:15360
    s_waitcnt vmcnt(2)
    v_mfma_f32_32x32x16_bf16 v[16:31], v[68:71], v[244:247], v[16:31]
    ds_read_b128 v[64:67], v2 offset:31744
    s_waitcnt lgkmcnt(3)
    v_mfma_f32_32x32x16_bf16 v[32:47], v[72:75], v[244:247], v[32:47]
    ds_read_b128 v[68:71], v121 offset:9216
    s_waitcnt vmcnt(1)
    v_mfma_f32_32x32x16_bf16 v[16:31], v[76:79], v[248:251], v[16:31]
    ds_read_b32 v72, v120 offset:0
    s_waitcnt lgkmcnt(3)
    v_mfma_f32_32x32x16_bf16 v[32:47], v[80:83], v[248:251], v[32:47]
    ds_read_b32 v76, v120 offset:128
    s_waitcnt vmcnt(0)
    v_mfma_f32_32x32x16_bf16 v[16:31], v[84:87], v[252:255], v[16:31]
    ds_read_b128 v[80:83], v121 offset:10240
    s_waitcnt lgkmcnt(3)
    v_mfma_f32_32x32x16_bf16 v[32:47], v[64:67], v[252:255], v[32:47]
    ds_read_b128 v[84:87], v121 offset:11264
    v_mfma_f32_32x32x16_bf16 v[48:63], v[68:71], v[164:167], v[48:63]
    ds_read_b128 v[64:67], v121 offset:12288
    s_waitcnt lgkmcnt(3)
    v_mfma_f32_32x32x16_bf16 v[16:31], v[72:75], v[88:91], v[16:31]
    ds_read_b128 v[68:71], v121 offset:13312
    v_mfma_f32_32x32x16_bf16 v[32:47], v[76:79], v[88:91], v[32:47]
    s_barrier
    ds_read_b128 v[72:75], v121 offset:14336
    s_waitcnt lgkmcnt(3)
    v_mfma_f32_32x32x16_bf16 v[48:63], v[80:83], v[168:171], v[48:63]
    ds_read_b128 v[76:79], v121 offset:15360
    v_mfma_f32_32x32x16_bf16 v[48:63], v[84:87], v[172:175], v[48:63]
    ds_read_b128 v[80:83], v121 offset:16384
    s_waitcnt lgkmcnt(3)
    v_mfma_f32_32x32x16_bf16 v[48:63], v[64:67], v[176:179], v[48:63]
    ds_read_b128 v[84:87], v121 offset:17408
    v_mul_f32 v112, v16, v16
    v_mul_f32 v24, v16, v24
    v_mul_f32 v113, v17, v17
    v_fma_f32 v112, v112, v93, v92
    v_mul_f32 v25, v17, v25
    v_mfma_f32_32x32x16_bf16 v[48:63], v[68:71], v[180:183], v[48:63]
    ds_read_b128 v[64:67], v121 offset:18432
    v_mul_f32 v114, v18, v18
    v_fma_f32 v113, v113, v93, v92
    v_mul_f32 v26, v18, v26
    v_mul_f32 v16, v112, v16
    s_waitcnt lgkmcnt(3)
    v_mfma_f32_32x32x16_bf16 v[48:63], v[72:75], v[184:187], v[48:63]
.Lhp_34:
    s_cbranch_execz .Lhbrc
    ds_read_b128 v[68:71], v121 offset:19456
    v_exp_f32 v16, v16
    v_mul_f32 v115, v19, v19
    v_fma_f32 v114, v114, v93, v92
    v_mul_f32 v27, v19, v27
    v_mfma_f32_32x32x16_bf16 v[48:63], v[76:79], v[188:191], v[48:63]
    ds_read_b128 v[72:75], v121 offset:20480
    v_mul_f32 v17, v113, v17
    v_exp_f32 v17, v17
    v_mul_f32 v112, v20, v20
    s_waitcnt lgkmcnt(3)
    v_mfma_f32_32x32x16_bf16 v[48:63], v[80:83], v[192:195], v[48:63]
    ds_read_b128 v[76:79], v121 offset:21504
    v_fma_f32 v115, v115, v93, v92
    v_mul_f32 v28, v20, v28
    v_mul_f32 v18, v114, v18
    v_fma_f32 v16, v16, v94, v94
    v_mfma_f32_32x32x16_bf16 v[48:63], v[84:87], v[196:199], v[48:63]
    ds_read_b128 v[80:83], v121 offset:22528
    v_exp_f32 v18, v18
    v_mul_f32 v113, v21, v21
    v_fma_f32 v112, v112, v93, v92
    v_mul_f32 v29, v21, v29
    s_waitcnt lgkmcnt(3)
    v_mfma_f32_32x32x16_bf16 v[48:63], v[64:67], v[200:203], v[48:63]
    ds_read_b128 v[84:87], v121 offset:23552
    v_rcp_f32 v16, v16
    v_mul_f32 v19, v115, v19
    v_fma_f32 v17, v17, v94, v94
    v_mfma_f32_32x32x16_bf16 v[48:63], v[68:71], v[204:207], v[48:63]
    ds_read_b128 v[64:67], v121 offset:24576
    v_exp_f32 v19, v19
    v_mul_f32 v114, v22, v22
    v_fma_f32 v113, v113, v93, v92
    v_mul_f32 v30, v22, v30
    s_waitcnt lgkmcnt(3)
    v_mfma_f32_32x32x16_bf16 v[48:63], v[72:75], v[208:211], v[48:63]
    ds_read_b128 v[68:71], v121 offset:25600
    v_rcp_f32 v17, v17
    v_mul_f32 v20, v112, v20
    v_fma_f32 v18, v18, v94, v94
    v_mul_f32 v16, v16, v24
    v_mfma_f32_32x32x16_bf16 v[48:63], v[76:79], v[212:215], v[48:63]
    ds_read_b128 v[72:75], v121 offset:26624
    v_exp_f32 v20, v20
    v_mul_f32 v115, v23, v23
    v_fma_f32 v114, v114, v93, v92
    s_waitcnt lgkmcnt(3)
    v_mfma_f32_32x32x16_bf16 v[48:63], v[80:83], v[216:219], v[48:63]
    ds_read_b128 v[76:79], v121 offset:27648
    v_mul_f32 v31, v23, v31
    v_rcp_f32 v18, v18
    v_mul_f32 v21, v113, v21
    v_fma_f32 v19, v19, v94, v94
    v_mfma_f32_32x32x16_bf16 v[48:63], v[84:87], v[220:223], v[48:63]
    ds_read_b128 v[80:83], v121 offset:28672
    v_mul_f32 v17, v17, v25
    v_exp_f32 v21, v21
    v_fma_f32 v115, v115, v93, v92
    s_waitcnt lgkmcnt(3)
    v_mfma_f32_32x32x16_bf16 v[48:63], v[64:67], v[224:227], v[48:63]
    ds_read_b128 v[84:87], v121 offset:29696
    v_rcp_f32 v19, v19
    v_mul_f32 v22, v114, v22
    v_fma_f32 v20, v20, v94, v94
    v_mul_f32 v18, v18, v26
    v_mfma_f32_32x32x16_bf16 v[48:63], v[68:71], v[228:231], v[48:63]
    ds_read_b128 v[64:67], v121 offset:30720
    v_cvt_pk_bf16_f32 v24, v16, v17
    v_exp_f32 v22, v22
    s_waitcnt lgkmcnt(3)
    v_mfma_f32_32x32x16_bf16 v[48:63], v[72:75], v[232:235], v[48:63]
    ds_read_b128 v[68:71], v121 offset:31744
    v_rcp_f32 v20, v20
    v_mul_f32 v23, v115, v23
    v_fma_f32 v21, v21, v94, v94
    v_mul_f32 v19, v19, v27
    v_mfma_f32_32x32x16_bf16 v[48:63], v[76:79], v[236:239], v[48:63]
    ds_read_b32 v72, v120 offset:256
    v_exp_f32 v23, v23
    v_rcp_f32 v21, v21
    v_fma_f32 v22, v22, v94, v94
    s_waitcnt lgkmcnt(3)
    v_mfma_f32_32x32x16_bf16 v[48:63], v[80:83], v[240:243], v[48:63]
    s_add_u32 s44, s44, 65536
.Lhsc_1_0:
.Lhp_35:
    s_cbranch_execz .Lhp_36
    s_and_b32 s44, s44, 131071
    v_add_u32 v2, s44, v1
    ds_read_b128 v[76:79], v2 offset:0
    v_mul_f32 v20, v20, v28
    v_cvt_pk_bf16_f32 v25, v18, v19
    v_mfma_f32_32x32x16_bf16 v[48:63], v[84:87], v[244:247], v[48:63]
    ds_read_b128 v[80:83], v2 offset:1024
    v_rcp_f32 v22, v22
    v_fma_f32 v23, v23, v94, v94
    v_mul_f32 v21, v21, v29
    s_waitcnt lgkmcnt(3)
    v_mfma_f32_32x32x16_bf16 v[48:63], v[64:67], v[248:251], v[48:63]
    ds_read_b128 v[84:87], v2 offset:2048
    v_rcp_f32 v23, v23
    v_mul_f32 v22, v22, v30
    v_cvt_pk_bf16_f32 v26, v20, v21
    s_add_u32 s41, s85, 0
    v_mfma_f32_32x32x16_bf16 v[48:63], v[68:71], v[252:255], v[48:63]
    ds_read_b128 v[64:67], v2 offset:3072
    v_mul_f32 v23, v23, v31
    v_cvt_pk_bf16_f32 v27, v22, v23
    buffer_store_dwordx4 v[24:27], v1, s[4:7], s41 offen
    v_mul_f32 v112, v32, v32
    s_waitcnt lgkmcnt(3)
    v_mfma_f32_32x32x16_bf16 v[48:63], v[72:75], v[88:91], v[48:63]
    s_barrier
    ds_read_b128 v[68:71], v2 offset:4096
    v_mul_f32 v40, v32, v40
    v_mul_f32 v113, v33, v33
    v_fma_f32 v112, v112, v93, v92
    v_mul_f32 v41, v33, v41
    v_mfma_f32_32x32x16_bf16 v[96:111], v[76:79], v[128:131], 0
    ds_read_b128 v[72:75], v2 offset:5120
    v_mul_f32 v114, v34, v34
    v_fma_f32 v113, v113, v93, v92
    v_mul_f32 v42, v34, v42
    v_mul_f32 v32, v112, v32
    s_waitcnt lgkmcnt(3)
    v_mfma_f32_32x32x16_bf16 v[96:111], v[80:83], v[132:135], v[96:111]
    ds_read_b128 v[76:79], v2 offset:6144
    v_exp_f32 v32, v32
    v_mul_f32 v115, v35, v35
    v_fma_f32 v114, v114, v93, v92
    v_mul_f32 v43, v35, v43
    v_mfma_f32_32x32x16_bf16 v[96:111], v[84:87], v[136:139], v[96:111]
    ds_read_b128 v[80:83], v2 offset:7168
    v_mul_f32 v33, v113, v33
    v_exp_f32 v33, v33
    v_mul_f32 v112, v36, v36
    s_waitcnt lgkmcnt(3)
    v_mfma_f32_32x32x16_bf16 v[96:111], v[64:67], v[140:143], v[96:111]
    ds_read_b128 v[84:87], v2 offset:8192
    v_fma_f32 v115, v115, v93, v92
    v_mul_f32 v44, v36, v44
    v_mul_f32 v34, v114, v34
    v_fma_f32 v32, v32, v94, v94
    v_mfma_f32_32x32x16_bf16 v[96:111], v[68:71], v[144:147], v[96:111]
    ds_read_b128 v[64:67], v2 offset:9216
    v_exp_f32 v34, v34
    v_mul_f32 v113, v37, v37
    v_fma_f32 v112, v112, v93, v92
    v_mul_f32 v45, v37, v45
    s_waitcnt lgkmcnt(3)
    v_mfma_f32_32x32x16_bf16 v[96:111], v[72:75], v[148:151], v[96:111]
    ds_read_b128 v[68:71], v2 offset:10240
    v_rcp_f32 v32, v32
    v_mul_f32 v35, v115, v35
    v_fma_f32 v33, v33, v94, v94
    v_mfma_f32_32x32x16_bf16 v[96:111], v[76:79], v[152:155], v[96:111]
    ds_read_b128 v[72:75], v2 offset:11264
    v_exp_f32 v35, v35
    v_mul_f32 v114, v38, v38
    v_fma_f32 v113, v113, v93, v92
    v_mul_f32 v46, v38, v46
    s_waitcnt lgkmcnt(3)
    v_mfma_f32_32x32x16_bf16 v[96:111], v[80:83], v[156:159], v[96:111]
    ds_read_b128 v[76:79], v2 offset:12288
    v_rcp_f32 v33, v33
    v_mul_f32 v36, v112, v36
    v_fma_f32 v34, v34, v94, v94
    v_mul_f32 v32, v32, v40
    v_mfma_f32_32x32x16_bf16 v[96:111], v[84:87], v[160:163], v[96:111]
    ds_read_b128 v[80:83], v2 offset:13312
    v_exp_f32 v36, v36
.Lhsc_1_1:
.Lhp_36:
    s_cbranch_execz .Lhp_37
    v_mul_f32 v115, v39, v39
    v_fma_f32 v114, v114, v93, v92
    s_waitcnt lgkmcnt(3)
    v_mfma_f32_32x32x16_bf16 v[96:111], v[64:67], v[164:167], v[96:111]
    ds_read_b128 v[84:87], v2 offset:14336
    v_mul_f32 v47, v39, v47
    v_rcp_f32 v34, v34
    v_mul_f32 v37, v113, v37
    v_fma_f32 v35, v35, v94, v94
    v_mfma_f32_32x32x16_bf16 v[96:111], v[68:71], v[168:171], v[96:111]
    ds_read_b128 v[64:67], v2 offset:15360
    v_mul_f32 v33, v33, v41
    v_exp_f32 v37, v37
    v_fma_f32 v115, v115, v93, v92
    s_waitcnt lgkmcnt(3)
    v_mfma_f32_32x32x16_bf16 v[96:111], v[72:75], v[172:175], v[96:111]
    ds_read_b128 v[68:71], v2 offset:16384
    v_rcp_f32 v35, v35
    v_mul_f32 v38, v114, v38
    v_fma_f32 v36, v36, v94, v94
    v_mul_f32 v34, v34, v42
    v_mfma_f32_32x32x16_bf16 v[96:111], v[76:79], v[176:179], v[96:111]
    ds_read_b128 v[72:75], v2 offset:17408
    v_cvt_pk_bf16_f32 v40, v32, v33
    v_exp_f32 v38, v38
    s_waitcnt lgkmcnt(3)
    v_mfma_f32_32x32x16_bf16 v[96:111], v[80:83], v[180:183], v[96:111]
    ds_read_b128 v[76:79], v2 offset:18432
    v_rcp_f32 v36, v36
    v_mul_f32 v39, v115, v39
    v_fma_f32 v37, v37, v94, v94
    v_mul_f32 v35, v35, v43
    v_mfma_f32_32x32x16_bf16 v[96:111], v[84:87], v[184:187], v[96:111]
    ds_read_b128 v[80:83], v2 offset:19456
    v_exp_f32 v39, v39
    v_rcp_f32 v37, v37
    v_fma_f32 v38, v38, v94, v94
    s_waitcnt lgkmcnt(3)
    v_mfma_f32_32x32x16_bf16 v[96:111], v[64:67], v[188:191], v[96:111]
    ds_read_b128 v[84:87], v2 offset:20480
    v_mul_f32 v36, v36, v44
    v_cvt_pk_bf16_f32 v41, v34, v35
    v_rcp_f32 v38, v38
    v_fma_f32 v39, v39, v94, v94
    v_mfma_f32_32x32x16_bf16 v[96:111], v[68:71], v[192:195], v[96:111]
    ds_read_b128 v[64:67], v2 offset:21504
    v_mul_f32 v37, v37, v45
    v_rcp_f32 v39, v39
    v_mul_f32 v38, v38, v46
    s_waitcnt lgkmcnt(3)
    v_mfma_f32_32x32x16_bf16 v[96:111], v[72:75], v[196:199], v[96:111]
    ds_read_b128 v[68:71], v2 offset:22528
    v_cvt_pk_bf16_f32 v42, v36, v37
    s_add_u32 s41, s85, 16384
    v_mul_f32 v39, v39, v47
    v_cvt_pk_bf16_f32 v43, v38, v39
    buffer_store_dwordx4 v[40:43], v1, s[4:7], s41 offen
    v_mfma_f32_32x32x16_bf16 v[96:111], v[76:79], v[200:203], v[96:111]
    ds_read_b128 v[72:75], v2 offset:23552
    v_mul_f32 v112, v48, v48
    v_mul_f32 v56, v48, v56
    v_mul_f32 v113, v49, v49
    v_fma_f32 v112, v112, v93, v92
    s_waitcnt lgkmcnt(3)
    v_mfma_f32_32x32x16_bf16 v[96:111], v[80:83], v[204:207], v[96:111]
    ds_read_b128 v[76:79], v2 offset:24576
    v_mul_f32 v57, v49, v57
    v_mul_f32 v114, v50, v50
    v_fma_f32 v113, v113, v93, v92
    v_mul_f32 v58, v50, v58
    v_mul_f32 v48, v112, v48
    v_mfma_f32_32x32x16_bf16 v[96:111], v[84:87], v[208:211], v[96:111]
    ds_read_b128 v[80:83], v2 offset:25600
    v_exp_f32 v48, v48
    v_mul_f32 v115, v51, v51
    v_fma_f32 v114, v114, v93, v92
    s_waitcnt lgkmcnt(3)
    v_mfma_f32_32x32x16_bf16 v[96:111], v[64:67], v[212:215], v[96:111]
    ds_read_b128 v[84:87], v2 offset:26624
    v_mul_f32 v59, v51, v59
    v_mul_f32 v49, v113, v49
    v_exp_f32 v49, v49
    v_mul_f32 v112, v52, v52
    v_mfma_f32_32x32x16_bf16 v[96:111], v[68:71], v[216:219], v[96:111]
.Lhsc_1_2:
.Lhp_37:
    s_cbranch_execz .Lhp_38
    ds_read_b128 v[64:67], v2 offset:27648
    v_fma_f32 v115, v115, v93, v92
    v_mul_f32 v60, v52, v60
    v_mul_f32 v50, v114, v50
    v_fma_f32 v48, v48, v94, v94
    s_waitcnt lgkmcnt(3)
    v_mfma_f32_32x32x16_bf16 v[96:111], v[72:75], v[220:223], v[96:111]
    ds_read_b128 v[68:71], v2 offset:28672
    v_exp_f32 v50, v50
    v_mul_f32 v113, v53, v53
    v_fma_f32 v112, v112, v93, v92
    v_mul_f32 v61, v53, v61
    v_mfma_f32_32x32x16_bf16 v[96:111], v[76:79], v[224:227], v[96:111]
    ds_read_b128 v[72:75], v2 offset:29696
    v_rcp_f32 v48, v48
    v_mul_f32 v51, v115, v51
    v_fma_f32 v49, v49, v94, v94
    s_waitcnt lgkmcnt(3)
    v_mfma_f32_32x32x16_bf16 v[96:111], v[80:83], v[228:231], v[96:111]
    ds_read_b128 v[76:79], v2 offset:30720
    v_exp_f32 v51, v51
    v_mul_f32 v114, v54, v54
    v_fma_f32 v113, v113, v93, v92
    v_mul_f32 v62, v54, v62
    v_mfma_f32_32x32x16_bf16 v[96:111], v[84:87], v[232:235], v[96:111]
    ds_read_b128 v[80:83], v2 offset:31744
    v_rcp_f32 v49, v49
    v_mul_f32 v52, v112, v52
    v_fma_f32 v50, v50, v94, v94
    s_waitcnt lgkmcnt(3)
    v_mfma_f32_32x32x16_bf16 v[96:111], v[64:67], v[236:239], v[96:111]
    ds_read_b32 v84, v120 offset:384
    v_mul_f32 v48, v48, v56
    v_exp_f32 v52, v52
    v_mul_f32 v115, v55, v55
    v_fma_f32 v114, v114, v93, v92
    v_mfma_f32_32x32x16_bf16 v[96:111], v[68:71], v[240:243], v[96:111]
    s_add_u32 s44, s44, 32768
    s_and_b32 s44, s44, 131071
    v_add_u32 v2, s44, v1
    ds_read_b128 v[64:67], v2 offset:0
    v_mul_f32 v63, v55, v63
    s_waitcnt lgkmcnt(3)
    v_mfma_f32_32x32x16_bf16 v[96:111], v[72:75], v[244:247], v[96:111]
    ds_read_b128 v[68:71], v2 offset:1024
    v_rcp_f32 v50, v50
    v_mul_f32 v53, v113, v53
    v_fma_f32 v51, v51, v94, v94
    v_mul_f32 v49, v49, v57
    v_mfma_f32_32x32x16_bf16 v[96:111], v[76:79], v[248:251], v[96:111]
    ds_read_b128 v[72:75], v2 offset:2048
    v_exp_f32 v53, v53
    v_fma_f32 v115, v115, v93, v92
    s_waitcnt lgkmcnt(3)
    v_mfma_f32_32x32x16_bf16 v[96:111], v[80:83], v[252:255], v[96:111]
    ds_read_b128 v[76:79], v2 offset:3072
    v_rcp_f32 v51, v51
    v_mul_f32 v54, v114, v54
    v_fma_f32 v52, v52, v94, v94
    v_mul_f32 v50, v50, v58
    v_cvt_pk_bf16_f32 v56, v48, v49
    v_mfma_f32_32x32x16_bf16 v[96:111], v[84:87], v[88:91], v[96:111]
    s_barrier
    ds_read_b128 v[80:83], v2 offset:4096
    v_exp_f32 v54, v54
    s_waitcnt lgkmcnt(3)
    v_mfma_f32_32x32x16_bf16 v[16:31], v[64:67], v[128:131], 0
    ds_read_b128 v[84:87], v2 offset:5120
    v_rcp_f32 v52, v52
    v_mul_f32 v55, v115, v55
    v_fma_f32 v53, v53, v94, v94
    v_mul_f32 v51, v51, v59
    v_mfma_f32_32x32x16_bf16 v[16:31], v[68:71], v[132:135], v[16:31]
    ds_read_b128 v[64:67], v2 offset:6144
    v_exp_f32 v55, v55
    v_rcp_f32 v53, v53
    v_fma_f32 v54, v54, v94, v94
    s_waitcnt lgkmcnt(3)
    v_mfma_f32_32x32x16_bf16 v[16:31], v[72:75], v[136:139], v[16:31]
    ds_read_b128 v[68:71], v2 offset:7168
    v_mul_f32 v52, v52, v60
    v_cvt_pk_bf16_f32 v57, v50, v51
    v_rcp_f32 v54, v54
    v_fma_f32 v55, v55, v94, v94
.Lhsc_1_3:
.Lhp_38:
    s_cbranch_execz .Lhp_39
    v_mfma_f32_32x32x16_bf16 v[16:31], v[76:79], v[140:143], v[16:31]
    s_waitcnt vmcnt(1)
    buffer_store_dword v12, off, s[4:7], s82 offset:256
    ds_read_b128 v[72:75], v2 offset:8192
    v_mul_f32 v53, v53, v61
    v_rcp_f32 v55, v55
    s_waitcnt lgkmcnt(3)
    v_mfma_f32_32x32x16_bf16 v[16:31], v[80:83], v[144:147], v[16:31]
    s_waitcnt vmcnt(1)
    buffer_store_dword v12, off, s[4:7], s82 offset:320
    ds_read_b128 v[76:79], v2 offset:9216
    v_mul_f32 v54, v54, v62
    v_cvt_pk_bf16_f32 v58, v52, v53
    s_add_u32 s41, s85, 32768
    v_mul_f32 v55, v55, v63
    v_mfma_f32_32x32x16_bf16 v[16:31], v[84:87], v[148:151], v[16:31]
    ds_read_b128 v[80:83], v2 offset:10240
    v_cvt_pk_bf16_f32 v59, v54, v55
    buffer_store_dwordx4 v[56:59], v1, s[4:7], s41 offen
    v_mul_f32 v112, v96, v96
    v_mul_f32 v104, v96, v104
    s_waitcnt lgkmcnt(3)
    v_mfma_f32_32x32x16_bf16 v[16:31], v[64:67], v[152:155], v[16:31]
    ds_read_b128 v[84:87], v2 offset:11264
    v_mul_f32 v113, v97, v97
    v_fma_f32 v112, v112, v93, v92
    v_mul_f32 v105, v97, v105
    v_mul_f32 v114, v98, v98
    v_fma_f32 v113, v113, v93, v92
    v_mfma_f32_32x32x16_bf16 v[16:31], v[68:71], v[156:159], v[16:31]
    ds_read_b128 v[64:67], v2 offset:12288
    v_mul_f32 v106, v98, v106
    v_mul_f32 v96, v112, v96
    v_exp_f32 v96, v96
    s_waitcnt lgkmcnt(3)
    v_mfma_f32_32x32x16_bf16 v[16:31], v[72:75], v[160:163], v[16:31]
    ds_read_b128 v[68:71], v2 offset:13312
    v_mul_f32 v115, v99, v99
    v_fma_f32 v114, v114, v93, v92
    v_mul_f32 v107, v99, v107
    v_mul_f32 v97, v113, v97
    v_mfma_f32_32x32x16_bf16 v[16:31], v[76:79], v[164:167], v[16:31]
    ds_read_b128 v[72:75], v2 offset:14336
    v_exp_f32 v97, v97
    v_mul_f32 v112, v100, v100
    v_fma_f32 v115, v115, v93, v92
    v_mul_f32 v108, v100, v108
    s_waitcnt lgkmcnt(3)
    v_mfma_f32_32x32x16_bf16 v[16:31], v[80:83], v[168:171], v[16:31]
    ds_read_b128 v[76:79], v2 offset:15360
    v_mul_f32 v98, v114, v98
    v_fma_f32 v96, v96, v94, v94
    v_exp_f32 v98, v98
    v_mul_f32 v113, v101, v101
    v_mfma_f32_32x32x16_bf16 v[16:31], v[84:87], v[172:175], v[16:31]
    ds_read_b128 v[80:83], v2 offset:16384
    v_fma_f32 v112, v112, v93, v92
    v_mul_f32 v109, v101, v109
    v_rcp_f32 v96, v96
    s_waitcnt lgkmcnt(3)
    v_mfma_f32_32x32x16_bf16 v[16:31], v[64:67], v[176:179], v[16:31]
    ds_read_b128 v[84:87], v2 offset:17408
    v_mul_f32 v99, v115, v99
    v_fma_f32 v97, v97, v94, v94
    v_exp_f32 v99, v99
    v_mul_f32 v114, v102, v102
    v_mfma_f32_32x32x16_bf16 v[16:31], v[68:71], v[180:183], v[16:31]
    ds_read_b128 v[64:67], v2 offset:18432
    v_fma_f32 v113, v113, v93, v92
    v_mul_f32 v110, v102, v110
    v_rcp_f32 v97, v97
    s_waitcnt lgkmcnt(3)
    v_mfma_f32_32x32x16_bf16 v[16:31], v[72:75], v[184:187], v[16:31]
    ds_read_b128 v[68:71], v2 offset:19456
    v_mul_f32 v100, v112, v100
    v_fma_f32 v98, v98, v94, v94
    v_mul_f32 v96, v96, v104
    v_exp_f32 v100, v100
    v_mfma_f32_32x32x16_bf16 v[16:31], v[76:79], v[188:191], v[16:31]
    ds_read_b128 v[72:75], v2 offset:20480
    v_mul_f32 v115, v103, v103
    v_fma_f32 v114, v114, v93, v92
    v_mul_f32 v111, v103, v111
    s_waitcnt lgkmcnt(3)
.Lhp_39:
    s_cbranch_execz .Lhp_40
    v_mfma_f32_32x32x16_bf16 v[16:31], v[80:83], v[192:195], v[16:31]
    ds_read_b128 v[76:79], v2 offset:21504
    v_rcp_f32 v98, v98
    v_mul_f32 v101, v113, v101
    v_fma_f32 v99, v99, v94, v94
    v_mul_f32 v97, v97, v105
    v_mfma_f32_32x32x16_bf16 v[16:31], v[84:87], v[196:199], v[16:31]
    ds_read_b128 v[80:83], v2 offset:22528
    v_exp_f32 v101, v101
    v_fma_f32 v115, v115, v93, v92
    v_rcp_f32 v99, v99
    s_waitcnt lgkmcnt(3)
    v_mfma_f32_32x32x16_bf16 v[16:31], v[64:67], v[200:203], v[16:31]
    ds_read_b128 v[84:87], v2 offset:23552
    v_mul_f32 v102, v114, v102
    v_fma_f32 v100, v100, v94, v94
    v_mul_f32 v98, v98, v106
    v_cvt_pk_bf16_f32 v104, v96, v97
    v_mfma_f32_32x32x16_bf16 v[16:31], v[68:71], v[204:207], v[16:31]
    ds_read_b128 v[64:67], v2 offset:24576
    v_exp_f32 v102, v102
    v_rcp_f32 v100, v100
    v_mul_f32 v103, v115, v103
    s_waitcnt lgkmcnt(3)
    v_mfma_f32_32x32x16_bf16 v[16:31], v[72:75], v[208:211], v[16:31]
    ds_read_b128 v[68:71], v2 offset:25600
    v_fma_f32 v101, v101, v94, v94
    v_mul_f32 v99, v99, v107
    v_exp_f32 v103, v103
    v_mfma_f32_32x32x16_bf16 v[16:31], v[76:79], v[212:215], v[16:31]
    ds_read_b128 v[72:75], v2 offset:26624
    v_rcp_f32 v101, v101
    v_fma_f32 v102, v102, v94, v94
    v_mul_f32 v100, v100, v108
    v_cvt_pk_bf16_f32 v105, v98, v99
    s_waitcnt lgkmcnt(3)
    v_mfma_f32_32x32x16_bf16 v[16:31], v[80:83], v[216:219], v[16:31]
    ds_read_b128 v[76:79], v2 offset:27648
    v_rcp_f32 v102, v102
    v_fma_f32 v103, v103, v94, v94
    v_mul_f32 v101, v101, v109
    v_mfma_f32_32x32x16_bf16 v[16:31], v[84:87], v[220:223], v[16:31]
    ds_read_b128 v[80:83], v2 offset:28672
    v_rcp_f32 v103, v103
    v_mul_f32 v102, v102, v110
    v_cvt_pk_bf16_f32 v106, v100, v101
    s_add_u32 s41, s85, 49152
    s_waitcnt lgkmcnt(3)
    v_mfma_f32_32x32x16_bf16 v[16:31], v[64:67], v[224:227], v[16:31]
    ds_read_b128 v[84:87], v2 offset:29696
    v_mul_f32 v103, v103, v111
    v_cvt_pk_bf16_f32 v107, v102, v103
    buffer_store_dwordx4 v[104:107], v1, s[4:7], s41 offen
    v_lshlrev_b32 v48, 16, v4
    v_and_b32 v49, 4294901760, v4
    v_mfma_f32_32x32x16_bf16 v[16:31], v[68:71], v[228:231], v[16:31]
    s_waitcnt vmcnt(1)
    buffer_store_dword v12, off, s[4:7], s82 offset:384
    ds_read_b128 v[64:67], v2 offset:30720
    v_lshlrev_b32 v50, 16, v5
    v_and_b32 v51, 4294901760, v5
    v_lshlrev_b32 v52, 16, v6
    s_waitcnt lgkmcnt(3)
    v_mfma_f32_32x32x16_bf16 v[16:31], v[72:75], v[232:235], v[16:31]
    ds_read_b128 v[68:71], v2 offset:31744
    v_and_b32 v53, 4294901760, v6
    v_lshlrev_b32 v54, 16, v7
    v_and_b32 v55, 4294901760, v7
    v_lshlrev_b32 v56, 16, v8
    v_and_b32 v57, 4294901760, v8
    v_mfma_f32_32x32x16_bf16 v[16:31], v[76:79], v[236:239], v[16:31]
    ds_read_b32 v72, v120 offset:512
    v_lshlrev_b32 v58, 16, v9
    v_and_b32 v59, 4294901760, v9
    v_lshlrev_b32 v60, 16, v10
    v_and_b32 v61, 4294901760, v10
    s_waitcnt lgkmcnt(3)
    v_mfma_f32_32x32x16_bf16 v[16:31], v[80:83], v[240:243], v[16:31]
    s_add_u32 s44, s44, 32768
    s_and_b32 s44, s44, 131071
.Lhsc_1_4:
.Lhp_40:
    s_cbranch_execz .Lhp_41
    v_add_u32 v2, s44, v1
    ds_read_b128 v[76:79], v2 offset:0
    v_lshlrev_b32 v62, 16, v11
    v_and_b32 v63, 4294901760, v11
    v_mfma_f32_32x32x16_bf16 v[16:31], v[84:87], v[244:247], v[16:31]
    ds_read_b128 v[80:83], v2 offset:1024
    s_waitcnt lgkmcnt(3)
    v_mfma_f32_32x32x16_bf16 v[16:31], v[64:67], v[248:251], v[16:31]
    v_and_b32 v15, 31, v0
    v_lshlrev_b32 v15, 2, v15
    ds_read_b128 v[84:87], v2 offset:2048
    v_mfma_f32_32x32x16_bf16 v[16:31], v[68:71], v[252:255], v[16:31]
    buffer_load_dword v125, v15, s[4:7], s81 offen offset:256 sc1
    ds_read_b128 v[64:67], v2 offset:3072
    s_waitcnt lgkmcnt(3)
    v_mfma_f32_32x32x16_bf16 v[16:31], v[72:75], v[88:91], v[16:31]
    s_barrier
    ds_read_b128 v[68:71], v2 offset:4096
    v_mfma_f32_32x32x16_bf16 v[32:47], v[76:79], v[128:131], 0
    ds_read_b128 v[72:75], v2 offset:5120
    s_waitcnt lgkmcnt(3)
    v_mfma_f32_32x32x16_bf16 v[32:47], v[80:83], v[132:135], v[32:47]
    ds_read_b128 v[76:79], v2 offset:6144
    v_mfma_f32_32x32x16_bf16 v[32:47], v[84:87], v[136:139], v[32:47]
    ds_read_b128 v[80:83], v2 offset:7168
    s_nop 2
    v_mul_f32 v112, v16, v16
    v_mul_f32 v24, v16, v24
    v_mul_f32 v113, v17, v17
    v_fma_f32 v112, v112, v93, v92
    s_waitcnt lgkmcnt(3)
    v_mfma_f32_32x32x16_bf16 v[32:47], v[64:67], v[140:143], v[32:47]
    ds_read_b128 v[84:87], v2 offset:8192
    v_mul_f32 v25, v17, v25
    v_mul_f32 v114, v18, v18
    v_fma_f32 v113, v113, v93, v92
    v_mul_f32 v26, v18, v26
    v_mul_f32 v16, v112, v16
    v_mfma_f32_32x32x16_bf16 v[32:47], v[68:71], v[144:147], v[32:47]
    ds_read_b128 v[64:67], v2 offset:9216
    v_exp_f32 v16, v16
    v_mul_f32 v115, v19, v19
    v_fma_f32 v114, v114, v93, v92
    s_waitcnt lgkmcnt(3)
    v_mfma_f32_32x32x16_bf16 v[32:47], v[72:75], v[148:151], v[32:47]
    ds_read_b128 v[68:71], v2 offset:10240
    v_mul_f32 v27, v19, v27
    v_mul_f32 v17, v113, v17
    v_exp_f32 v17, v17
    v_mul_f32 v112, v20, v20
    v_mfma_f32_32x32x16_bf16 v[32:47], v[76:79], v[152:155], v[32:47]
    ds_read_b128 v[72:75], v2 offset:11264
    v_fma_f32 v115, v115, v93, v92
    v_mul_f32 v28, v20, v28
    v_mul_f32 v18, v114, v18
    v_fma_f32 v16, v16, v94, v94
    s_waitcnt lgkmcnt(3)
    v_mfma_f32_32x32x16_bf16 v[32:47], v[80:83], v[156:159], v[32:47]
    ds_read_b128 v[76:79], v2 offset:12288
    v_exp_f32 v18, v18
    v_mul_f32 v113, v21, v21
    v_fma_f32 v112, v112, v93, v92
    v_mul_f32 v29, v21, v29
    v_mfma_f32_32x32x16_bf16 v[32:47], v[84:87], v[160:163], v[32:47]
    ds_read_b128 v[80:83], v2 offset:13312
    v_rcp_f32 v16, v16
    v_mul_f32 v19, v115, v19
    v_fma_f32 v17, v17, v94, v94
    s_waitcnt lgkmcnt(3)
    v_mfma_f32_32x32x16_bf16 v[32:47], v[64:67], v[164:167], v[32:47]
    s_waitcnt vmcnt(2)
    buffer_store_dword v12, off, s[4:7], s82 offset:448
    ds_read_b128 v[84:87], v2 offset:14336
    v_exp_f32 v19, v19
    v_mul_f32 v114, v22, v22
    v_fma_f32 v113, v113, v93, v92
    v_mfma_f32_32x32x16_bf16 v[32:47], v[68:71], v[168:171], v[32:47]
    s_waitcnt vmcnt(1)
    v_cmp_ne_u32 vcc, s71, v125
    s_cbranch_vccnz .Lsoftx_53
.Lsoft_52:
    ds_read_b128 v[64:67], v2 offset:15360
    v_mul_f32 v30, v22, v30
    s_waitcnt lgkmcnt(3)
    v_mfma_f32_32x32x16_bf16 v[32:47], v[72:75], v[172:175], v[32:47]
.Lhsc_1_5:
.Lhp_41:
    s_cbranch_execz .Lhp_42
    s_add_u32 s48, s84, 0
    buffer_load_dwordx4 v[128:131], v1, s[4:7], s48 offen offset:0 sc1
    ds_read_b128 v[68:71], v2 offset:16384
    v_rcp_f32 v17, v17
    v_mul_f32 v20, v112, v20
    v_fma_f32 v18, v18, v94, v94
    v_mfma_f32_32x32x16_bf16 v[32:47], v[76:79], v[176:179], v[32:47]
    ds_read_b128 v[72:75], v2 offset:17408
    v_mul_f32 v16, v16, v24
    v_exp_f32 v20, v20
    v_mul_f32 v115, v23, v23
    s_waitcnt lgkmcnt(3)
    v_mfma_f32_32x32x16_bf16 v[32:47], v[80:83], v[180:183], v[32:47]
    buffer_load_dwordx4 v[132:135], v1, s[4:7], s48 offen offset:2048 sc1
    ds_read_b128 v[76:79], v2 offset:18432
    v_fma_f32 v114, v114, v93, v92
    v_mul_f32 v31, v23, v31
    v_rcp_f32 v18, v18
    v_mfma_f32_32x32x16_bf16 v[32:47], v[84:87], v[184:187], v[32:47]
    ds_read_b128 v[80:83], v2 offset:19456
    v_mul_f32 v21, v113, v21
    v_fma_f32 v19, v19, v94, v94
    v_mul_f32 v17, v17, v25
    s_waitcnt lgkmcnt(3)
    v_mfma_f32_32x32x16_bf16 v[32:47], v[64:67], v[188:191], v[32:47]
    s_add_u32 s48, s84, 4096
    buffer_load_dwordx4 v[136:139], v1, s[4:7], s48 offen offset:0 sc1
    ds_read_b128 v[84:87], v2 offset:20480
    v_exp_f32 v21, v21
    v_fma_f32 v115, v115, v93, v92
    v_mfma_f32_32x32x16_bf16 v[32:47], v[68:71], v[192:195], v[32:47]
    ds_read_b128 v[64:67], v2 offset:21504
    v_rcp_f32 v19, v19
    v_mul_f32 v22, v114, v22
    v_fma_f32 v20, v20, v94, v94
    v_mul_f32 v18, v18, v26
    s_waitcnt lgkmcnt(3)
    v_mfma_f32_32x32x16_bf16 v[32:47], v[72:75], v[196:199], v[32:47]
    buffer_load_dwordx4 v[140:143], v1, s[4:7], s48 offen offset:2048 sc1
    ds_read_b128 v[68:71], v2 offset:22528
    v_cvt_pk_bf16_f32 v24, v16, v17
    v_exp_f32 v22, v22
    v_mfma_f32_32x32x16_bf16 v[32:47], v[76:79], v[200:203], v[32:47]
    ds_read_b128 v[72:75], v2 offset:23552
    v_rcp_f32 v20, v20
    v_mul_f32 v23, v115, v23
    v_fma_f32 v21, v21, v94, v94
    v_mul_f32 v19, v19, v27
    s_waitcnt lgkmcnt(3)
    v_mfma_f32_32x32x16_bf16 v[32:47], v[80:83], v[204:207], v[32:47]
    s_add_u32 s48, s84, 8192
    buffer_load_dwordx4 v[144:147], v1, s[4:7], s48 offen offset:0 sc1
    ds_read_b128 v[76:79], v2 offset:24576
    v_exp_f32 v23, v23
    v_mfma_f32_32x32x16_bf16 v[32:47], v[84:87], v[208:211], v[32:47]
    ds_read_b128 v[80:83], v2 offset:25600
    v_rcp_f32 v21, v21
    v_fma_f32 v22, v22, v94, v94
    v_mul_f32 v20, v20, v28
    v_cvt_pk_bf16_f32 v25, v18, v19
    s_waitcnt lgkmcnt(3)
    v_mfma_f32_32x32x16_bf16 v[32:47], v[64:67], v[212:215], v[32:47]
    buffer_load_dword v125, v3, s[4:7], s81 offen offset:384 sc1
    buffer_load_dwordx4 v[148:151], v1, s[4:7], s48 offen offset:2048 sc1
    ds_read_b128 v[84:87], v2 offset:26624
    v_rcp_f32 v22, v22
    v_fma_f32 v23, v23, v94, v94
    v_mfma_f32_32x32x16_bf16 v[32:47], v[68:71], v[216:219], v[32:47]
    ds_read_b128 v[64:67], v2 offset:27648
    v_mul_f32 v21, v21, v29
    v_rcp_f32 v23, v23
    v_mul_f32 v22, v22, v30
    s_waitcnt lgkmcnt(3)
    v_mfma_f32_32x32x16_bf16 v[32:47], v[72:75], v[220:223], v[32:47]
    s_add_u32 s48, s84, 12288
    buffer_load_dwordx4 v[152:155], v1, s[4:7], s48 offen offset:0 sc1
    ds_read_b128 v[68:71], v2 offset:28672
    v_cvt_pk_bf16_f32 v26, v20, v21
    s_add_u32 s41, s85, 65536
.Lhsc_1_6:
.Lhp_42:
    s_cbranch_execz .Lhp_43
    v_mul_f32 v23, v23, v31
    v_mfma_f32_32x32x16_bf16 v[32:47], v[76:79], v[224:227], v[32:47]
    ds_read_b128 v[72:75], v2 offset:29696
    v_cvt_pk_bf16_f32 v27, v22, v23
    buffer_store_dwordx4 v[24:27], v1, s[4:7], s41 offen
    s_waitcnt lgkmcnt(3)
    v_mfma_f32_32x32x16_bf16 v[32:47], v[80:83], v[228:231], v[32:47]
    buffer_load_dwordx4 v[156:159], v1, s[4:7], s48 offen offset:2048 sc1
    ds_read_b128 v[76:79], v2 offset:30720
    v_mfma_f32_32x32x16_bf16 v[32:47], v[84:87], v[232:235], v[32:47]
    ds_read_b128 v[80:83], v2 offset:31744
    s_waitcnt lgkmcnt(3)
    v_mfma_f32_32x32x16_bf16 v[32:47], v[64:67], v[236:239], v[32:47]
    s_add_u32 s48, s84, 16384
    buffer_load_dwordx4 v[160:163], v1, s[4:7], s48 offen offset:0 sc1
    ds_read_b32 v84, v120 offset:640
    v_mfma_f32_32x32x16_bf16 v[32:47], v[68:71], v[240:243], v[32:47]
    s_add_u32 s44, s44, 32768
    s_and_b32 s44, s44, 131071
    v_add_u32 v2, s44, v123
    v_xor_b32 v121, 64, v2
    ds_read_b64_tr_b16 v[64:65], v2 offset:0
    ds_read_b64_tr_b16 v[66:67], v2 offset:512
    s_waitcnt lgkmcnt(4)
    v_mfma_f32_32x32x16_bf16 v[32:47], v[72:75], v[244:247], v[32:47]
    buffer_load_dwordx4 v[164:167], v1, s[4:7], s48 offen offset:2048 sc1
    ds_read_b64_tr_b16 v[68:69], v121 offset:0
    ds_read_b64_tr_b16 v[70:71], v121 offset:512
    v_mfma_f32_32x32x16_bf16 v[32:47], v[76:79], v[248:251], v[32:47]
    ds_read_b64_tr_b16 v[72:73], v2 offset:4096
    ds_read_b64_tr_b16 v[74:75], v2 offset:4608
    s_waitcnt lgkmcnt(6)
    v_mfma_f32_32x32x16_bf16 v[32:47], v[80:83], v[252:255], v[32:47]
    s_add_u32 s48, s84, 20480
    buffer_load_dwordx4 v[168:171], v1, s[4:7], s48 offen offset:0 sc1
    ds_read_b64_tr_b16 v[76:77], v121 offset:4096
    ds_read_b64_tr_b16 v[78:79], v121 offset:4608
    v_mfma_f32_32x32x16_bf16 v[32:47], v[84:87], v[88:91], v[32:47]
    s_barrier
    ds_read_b64_tr_b16 v[80:81], v2 offset:8192
    ds_read_b64_tr_b16 v[82:83], v2 offset:8704
    s_waitcnt vmcnt(12) lgkmcnt(6)
    v_mfma_f32_32x32x16_bf16 v[48:63], v[64:67], v[128:131], v[48:63]
    s_waitcnt vmcnt(7)
    v_cmp_ne_u32 vcc, s71, v125
    s_cbranch_vccnz .Lsoftx_57
.Lsoft_56:
    buffer_load_dwordx4 v[172:175], v1, s[4:7], s48 offen offset:2048 sc1
    ds_read_b64_tr_b16 v[84:85], v121 offset:8192
    ds_read_b64_tr_b16 v[86:87], v121 offset:8704
    v_mfma_f32_32x32x16_bf16 v[96:111], v[68:71], v[128:131], 0
    ds_read_b64_tr_b16 v[64:65], v2 offset:12288
    ds_read_b64_tr_b16 v[66:67], v2 offset:12800
    s_waitcnt lgkmcnt(6)
    v_mfma_f32_32x32x16_bf16 v[48:63], v[72:75], v[132:135], v[48:63]
    s_add_u32 s48, s84, 24576
    buffer_load_dwordx4 v[176:179], v1, s[4:7], s48 offen offset:0 sc1
    ds_read_b64_tr_b16 v[68:69], v121 offset:12288
    ds_read_b64_tr_b16 v[70:71], v121 offset:12800
    v_mul_f32 v112, v32, v32
    v_mul_f32 v40, v32, v40
    v_mul_f32 v113, v33, v33
    v_mfma_f32_32x32x16_bf16 v[96:111], v[76:79], v[132:135], v[96:111]
    ds_read_b64_tr_b16 v[72:73], v2 offset:16384
    ds_read_b64_tr_b16 v[74:75], v2 offset:16896
    v_fma_f32 v112, v112, v93, v92
    v_mul_f32 v41, v33, v41
    v_mul_f32 v114, v34, v34
    v_fma_f32 v113, v113, v93, v92
    s_waitcnt lgkmcnt(6)
    v_mfma_f32_32x32x16_bf16 v[48:63], v[80:83], v[136:139], v[48:63]
    buffer_load_dword v125, v3, s[4:7], s81 offen offset:448 sc1
    buffer_load_dwordx4 v[180:183], v1, s[4:7], s48 offen offset:2048 sc1
    ds_read_b64_tr_b16 v[76:77], v121 offset:16384
.Lhsc_1_7:
.Lhp_43:
    s_cbranch_execz .Lhp_44
    ds_read_b64_tr_b16 v[78:79], v121 offset:16896
    v_mul_f32 v42, v34, v42
    v_mul_f32 v32, v112, v32
    v_mfma_f32_32x32x16_bf16 v[96:111], v[84:87], v[136:139], v[96:111]
    ds_read_b64_tr_b16 v[80:81], v2 offset:20480
    ds_read_b64_tr_b16 v[82:83], v2 offset:20992
    v_exp_f32 v32, v32
    v_mul_f32 v115, v35, v35
    v_fma_f32 v114, v114, v93, v92
    v_mul_f32 v43, v35, v43
    s_waitcnt lgkmcnt(6)
    v_mfma_f32_32x32x16_bf16 v[48:63], v[64:67], v[140:143], v[48:63]
    s_add_u32 s48, s84, 28672
    buffer_load_dwordx4 v[184:187], v1, s[4:7], s48 offen offset:0 sc1
    ds_read_b64_tr_b16 v[84:85], v121 offset:20480
    ds_read_b64_tr_b16 v[86:87], v121 offset:20992
    v_mul_f32 v33, v113, v33
    v_exp_f32 v33, v33
    v_mfma_f32_32x32x16_bf16 v[96:111], v[68:71], v[140:143], v[96:111]
    s_waitcnt vmcnt(9)
    buffer_store_dword v12, off, s[4:7], s82 offset:512
    ds_read_b64_tr_b16 v[64:65], v2 offset:24576
    ds_read_b64_tr_b16 v[66:67], v2 offset:25088
    v_mul_f32 v112, v36, v36
    v_fma_f32 v115, v115, v93, v92
    v_mul_f32 v44, v36, v44
    s_waitcnt lgkmcnt(6)
    v_mfma_f32_32x32x16_bf16 v[48:63], v[72:75], v[144:147], v[48:63]
    buffer_load_dwordx4 v[188:191], v1, s[4:7], s48 offen offset:2048 sc1
    ds_read_b64_tr_b16 v[68:69], v121 offset:24576
    ds_read_b64_tr_b16 v[70:71], v121 offset:25088
    v_mul_f32 v34, v114, v34
    v_fma_f32 v32, v32, v94, v94
    v_exp_f32 v34, v34
    v_mfma_f32_32x32x16_bf16 v[96:111], v[76:79], v[144:147], v[96:111]
    ds_read_b64_tr_b16 v[72:73], v2 offset:28672
    ds_read_b64_tr_b16 v[74:75], v2 offset:29184
    v_mul_f32 v113, v37, v37
    v_fma_f32 v112, v112, v93, v92
    v_mul_f32 v45, v37, v45
    s_waitcnt lgkmcnt(6)
    v_mfma_f32_32x32x16_bf16 v[48:63], v[80:83], v[148:151], v[48:63]
    s_barrier
    s_add_u32 s48, s84, 32768
    buffer_load_dwordx4 v[192:195], v1, s[4:7], s48 offen offset:0 sc1
    ds_read_b64_tr_b16 v[76:77], v121 offset:28672
    ds_read_b64_tr_b16 v[78:79], v121 offset:29184
    v_rcp_f32 v32, v32
    v_mul_f32 v35, v115, v35
    v_mfma_f32_32x32x16_bf16 v[96:111], v[84:87], v[148:151], v[96:111]
    s_add_u32 s44, s44, 32768
    s_and_b32 s44, s44, 131071
    v_add_u32 v2, s44, v123
    v_xor_b32 v121, 64, v2
    ds_read_b64_tr_b16 v[80:81], v2 offset:0
    ds_read_b64_tr_b16 v[82:83], v2 offset:512
    s_waitcnt lgkmcnt(6)
    v_mfma_f32_32x32x16_bf16 v[48:63], v[64:67], v[152:155], v[48:63]
    buffer_load_dwordx4 v[196:199], v1, s[4:7], s48 offen offset:2048 sc1
    ds_read_b64_tr_b16 v[84:85], v121 offset:0
    ds_read_b64_tr_b16 v[86:87], v121 offset:512
    v_fma_f32 v33, v33, v94, v94
    v_exp_f32 v35, v35
    v_mul_f32 v114, v38, v38
    v_mfma_f32_32x32x16_bf16 v[96:111], v[68:71], v[152:155], v[96:111]
    ds_read_b64_tr_b16 v[64:65], v2 offset:4096
    ds_read_b64_tr_b16 v[66:67], v2 offset:4608
    v_fma_f32 v113, v113, v93, v92
    v_mul_f32 v46, v38, v46
    v_rcp_f32 v33, v33
    s_waitcnt vmcnt(12) lgkmcnt(6)
    v_mfma_f32_32x32x16_bf16 v[48:63], v[72:75], v[156:159], v[48:63]
    s_add_u32 s48, s84, 36864
    buffer_load_dwordx4 v[200:203], v1, s[4:7], s48 offen offset:0 sc1
    ds_read_b64_tr_b16 v[68:69], v121 offset:4096
    ds_read_b64_tr_b16 v[70:71], v121 offset:4608
    v_mul_f32 v36, v112, v36
    v_fma_f32 v34, v34, v94, v94
.Lhp_44:
    s_cbranch_execz .Lhbrc
    v_mul_f32 v32, v32, v40
    v_mfma_f32_32x32x16_bf16 v[96:111], v[76:79], v[156:159], v[96:111]
    ds_read_b64_tr_b16 v[72:73], v2 offset:8192
    ds_read_b64_tr_b16 v[74:75], v2 offset:8704
    v_exp_f32 v36, v36
    v_mul_f32 v115, v39, v39
    v_fma_f32 v114, v114, v93, v92
    s_waitcnt vmcnt(12) lgkmcnt(6)
    v_mfma_f32_32x32x16_bf16 v[48:63], v[80:83], v[160:163], v[48:63]
    s_waitcnt vmcnt(7)
    v_cmp_ne_u32 vcc, s71, v125
    s_cbranch_vccnz .Lsoftx_61
.Lsoft_60:
    buffer_load_dwordx4 v[204:207], v1, s[4:7], s48 offen offset:2048 sc1
    ds_read_b64_tr_b16 v[76:77], v121 offset:8192
    ds_read_b64_tr_b16 v[78:79], v121 offset:8704
    v_mul_f32 v47, v39, v47
    v_mfma_f32_32x32x16_bf16 v[96:111], v[84:87], v[160:163], v[96:111]
    ds_read_b64_tr_b16 v[80:81], v2 offset:12288
    ds_read_b64_tr_b16 v[82:83], v2 offset:12800
    v_rcp_f32 v34, v34
    v_mul_f32 v37, v113, v37
    v_fma_f32 v35, v35, v94, v94
    v_mul_f32 v33, v33, v41
    s_waitcnt lgkmcnt(6)
    v_mfma_f32_32x32x16_bf16 v[48:63], v[64:67], v[164:167], v[48:63]
    s_add_u32 s48, s84, 40960
    buffer_load_dwordx4 v[208:211], v1, s[4:7], s48 offen offset:0 sc1
    ds_read_b64_tr_b16 v[84:85], v121 offset:12288
    ds_read_b64_tr_b16 v[86:87], v121 offset:12800
    v_exp_f32 v37, v37
    v_fma_f32 v115, v115, v93, v92
    v_mfma_f32_32x32x16_bf16 v[96:111], v[68:71], v[164:167], v[96:111]
    ds_read_b64_tr_b16 v[64:65], v2 offset:16384
    ds_read_b64_tr_b16 v[66:67], v2 offset:16896
    v_rcp_f32 v35, v35
    v_mul_f32 v38, v114, v38
    v_fma_f32 v36, v36, v94, v94
    s_waitcnt lgkmcnt(6)
    v_mfma_f32_32x32x16_bf16 v[48:63], v[72:75], v[168:171], v[48:63]
    buffer_load_dwordx4 v[212:215], v1, s[4:7], s48 offen offset:2048 sc1
    ds_read_b64_tr_b16 v[68:69], v121 offset:16384
    ds_read_b64_tr_b16 v[70:71], v121 offset:16896
    v_mul_f32 v34, v34, v42
    v_cvt_pk_bf16_f32 v40, v32, v33
    v_exp_f32 v38, v38
    v_mfma_f32_32x32x16_bf16 v[96:111], v[76:79], v[168:171], v[96:111]
    ds_read_b64_tr_b16 v[72:73], v2 offset:20480
    ds_read_b64_tr_b16 v[74:75], v2 offset:20992
    v_rcp_f32 v36, v36
    v_mul_f32 v39, v115, v39
    v_fma_f32 v37, v37, v94, v94
    s_waitcnt lgkmcnt(6)
    v_mfma_f32_32x32x16_bf16 v[48:63], v[80:83], v[172:175], v[48:63]
    s_add_u32 s48, s84, 45056
    buffer_load_dwordx4 v[216:219], v1, s[4:7], s48 offen offset:0 sc1
    ds_read_b64_tr_b16 v[76:77], v121 offset:20480
    ds_read_b64_tr_b16 v[78:79], v121 offset:20992
    v_mul_f32 v35, v35, v43
    v_exp_f32 v39, v39
    v_mfma_f32_32x32x16_bf16 v[96:111], v[84:87], v[172:175], v[96:111]
    ds_read_b64_tr_b16 v[80:81], v2 offset:24576
    ds_read_b64_tr_b16 v[82:83], v2 offset:25088
    v_rcp_f32 v37, v37
    v_fma_f32 v38, v38, v94, v94
    v_mul_f32 v36, v36, v44
    s_waitcnt lgkmcnt(6)
    v_mfma_f32_32x32x16_bf16 v[48:63], v[64:67], v[176:179], v[48:63]
    buffer_load_dwordx4 v[220:223], v1, s[4:7], s48 offen offset:2048 sc1
    ds_read_b64_tr_b16 v[84:85], v121 offset:24576
    ds_read_b64_tr_b16 v[86:87], v121 offset:25088
    v_cvt_pk_bf16_f32 v41, v34, v35
    v_rcp_f32 v38, v38
    v_fma_f32 v39, v39, v94, v94
    v_mfma_f32_32x32x16_bf16 v[96:111], v[68:71], v[176:179], v[96:111]
    ds_read_b64_tr_b16 v[64:65], v2 offset:28672
    ds_read_b64_tr_b16 v[66:67], v2 offset:29184
    v_mul_f32 v37, v37, v45
    v_rcp_f32 v39, v39
.Lhsc_2_0:
.Lhp_45:
    s_cbranch_execz .Lhp_46
    v_mul_f32 v38, v38, v46
    s_waitcnt vmcnt(11) lgkmcnt(6)
    v_mfma_f32_32x32x16_bf16 v[48:63], v[72:75], v[180:183], v[48:63]
    s_barrier
    s_add_u32 s48, s84, 49152
    buffer_load_dwordx4 v[224:227], v1, s[4:7], s48 offen offset:0 sc1
    ds_read_b64_tr_b16 v[68:69], v121 offset:28672
    ds_read_b64_tr_b16 v[70:71], v121 offset:29184
    v_cvt_pk_bf16_f32 v42, v36, v37
    v_mul_f32 v39, v39, v47
    v_mfma_f32_32x32x16_bf16 v[96:111], v[76:79], v[180:183], v[96:111]
    s_add_u32 s44, s44, 32768
    s_and_b32 s44, s44, 131071
    v_add_u32 v2, s44, v123
    v_xor_b32 v121, 64, v2
    ds_read_b64_tr_b16 v[72:73], v2 offset:0
    ds_read_b64_tr_b16 v[74:75], v2 offset:512
    s_waitcnt vmcnt(11) lgkmcnt(6)
    v_mfma_f32_32x32x16_bf16 v[48:63], v[80:83], v[184:187], v[48:63]
    buffer_load_dwordx4 v[228:231], v1, s[4:7], s48 offen offset:2048 sc1
    ds_read_b64_tr_b16 v[76:77], v121 offset:0
    ds_read_b64_tr_b16 v[78:79], v121 offset:512
    v_cvt_pk_bf16_f32 v43, v38, v39
    buffer_store_dwordx4 v[40:43], v1, s[4:7], s49 offen
    v_mfma_f32_32x32x16_bf16 v[96:111], v[84:87], v[184:187], v[96:111]
    ds_read_b64_tr_b16 v[80:81], v2 offset:4096
    ds_read_b64_tr_b16 v[82:83], v2 offset:4608
    s_waitcnt vmcnt(11) lgkmcnt(6)
    v_mfma_f32_32x32x16_bf16 v[48:63], v[64:67], v[188:191], v[48:63]
    buffer_load_dword v125, v3, s[4:7], s81 offen offset:512 sc1
    s_add_u32 s48, s84, 53248
    buffer_load_dwordx4 v[232:235], v1, s[4:7], s48 offen offset:0 sc1
    ds_read_b64_tr_b16 v[84:85], v121 offset:4096
    ds_read_b64_tr_b16 v[86:87], v121 offset:4608
    v_mfma_f32_32x32x16_bf16 v[96:111], v[68:71], v[188:191], v[96:111]
    ds_read_b64_tr_b16 v[64:65], v2 offset:8192
    ds_read_b64_tr_b16 v[66:67], v2 offset:8704
    s_waitcnt vmcnt(12) lgkmcnt(6)
    v_mfma_f32_32x32x16_bf16 v[48:63], v[72:75], v[192:195], v[48:63]
    buffer_load_dwordx4 v[236:239], v1, s[4:7], s48 offen offset:2048 sc1
    ds_read_b64_tr_b16 v[68:69], v121 offset:8192
    ds_read_b64_tr_b16 v[70:71], v121 offset:8704
    v_mfma_f32_32x32x16_bf16 v[96:111], v[76:79], v[192:195], v[96:111]
    ds_read_b64_tr_b16 v[72:73], v2 offset:12288
    ds_read_b64_tr_b16 v[74:75], v2 offset:12800
    s_waitcnt vmcnt(12) lgkmcnt(6)
    v_mfma_f32_32x32x16_bf16 v[48:63], v[80:83], v[196:199], v[48:63]
    s_add_u32 s48, s84, 57344
    buffer_load_dwordx4 v[240:243], v1, s[4:7], s48 offen offset:0 sc1
    ds_read_b64_tr_b16 v[76:77], v121 offset:12288
    ds_read_b64_tr_b16 v[78:79], v121 offset:12800
    v_mfma_f32_32x32x16_bf16 v[96:111], v[84:87], v[196:199], v[96:111]
    ds_read_b64_tr_b16 v[80:81], v2 offset:16384
    ds_read_b64_tr_b16 v[82:83], v2 offset:16896
    s_waitcnt vmcnt(12) lgkmcnt(6)
    v_mfma_f32_32x32x16_bf16 v[48:63], v[64:67], v[200:203], v[48:63]
    buffer_load_dwordx4 v[244:247], v1, s[4:7], s48 offen offset:2048 sc1
    ds_read_b64_tr_b16 v[84:85], v121 offset:16384
    ds_read_b64_tr_b16 v[86:87], v121 offset:16896
    v_mfma_f32_32x32x16_bf16 v[96:111], v[68:71], v[200:203], v[96:111]
    ds_read_b64_tr_b16 v[64:65], v2 offset:20480
    ds_read_b64_tr_b16 v[66:67], v2 offset:20992
    s_waitcnt vmcnt(12) lgkmcnt(6)
    v_mfma_f32_32x32x16_bf16 v[48:63], v[72:75], v[204:207], v[48:63]
    s_add_u32 s48, s84, 61440
    buffer_load_dwordx4 v[248:251], v1, s[4:7], s48 offen offset:0 sc1
    ds_read_b64_tr_b16 v[68:69], v121 offset:20480
    ds_read_b64_tr_b16 v[70:71], v121 offset:20992
    v_mfma_f32_32x32x16_bf16 v[96:111], v[76:79], v[204:207], v[96:111]
    ds_read_b64_tr_b16 v[72:73], v2 offset:24576
.Lhsc_2_1:
.Lhp_46:
    s_cbranch_execz .Lhp_47
    ds_read_b64_tr_b16 v[74:75], v2 offset:25088
    s_waitcnt vmcnt(12) lgkmcnt(6)
    v_mfma_f32_32x32x16_bf16 v[48:63], v[80:83], v[208:211], v[48:63]
    buffer_load_dwordx4 v[252:255], v1, s[4:7], s48 offen offset:2048 sc1
    s_waitcnt vmcnt(7)
    buffer_store_dword v12, off, s[4:7], s83 offset:576
    ds_read_b64_tr_b16 v[76:77], v121 offset:24576
    ds_read_b64_tr_b16 v[78:79], v121 offset:25088
    v_mfma_f32_32x32x16_bf16 v[96:111], v[84:87], v[208:211], v[96:111]
    ds_read_b64_tr_b16 v[80:81], v2 offset:28672
    ds_read_b64_tr_b16 v[82:83], v2 offset:29184
    s_waitcnt lgkmcnt(6)
    v_mfma_f32_32x32x16_bf16 v[48:63], v[64:67], v[212:215], v[48:63]
    s_barrier
    s_waitcnt vmcnt(7)
    v_cmp_ne_u32 vcc, s71, v125
    s_cbranch_vccnz .Lsoftx_65
.Lsoft_64:
    s_add_u32 s48, s84, 65536
    buffer_load_dwordx4 v[16:19], v1, s[4:7], s48 offen offset:0 sc1
    ds_read_b64_tr_b16 v[84:85], v121 offset:28672
    ds_read_b64_tr_b16 v[86:87], v121 offset:29184
    v_mfma_f32_32x32x16_bf16 v[96:111], v[68:71], v[212:215], v[96:111]
    s_add_u32 s44, s44, 32768
    s_and_b32 s44, s44, 131071
    v_add_u32 v2, s44, v123
    v_xor_b32 v121, 64, v2
    ds_read_b64_tr_b16 v[64:65], v2 offset:0
    ds_read_b64_tr_b16 v[66:67], v2 offset:512
    s_waitcnt lgkmcnt(6)
    v_mfma_f32_32x32x16_bf16 v[48:63], v[72:75], v[216:219], v[48:63]
    buffer_load_dwordx4 v[20:23], v1, s[4:7], s48 offen offset:2048 sc1
    ds_read_b64_tr_b16 v[68:69], v121 offset:0
    ds_read_b64_tr_b16 v[70:71], v121 offset:512
    v_mfma_f32_32x32x16_bf16 v[96:111], v[76:79], v[216:219], v[96:111]
    ds_read_b64_tr_b16 v[72:73], v2 offset:4096
    ds_read_b64_tr_b16 v[74:75], v2 offset:4608
    s_waitcnt lgkmcnt(6)
    v_mfma_f32_32x32x16_bf16 v[48:63], v[80:83], v[220:223], v[48:63]
    s_add_u32 s48, s84, 69632
    buffer_load_dwordx4 v[24:27], v1, s[4:7], s48 offen offset:0 sc1
    ds_read_b64_tr_b16 v[76:77], v121 offset:4096
    ds_read_b64_tr_b16 v[78:79], v121 offset:4608
    v_mfma_f32_32x32x16_bf16 v[96:111], v[84:87], v[220:223], v[96:111]
    ds_read_b64_tr_b16 v[80:81], v2 offset:8192
    ds_read_b64_tr_b16 v[82:83], v2 offset:8704
    s_waitcnt lgkmcnt(6)
    v_mfma_f32_32x32x16_bf16 v[48:63], v[64:67], v[224:227], v[48:63]
    buffer_load_dwordx4 v[28:31], v1, s[4:7], s48 offen offset:2048 sc1
    ds_read_b64_tr_b16 v[84:85], v121 offset:8192
    ds_read_b64_tr_b16 v[86:87], v121 offset:8704
    v_mfma_f32_32x32x16_bf16 v[96:111], v[68:71], v[224:227], v[96:111]
    ds_read_b64_tr_b16 v[64:65], v2 offset:12288
    ds_read_b64_tr_b16 v[66:67], v2 offset:12800
    s_waitcnt lgkmcnt(6)
    v_mfma_f32_32x32x16_bf16 v[48:63], v[72:75], v[228:231], v[48:63]
    s_add_u32 s48, s84, 73728
    buffer_load_dwordx4 v[116:119], v1, s[4:7], s48 offen offset:0 sc1
    ds_read_b64_tr_b16 v[68:69], v121 offset:12288
    ds_read_b64_tr_b16 v[70:71], v121 offset:12800
    v_mfma_f32_32x32x16_bf16 v[96:111], v[76:79], v[228:231], v[96:111]
    ds_read_b64_tr_b16 v[72:73], v2 offset:16384
    ds_read_b64_tr_b16 v[74:75], v2 offset:16896
    s_waitcnt vmcnt(11) lgkmcnt(6)
    v_mfma_f32_32x32x16_bf16 v[48:63], v[80:83], v[232:235], v[48:63]
    buffer_load_dwordx4 v[88:91], v1, s[4:7], s48 offen offset:2048 sc1
    ds_read_b64_tr_b16 v[76:77], v121 offset:16384
    ds_read_b64_tr_b16 v[78:79], v121 offset:16896
    v_mfma_f32_32x32x16_bf16 v[96:111], v[84:87], v[232:235], v[96:111]
    buffer_load_dword v125, v124, s[4:7], s81 offen offset:576 sc1
    ds_read_b64_tr_b16 v[80:81], v2 offset:20480
.Lhsc_2_2:
.Lhp_47:
    s_cbranch_execz .Lhp_48
    ds_read_b64_tr_b16 v[82:83], v2 offset:20992
    s_waitcnt vmcnt(12) lgkmcnt(6)
    v_mfma_f32_32x32x16_bf16 v[48:63], v[64:67], v[236:239], v[48:63]
    s_add_u32 s48, s84, 77824
    buffer_load_dwordx4 v[128:131], v1, s[4:7], s48 offen offset:0 sc1
    ds_read_b64_tr_b16 v[84:85], v121 offset:20480
    ds_read_b64_tr_b16 v[86:87], v121 offset:20992
    v_mfma_f32_32x32x16_bf16 v[96:111], v[68:71], v[236:239], v[96:111]
    ds_read_b64_tr_b16 v[64:65], v2 offset:24576
    ds_read_b64_tr_b16 v[66:67], v2 offset:25088
    s_waitcnt vmcnt(12) lgkmcnt(6)
    v_mfma_f32_32x32x16_bf16 v[48:63], v[72:75], v[240:243], v[48:63]
    buffer_load_dwordx4 v[132:135], v1, s[4:7], s48 offen offset:2048 sc1
    ds_read_b64_tr_b16 v[68:69], v121 offset:24576
    ds_read_b64_tr_b16 v[70:71], v121 offset:25088
    v_mfma_f32_32x32x16_bf16 v[96:111], v[76:79], v[240:243], v[96:111]
    ds_read_b64_tr_b16 v[72:73], v2 offset:28672
    ds_read_b64_tr_b16 v[74:75], v2 offset:29184
    s_waitcnt vmcnt(12) lgkmcnt(6)
    v_mfma_f32_32x32x16_bf16 v[48:63], v[80:83], v[244:247], v[48:63]
    s_barrier
    ds_read_b64_tr_b16 v[76:77], v121 offset:28672
    ds_read_b64_tr_b16 v[78:79], v121 offset:29184
    v_mfma_f32_32x32x16_bf16 v[96:111], v[84:87], v[244:247], v[96:111]
    s_add_u32 s44, s44, 32768
    s_and_b32 s44, s44, 131071
    v_add_u32 v2, s44, v123
    v_xor_b32 v121, 64, v2
    ds_read_b64_tr_b16 v[80:81], v2 offset:0
    ds_read_b64_tr_b16 v[82:83], v2 offset:512
    s_waitcnt vmcnt(11) lgkmcnt(6)
    v_mfma_f32_32x32x16_bf16 v[48:63], v[64:67], v[248:251], v[48:63]
    ds_read_b64_tr_b16 v[84:85], v121 offset:0
    ds_read_b64_tr_b16 v[86:87], v121 offset:512
    v_mfma_f32_32x32x16_bf16 v[96:111], v[68:71], v[248:251], v[96:111]
    ds_read_b64_tr_b16 v[64:65], v2 offset:4096
    ds_read_b64_tr_b16 v[66:67], v2 offset:4608
    s_waitcnt vmcnt(10) lgkmcnt(6)
    v_mfma_f32_32x32x16_bf16 v[48:63], v[72:75], v[252:255], v[48:63]
    ds_read_b64_tr_b16 v[68:69], v121 offset:4096
    ds_read_b64_tr_b16 v[70:71], v121 offset:4608
    v_mfma_f32_32x32x16_bf16 v[96:111], v[76:79], v[252:255], v[96:111]
    ds_read_b64_tr_b16 v[72:73], v2 offset:8192
    ds_read_b64_tr_b16 v[74:75], v2 offset:8704
    s_waitcnt vmcnt(8) lgkmcnt(6)
    v_mfma_f32_32x32x16_bf16 v[48:63], v[80:83], v[16:19], v[48:63]
    ds_read_b64_tr_b16 v[76:77], v121 offset:8192
    ds_read_b64_tr_b16 v[78:79], v121 offset:8704
    v_mfma_f32_32x32x16_bf16 v[96:111], v[84:87], v[16:19], v[96:111]
    s_waitcnt vmcnt(2)
    v_cmp_ne_u32 vcc, s71, v125
    s_cbranch_vccnz .Lsoftx_69
.Lsoft_68:
    s_add_u32 s71, s71, 1
    v_add_u32 v12, 1, v12
    s_add_u32 s48, s84, 81920
    buffer_load_dwordx4 v[32:35], v1, s[4:7], s48 offen offset:0 sc1
    buffer_load_dwordx4 v[36:39], v1, s[4:7], s48 offen offset:2048 sc1
    s_add_u32 s48, s84, 86016
    buffer_load_dwordx4 v[40:43], v1, s[4:7], s48 offen offset:0 sc1
    ds_read_b64_tr_b16 v[80:81], v2 offset:12288
    ds_read_b64_tr_b16 v[82:83], v2 offset:12800
    s_waitcnt lgkmcnt(6)
    v_mfma_f32_32x32x16_bf16 v[48:63], v[64:67], v[20:23], v[48:63]
    ds_read_b64_tr_b16 v[84:85], v121 offset:12288
    ds_read_b64_tr_b16 v[86:87], v121 offset:12800
    v_mfma_f32_32x32x16_bf16 v[96:111], v[68:71], v[20:23], v[96:111]
    ds_read_b64_tr_b16 v[64:65], v2 offset:16384
    ds_read_b64_tr_b16 v[66:67], v2 offset:16896
    s_waitcnt lgkmcnt(6)
    v_mfma_f32_32x32x16_bf16 v[48:63], v[72:75], v[24:27], v[48:63]
    ds_read_b64_tr_b16 v[68:69], v121 offset:16384
    ds_read_b64_tr_b16 v[70:71], v121 offset:16896
.Lhsc_2_3:
.Lhp_48:
    s_cbranch_execz .Lhp_10
    v_mfma_f32_32x32x16_bf16 v[96:111], v[76:79], v[24:27], v[96:111]
    ds_read_b64_tr_b16 v[72:73], v2 offset:20480
    ds_read_b64_tr_b16 v[74:75], v2 offset:20992
    s_waitcnt lgkmcnt(6)
    v_mfma_f32_32x32x16_bf16 v[48:63], v[80:83], v[28:31], v[48:63]
    ds_read_b64_tr_b16 v[76:77], v121 offset:20480
    ds_read_b64_tr_b16 v[78:79], v121 offset:20992
    v_mfma_f32_32x32x16_bf16 v[96:111], v[84:87], v[28:31], v[96:111]
    ds_read_b64_tr_b16 v[80:81], v2 offset:24576
    ds_read_b64_tr_b16 v[82:83], v2 offset:25088
    s_waitcnt lgkmcnt(6)
    v_mfma_f32_32x32x16_bf16 v[48:63], v[64:67], v[116:119], v[48:63]
    ds_read_b64_tr_b16 v[84:85], v121 offset:24576
    ds_read_b64_tr_b16 v[86:87], v121 offset:25088
    v_mfma_f32_32x32x16_bf16 v[96:111], v[68:71], v[116:119], v[96:111]
    ds_read_b64_tr_b16 v[64:65], v2 offset:28672
    ds_read_b64_tr_b16 v[66:67], v2 offset:29184
    s_waitcnt lgkmcnt(6)
    v_mfma_f32_32x32x16_bf16 v[48:63], v[72:75], v[88:91], v[48:63]
    s_barrier
    ds_read_b64_tr_b16 v[68:69], v121 offset:28672
    ds_read_b64_tr_b16 v[70:71], v121 offset:29184
    v_mfma_f32_32x32x16_bf16 v[96:111], v[76:79], v[88:91], v[96:111]
    s_add_u32 s44, s44, 32768
    s_and_b32 s44, s44, 131071
    v_add_u32 v2, s44, v123
    v_xor_b32 v121, 64, v2
    ds_read_b64_tr_b16 v[72:73], v121 offset:0
    ds_read_b64_tr_b16 v[74:75], v121 offset:512
    s_waitcnt vmcnt(4) lgkmcnt(6)
    v_mfma_f32_32x32x16_bf16 v[48:63], v[80:83], v[128:131], v[48:63]
    ds_read_b64_tr_b16 v[76:77], v121 offset:4096
    ds_read_b64_tr_b16 v[78:79], v121 offset:4608
    v_mfma_f32_32x32x16_bf16 v[96:111], v[84:87], v[128:131], v[96:111]
    ds_read_b64_tr_b16 v[80:81], v121 offset:8192
    ds_read_b64_tr_b16 v[82:83], v121 offset:8704
    s_waitcnt vmcnt(3) lgkmcnt(6)
    v_mfma_f32_32x32x16_bf16 v[48:63], v[64:67], v[132:135], v[48:63]
    ds_read_b64_tr_b16 v[84:85], v2 offset:0
    ds_read_b64_tr_b16 v[86:87], v2 offset:512
    v_mfma_f32_32x32x16_bf16 v[96:111], v[68:71], v[132:135], v[96:111]
    ds_read_b64_tr_b16 v[64:65], v2 offset:4096
    ds_read_b64_tr_b16 v[66:67], v2 offset:4608
    s_waitcnt vmcnt(2) lgkmcnt(6)
    v_mfma_f32_32x32x16_bf16 v[96:111], v[72:75], v[32:35], v[96:111]
    ds_read_b64_tr_b16 v[68:69], v2 offset:8192
    ds_read_b64_tr_b16 v[70:71], v2 offset:8704
    s_waitcnt vmcnt(1)
    v_mfma_f32_32x32x16_bf16 v[96:111], v[76:79], v[36:39], v[96:111]
    s_waitcnt vmcnt(0) lgkmcnt(4)
    v_mfma_f32_32x32x16_bf16 v[96:111], v[80:83], v[40:43], v[96:111]
    v_mfma_f32_32x32x16_bf16 v[48:63], v[84:87], v[32:35], v[48:63]
    s_nop 10
    ds_write_b128 v126, v[96:99] offset:0
    ds_write_b128 v126, v[100:103] offset:1024
    ds_write_b128 v126, v[104:107] offset:2048
    ds_write_b128 v126, v[108:111] offset:3072
    s_waitcnt lgkmcnt(4)
    v_mfma_f32_32x32x16_bf16 v[48:63], v[64:67], v[36:39], v[48:63]
    v_mfma_f32_32x32x16_bf16 v[48:63], v[68:71], v[40:43], v[48:63]
    v_xor_b32 v126, 4096, v126
    s_waitcnt lgkmcnt(0)
    s_barrier
    ds_read_b128 v[16:19], v126 offset:0
    ds_read_b128 v[20:23], v126 offset:1024
    ds_read_b128 v[24:27], v126 offset:2048
    ds_read_b128 v[28:31], v126 offset:3072
    v_and_b32 v126, 31, v0
    v_lshlrev_b32 v126, 4, v126
    v_lshrrev_b32 v13, 5, v0
    v_lshl_add_u32 v126, v13, 2, v126
    s_waitcnt lgkmcnt(3)
    v_pk_add_f32 v[48:49], v[48:49], v[16:17] op_sel:[0,0] op_sel_hi:[1,1]
    s_nop 0
    v_pk_add_f32 v[50:51], v[50:51], v[18:19] op_sel:[0,0] op_sel_hi:[1,1]
    v_cvt_pk_bf16_f32 v4, v48, v49
    v_cvt_pk_bf16_f32 v5, v50, v51
    s_waitcnt lgkmcnt(2)
    v_pk_add_f32 v[52:53], v[52:53], v[20:21] op_sel:[0,0] op_sel_hi:[1,1]
    v_pk_add_f32 v[54:55], v[54:55], v[22:23] op_sel:[0,0] op_sel_hi:[1,1]
    v_cvt_pk_bf16_f32 v6, v52, v53
    v_cvt_pk_bf16_f32 v7, v54, v55
    s_waitcnt lgkmcnt(1)
    v_pk_add_f32 v[56:57], v[56:57], v[24:25] op_sel:[0,0] op_sel_hi:[1,1]
    v_pk_add_f32 v[58:59], v[58:59], v[26:27] op_sel:[0,0] op_sel_hi:[1,1]
    v_cvt_pk_bf16_f32 v8, v56, v57
    v_cvt_pk_bf16_f32 v9, v58, v59
    s_waitcnt lgkmcnt(0)
    v_pk_add_f32 v[60:61], v[60:61], v[28:29] op_sel:[0,0] op_sel_hi:[1,1]
    v_pk_add_f32 v[62:63], v[62:63], v[30:31] op_sel:[0,0] op_sel_hi:[1,1]
    v_cvt_pk_bf16_f32 v10, v60, v61
    v_cvt_pk_bf16_f32 v11, v62, v63
    s_cmp_eq_u32 s73, 1
    s_cbranch_scc1 .Lfin_72
    buffer_store_dwordx4 v[4:7], v1, s[4:7], s77 offen offset:0
    buffer_store_dwordx4 v[8:11], v1, s[4:7], s77 offen offset:1024
    v_dot2_f32_bf16 v48, v4, s97, 0
    v_dot2_f32_bf16 v49, v4, v4, 0
    v_dot2_f32_bf16 v50, v5, s97, 0
    v_dot2_f32_bf16 v51, v5, v5, 0
    v_dot2_f32_bf16 v48, v6, s97, v48
    v_dot2_f32_bf16 v49, v6, v6, v49
    v_dot2_f32_bf16 v50, v7, s97, v50
    v_dot2_f32_bf16 v51, v7, v7, v51
    v_dot2_f32_bf16 v48, v8, s97, v48
    v_dot2_f32_bf16 v49, v8, v8, v49
    v_dot2_f32_bf16 v50, v9, s97, v50
    v_dot2_f32_bf16 v51, v9, v9, v51
    v_dot2_f32_bf16 v48, v10, s97, v48
    v_dot2_f32_bf16 v49, v10, v10, v49
    v_dot2_f32_bf16 v50, v11, s97, v50
    v_dot2_f32_bf16 v51, v11, v11, v51
    s_nop 2
    v_pk_add_f32 v[48:49], v[48:49], v[50:51] op_sel:[0,0] op_sel_hi:[1,1]
    s_nop 1
    v_permlane32_swap_b32 v48, v49
    v_add_f32 v48, v48, v49
    buffer_store_dword v48, v126, s[4:7], s78 offen
    s_add_u32 s44, s44, 32768
    s_and_b32 s44, s44, 131071
    v_add_u32 v2, s44, v122
    v_xor_b32 v121, 64, v2
    v_lshrrev_b32 v15, 5, v0
    v_lshlrev_b32 v15, 11, v15
    v_and_b32 v14, 31, v0
    v_lshl_add_u32 v15, v14, 4, v15
    s_waitcnt vmcnt(0)
    buffer_store_dword v12, off, s[4:7], s79
    s_mov_b32 s73, 1
    s_branch .Lpair_f
.Lfin_72:
    v_and_b32 v126, 31, v0
    v_lshlrev_b32 v126, 10, v126
    v_lshrrev_b32 v13, 5, v0
    v_lshl_add_u32 v126, v13, 4, v126
    buffer_store_dwordx4 v[4:7], v126, s[12:15], s98 offen
    buffer_store_dwordx4 v[8:11], v126, s[12:15], s98 offen offset:32
    s_or_b32 s92, s2, s3
    s_cmp_lg_u32 s92, 0
    s_cbranch_scc1 .Lend
    v_add_u32 v12, 22, v12
    buffer_store_dword v12, off, s[4:7], 0 offset:0 sc1
    s_branch .Lend
.Lld0:
    v_lshrrev_b32 v13, 3, v0
    v_bfe_u32 v14, v0, 4, 1
    v_lshlrev_b32 v14, 2, v14
    v_and_b32 v15, 7, v0
    v_xor_b32 v14, v14, v15
    v_mul_u32_u24 v2, 3072, v13
    v_and_b32 v15, 3, v14
    v_lshl_add_u32 v2, v15, 4, v2
    v_lshrrev_b32 v15, 2, v14
    v_mul_u32_u24 v4, 786432, v15
    v_add_u32 v4, v4, v2
    s_nop 0
    v_lshl_add_u32 v2, v15, 10, v2
    v_add_u32 v2, 1024, v2
    v_lshlrev_b32 v5, 10, v13
    v_lshl_add_u32 v5, v14, 4, v5
    s_lshl_b32 s74, s70, 13
    s_mul_i32 s75, s70, 196608
    s_lshl_b32 s92, s67, 6
    s_add_u32 s75, s75, s92
    s_mov_b32 s89, 0
    s_add_u32 s89, s89, s70
    s_lshl_b32 s88, s67, 6
    s_and_b32 s93, s89, 7
    s_mul_i32 s84, s93, 196608
    s_add_u32 s84, s84, s88
    s_and_b32 s79, s66, 1
    s_lshl_b32 s79, s79, 4
    s_add_u32 s79, s79, s67
    s_lshl_b32 s79, s79, 2
    s_add_u32 s79, s79, s70
    s_waitcnt lgkmcnt(0)
    s_mov_b32 s16, s46
    s_and_b32 s17, s47, 65535
    s_mov_b32 s4, s64
    s_and_b32 s5, s65, 65535
    s_mov_b32 s20, s48
    s_and_b32 s21, s49, 65535
    s_mov_b32 s24, s50
    s_and_b32 s25, s51, 65535
    s_mov_b32 s28, s54
    s_and_b32 s29, s55, 65535
    s_mov_b32 s32, s56
    s_and_b32 s33, s57, 65535
    s_mov_b32 s36, s58
    s_and_b32 s37, s59, 65535
    s_mov_b32 s12, s60
    s_and_b32 s13, s61, 65535
    s_mul_i32 s90, s79, 3072
    s_add_u32 s100, s46, s90
    s_addc_u32 s101, s47, 0
    s_load_dwordx2 s[86:87], s[100:101], 0x5bc
    s_load_dwordx2 s[86:87], s[100:101], 0x9bc
    s_load_dwordx2 s[86:87], s[100:101], 0x605bc
    s_load_dwordx2 s[86:87], s[100:101], 0x609bc
    s_lshr_b32 s90, s79, 4
    s_mul_i32 s90, s90, 3072
    s_and_b32 s91, s79, 15
    s_lshl_b32 s91, s91, 7
    s_add_u32 s91, s91, s90
    s_add_u32 s44, s46, s91
    s_addc_u32 s45, s47, 0
    s_load_dwordx2 s[86:87], s[44:45], 0x43c
    s_load_dwordx2 s[86:87], s[44:45], 0x643c
    s_load_dwordx2 s[86:87], s[44:45], 0xc43c
    s_load_dwordx2 s[86:87], s[44:45], 0x1243c
    s_load_dwordx2 s[86:87], s[44:45], 0x1843c
    s_load_dwordx2 s[86:87], s[44:45], 0x1e43c
    s_load_dwordx2 s[86:87], s[44:45], 0x2443c
    s_load_dwordx2 s[86:87], s[44:45], 0x2a43c
    s_load_dwordx2 s[86:87], s[44:45], 0x3043c
    s_load_dwordx2 s[86:87], s[44:45], 0x3643c
    s_load_dwordx2 s[86:87], s[44:45], 0x3c43c
    s_load_dwordx2 s[86:87], s[44:45], 0x4243c
    s_load_dwordx2 s[86:87], s[44:45], 0x4843c
    s_load_dwordx2 s[86:87], s[44:45], 0x4e43c
    s_load_dwordx2 s[86:87], s[44:45], 0x5443c
    s_load_dwordx2 s[86:87], s[44:45], 0x5a43c
    s_load_dwordx2 s[86:87], s[44:45], 0x6043c
    s_add_u32 m0, s74, 0
    s_add_u32 s92, s84, 0
    buffer_load_dwordx4 v2, s[16:19], s92 offen lds
    s_add_u32 m0, s74, 1024
    s_add_u32 s92, s84, 24576
    buffer_load_dwordx4 v2, s[16:19], s92 offen lds
    s_add_u32 m0, s74, 2048
    s_add_u32 s92, s84, 49152
    buffer_load_dwordx4 v2, s[16:19], s92 offen lds
    s_add_u32 m0, s74, 3072
    s_add_u32 s92, s84, 73728
    buffer_load_dwordx4 v2, s[16:19], s92 offen lds
    s_add_u32 m0, s74, 4096
    s_nop 0
    s_add_u32 s92, s84, 98304
    buffer_load_dwordx4 v2, s[16:19], s92 offen lds
    s_add_u32 m0, s74, 5120
    s_add_u32 s92, s84, 122880
    buffer_load_dwordx4 v2, s[16:19], s92 offen lds
    s_add_u32 m0, s74, 6144
    s_add_u32 s92, s84, 147456
    buffer_load_dwordx4 v2, s[16:19], s92 offen lds
    s_add_u32 m0, s74, 7168
    s_add_u32 s92, s84, 172032
    buffer_load_dwordx4 v2, s[16:19], s92 offen lds
    buffer_load_dword v12, off, s[4:7], 0 offset:0 sc1
    s_lshl_b32 s92, s67, 10
    buffer_load_dwordx4 v[56:59], v1, s[20:23], s92 offen
    s_lshl_b32 s76, s70, 16
    s_lshl_b32 s92, s69, 7
    s_add_u32 s76, s76, s92
    s_lshl_b32 s93, s70, 2
    s_add_u32 s93, s93, 0
    s_mul_i32 s94, s93, 6
    s_mul_i32 s95, s93, 5
    s_add_u32 s95, s95, 6
    s_min_u32 s94, s94, s95
    s_lshl_b32 s94, s94, 14
    s_add_u32 s80, s94, s92
    s_lshl_b32 s93, s70, 2
    s_add_u32 s93, s93, 1
    s_mul_i32 s94, s93, 6
    s_mul_i32 s95, s93, 5
    s_add_u32 s95, s95, 6
    s_min_u32 s94, s94, s95
    s_lshl_b32 s94, s94, 14
    s_add_u32 s81, s94, s92
    s_lshl_b32 s93, s70, 2
    s_add_u32 s93, s93, 2
    s_mul_i32 s94, s93, 6
    s_mul_i32 s95, s93, 5
    s_add_u32 s95, s95, 6
    s_min_u32 s94, s94, s95
    s_lshl_b32 s94, s94, 14
    s_add_u32 s82, s94, s92
    s_lshl_b32 s93, s70, 2
    s_add_u32 s93, s93, 3
    s_mul_i32 s94, s93, 6
    s_mul_i32 s95, s93, 5
    s_add_u32 s95, s95, 6
    s_min_u32 s94, s94, s95
    s_lshl_b32 s94, s94, 14
    s_add_u32 s83, s94, s92
    s_add_u32 s78, s92, 81920
    s_mul_i32 s94, s67, 6
    s_mul_i32 s95, s67, 5
    s_add_u32 s95, s95, 6
    s_min_u32 s94, s94, s95
    s_lshl_b32 s94, s94, 5
    s_mul_i32 s77, s70, 44032
    s_add_u32 s77, s77, s94
    s_lshr_b32 s96, s66, 1
    s_cmp_eq_u32 s99, 1
    s_cselect_b32 s93, 12, 10
    s_lshl_b32 s94, s70, 12
    s_add_u32 s94, s94, 32768
    v_add_u32 v13, 0, v0
    v_mul_u32_u24 v14, 5462, v13
    v_lshrrev_b32 v14, 16, v14
    v_mul_u32_u24 v15, 12, v14
    v_sub_u32 v13, v13, v15
    v_mul_u32_u24 v8, 2752, v14
    v_lshl_add_u32 v8, v13, 4, v8
    v_cmp_gt_u32 vcc, s93, v13
    v_mov_b32 v15, 2147483648
    s_nop 0
    v_cndmask_b32 v8, v15, v8, vcc
    v_and_b32 v15, 7, v14
    v_mul_u32_u24 v16, 448, v15
    v_lshrrev_b32 v15, 3, v14
    v_lshl_add_u32 v16, v15, 14, v16
    v_lshl_add_u32 v16, v13, 4, v16
    v_add_u32 v16, s94, v16
    v_add_u32 v13, 64, v0
    v_mul_u32_u24 v14, 5462, v13
    v_lshrrev_b32 v14, 16, v14
    v_mul_u32_u24 v15, 12, v14
    v_sub_u32 v13, v13, v15
    v_mul_u32_u24 v9, 2752, v14
    v_lshl_add_u32 v9, v13, 4, v9
    v_cmp_gt_u32 vcc, s93, v13
    v_mov_b32 v15, 2147483648
    s_nop 0
    v_cndmask_b32 v9, v15, v9, vcc
    v_and_b32 v15, 7, v14
    v_mul_u32_u24 v17, 448, v15
    v_lshrrev_b32 v15, 3, v14
    v_lshl_add_u32 v17, v15, 14, v17
    v_lshl_add_u32 v17, v13, 4, v17
    v_add_u32 v17, s94, v17
    v_add_u32 v13, 128, v0
    s_nop 0
    v_mul_u32_u24 v14, 5462, v13
    v_lshrrev_b32 v14, 16, v14
    v_mul_u32_u24 v15, 12, v14
    v_sub_u32 v13, v13, v15
    v_mul_u32_u24 v10, 2752, v14
    v_lshl_add_u32 v10, v13, 4, v10
    v_cmp_gt_u32 vcc, s93, v13
    v_mov_b32 v15, 2147483648
    s_nop 0
    v_cndmask_b32 v10, v15, v10, vcc
    v_and_b32 v15, 7, v14
    v_mul_u32_u24 v18, 448, v15
    v_lshrrev_b32 v15, 3, v14
    v_lshl_add_u32 v18, v15, 14, v18
    v_lshl_add_u32 v18, v13, 4, v18
    v_add_u32 v18, s94, v18
    v_bfe_u32 v19, v0, 2, 2
    v_mul_u32_u24 v19, 448, v19
    v_lshrrev_b32 v13, 5, v0
    v_lshl_add_u32 v19, v13, 14, v19
    v_and_b32 v13, 1, v0
    v_lshl_add_u32 v19, v13, 4, v19
    v_bfe_u32 v13, v0, 1, 1
    v_lshl_add_u32 v19, v13, 3, v19
    v_bfe_u32 v13, v0, 4, 1
    v_lshl_add_u32 v19, v13, 5, v19
    v_add_u32 v19, s94, v19
    v_bfe_u32 v13, v0, 4, 1
    v_mul_u32_u24 v13, 192, v13
    v_add_u32 v19, v13, v19
    v_bfe_u32 v20, v0, 2, 2
    v_lshlrev_b32 v20, 7, v20
    v_lshrrev_b32 v13, 5, v0
    v_lshl_add_u32 v20, v13, 10, v20
    v_and_b32 v13, 1, v0
    v_lshl_add_u32 v20, v13, 5, v20
    v_bfe_u32 v13, v0, 1, 1
    v_lshl_add_u32 v20, v13, 3, v20
    v_bfe_u32 v13, v0, 4, 1
    v_lshl_add_u32 v20, v13, 4, v20
    v_bfe_u32 v13, v0, 3, 1
    v_lshl_add_u32 v20, v13, 6, v20
    v_xor_b32 v21, 64, v20
    s_lshl_b32 s92, s70, 10
    v_add_u32 v6, s92, v1
    v_add_u32 v7, 65536, v6
    v_bfe_u32 v13, v0, 4, 1
    v_and_b32 v14, 1, v0
    v_cmp_eq_u32 vcc, v13, v14
    v_mov_b32 v15, 1065369472
    s_nop 0
    v_cndmask_b32 v24, 0, v15, vcc
    v_cndmask_b32 v25, 0, v15, vcc
    v_cndmask_b32 v26, 0, v15, vcc
    v_cndmask_b32 v27, 0, v15, vcc
    v_lshlrev_b32 v22, 6, v13
    v_lshl_add_u32 v22, v14, 5, v22
    v_lshrrev_b32 v13, 5, v0
    v_lshl_add_u32 v22, v13, 4, v22
    s_xor_b32 s93, s89, 4
    s_and_b32 s93, s93, 7
    s_mul_i32 s85, s93, 196608
    s_add_u32 s85, s85, s88
    s_add_u32 m0, s74, 32768
    s_add_u32 s92, s85, 0
    buffer_load_dwordx4 v2, s[16:19], s92 offen lds
    s_add_u32 m0, s74, 33792
    s_add_u32 s92, s85, 24576
    buffer_load_dwordx4 v2, s[16:19], s92 offen lds
    s_add_u32 m0, s74, 34816
    s_add_u32 s92, s85, 49152
    buffer_load_dwordx4 v2, s[16:19], s92 offen lds
    s_add_u32 m0, s74, 35840
    s_add_u32 s92, s85, 73728
    buffer_load_dwordx4 v2, s[16:19], s92 offen lds
    s_add_u32 m0, s74, 36864
    s_add_u32 s92, s85, 98304
    buffer_load_dwordx4 v2, s[16:19], s92 offen lds
    s_add_u32 m0, s74, 37888
    s_nop 0
    s_add_u32 s92, s85, 122880
    buffer_load_dwordx4 v2, s[16:19], s92 offen lds
    s_add_u32 m0, s74, 38912
    s_add_u32 s92, s85, 147456
    buffer_load_dwordx4 v2, s[16:19], s92 offen lds
    s_add_u32 m0, s74, 39936
    s_add_u32 s92, s85, 172032
    buffer_load_dwordx4 v2, s[16:19], s92 offen lds
    s_mul_i32 s90, s79, 3072
    s_add_u32 s100, s46, s90
    s_addc_u32 s101, s47, 0
    s_load_dwordx2 s[86:87], s[100:101], 0x1bc
    s_load_dwordx2 s[86:87], s[100:101], 0x601bc
    s_load_dwordx2 s[86:87], s[100:101], 0xc01bc
    s_add_u32 s100, s100, 1048576
    s_addc_u32 s101, s101, 0
    s_load_dwordx2 s[86:87], s[100:101], 0x201bc
    s_waitcnt vmcnt(10)
    s_barrier
    v_add_u32 v13, s84, v4
    v_subrev_u32 v14, 1572864, v13
    v_min_u32 v64, v13, v14
    s_add_u32 m0, s74, 65536
    s_add_u32 s92, 0, 0
    buffer_load_dwordx4 v64, s[16:19], s92 offen lds
    s_add_u32 m0, s74, 66560
    s_add_u32 s92, 0, 24576
    buffer_load_dwordx4 v64, s[16:19], s92 offen lds
    s_add_u32 m0, s74, 67584
    s_add_u32 s92, 0, 49152
    buffer_load_dwordx4 v64, s[16:19], s92 offen lds
    s_add_u32 m0, s74, 68608
    s_add_u32 s92, 0, 73728
    buffer_load_dwordx4 v64, s[16:19], s92 offen lds
    s_add_u32 m0, s74, 69632
    s_add_u32 s92, 0, 98304
    buffer_load_dwordx4 v64, s[16:19], s92 offen lds
    s_add_u32 m0, s74, 70656
    s_add_u32 s92, 0, 122880
    buffer_load_dwordx4 v64, s[16:19], s92 offen lds
    s_add_u32 m0, s74, 71680
    s_add_u32 s92, 0, 147456
    buffer_load_dwordx4 v64, s[16:19], s92 offen lds
    s_add_u32 m0, s74, 72704
    s_add_u32 s92, 0, 172032
    buffer_load_dwordx4 v64, s[16:19], s92 offen lds
    s_lshl_b32 s92, s70, 6
    v_xor_b32 v23, s92, v20
    s_sub_u32 s92, s70, 0
    s_cmp_ge_u32 s92, 2
    s_cbranch_scc1 .Lcs_73
    ds_read_b64_tr_b16 v[36:37], v23 offset:0
    ds_read_b64_tr_b16 v[38:39], v23 offset:512
    ds_read_b64_tr_b16 v[40:41], v23 offset:2048
    ds_read_b64_tr_b16 v[42:43], v23 offset:2560
    ds_read_b64_tr_b16 v[44:45], v23 offset:4096
    ds_read_b64_tr_b16 v[46:47], v23 offset:4608
    ds_read_b64_tr_b16 v[48:49], v23 offset:6144
    ds_read_b64_tr_b16 v[50:51], v23 offset:6656
    s_waitcnt lgkmcnt(6)
    v_mfma_f32_16x16x32_bf16 v[28:31], v[36:39], v[24:27], 0
    ds_read_b64_tr_b16 v[52:53], v23 offset:8192
    ds_read_b64_tr_b16 v[54:55], v23 offset:8704
    s_waitcnt lgkmcnt(6)
    v_mfma_f32_16x16x32_bf16 v[32:35], v[40:43], v[24:27], 0
    ds_read_b64_tr_b16 v[36:37], v23 offset:10240
    ds_read_b64_tr_b16 v[38:39], v23 offset:10752
    s_waitcnt lgkmcnt(6)
    v_mfma_f32_16x16x32_bf16 v[28:31], v[44:47], v[24:27], v[28:31]
    ds_read_b64_tr_b16 v[40:41], v23 offset:12288
    ds_read_b64_tr_b16 v[42:43], v23 offset:12800
    s_waitcnt lgkmcnt(6)
    s_nop 0
    v_mfma_f32_16x16x32_bf16 v[32:35], v[48:51], v[24:27], v[32:35]
    ds_read_b64_tr_b16 v[44:45], v23 offset:14336
    ds_read_b64_tr_b16 v[46:47], v23 offset:14848
    s_waitcnt lgkmcnt(6)
    v_mfma_f32_16x16x32_bf16 v[28:31], v[52:55], v[24:27], v[28:31]
    ds_read_b64_tr_b16 v[48:49], v23 offset:16384
    ds_read_b64_tr_b16 v[50:51], v23 offset:16896
    s_waitcnt lgkmcnt(6)
    v_mfma_f32_16x16x32_bf16 v[32:35], v[36:39], v[24:27], v[32:35]
    ds_read_b64_tr_b16 v[52:53], v23 offset:18432
    ds_read_b64_tr_b16 v[54:55], v23 offset:18944
    s_waitcnt lgkmcnt(6)
    v_mfma_f32_16x16x32_bf16 v[28:31], v[40:43], v[24:27], v[28:31]
    ds_read_b64_tr_b16 v[36:37], v23 offset:20480
    ds_read_b64_tr_b16 v[38:39], v23 offset:20992
    s_waitcnt lgkmcnt(6)
    v_mfma_f32_16x16x32_bf16 v[32:35], v[44:47], v[24:27], v[32:35]
    ds_read_b64_tr_b16 v[40:41], v23 offset:22528
    ds_read_b64_tr_b16 v[42:43], v23 offset:23040
    s_waitcnt lgkmcnt(6)
    v_mfma_f32_16x16x32_bf16 v[28:31], v[48:51], v[24:27], v[28:31]
    ds_read_b64_tr_b16 v[44:45], v23 offset:24576
    ds_read_b64_tr_b16 v[46:47], v23 offset:25088
    s_waitcnt lgkmcnt(6)
    v_mfma_f32_16x16x32_bf16 v[32:35], v[52:55], v[24:27], v[32:35]
    ds_read_b64_tr_b16 v[48:49], v23 offset:26624
    ds_read_b64_tr_b16 v[50:51], v23 offset:27136
    s_waitcnt lgkmcnt(6)
    v_mfma_f32_16x16x32_bf16 v[28:31], v[36:39], v[24:27], v[28:31]
    ds_read_b64_tr_b16 v[52:53], v23 offset:28672
    ds_read_b64_tr_b16 v[54:55], v23 offset:29184
    s_waitcnt lgkmcnt(6)
    v_mfma_f32_16x16x32_bf16 v[32:35], v[40:43], v[24:27], v[32:35]
    ds_read_b64_tr_b16 v[36:37], v23 offset:30720
    ds_read_b64_tr_b16 v[38:39], v23 offset:31232
    s_waitcnt lgkmcnt(6)
    v_mfma_f32_16x16x32_bf16 v[28:31], v[44:47], v[24:27], v[28:31]
    s_waitcnt lgkmcnt(4)
    v_mfma_f32_16x16x32_bf16 v[32:35], v[48:51], v[24:27], v[32:35]
    s_waitcnt lgkmcnt(2)
    v_mfma_f32_16x16x32_bf16 v[28:31], v[52:55], v[24:27], v[28:31]
    s_waitcnt lgkmcnt(0)
    v_mfma_f32_16x16x32_bf16 v[32:35], v[36:39], v[24:27], v[32:35]
.Lcs_73:
    s_waitcnt lgkmcnt(0)
    s_mul_i32 s90, s79, 1024
    s_add_u32 s100, s50, s90
    s_addc_u32 s101, s51, 0
    s_load_dwordx2 s[86:87], s[100:101], 0x1bc
    s_load_dwordx2 s[86:87], s[100:101], 0x201bc
    s_load_dwordx2 s[86:87], s[100:101], 0x401bc
    s_load_dwordx2 s[86:87], s[100:101], 0x601bc
    s_waitcnt vmcnt(8)
    s_barrier
    s_lshl_b32 s92, s70, 7
    s_add_u32 s92, s92, 162048
    v_add_u32 v15, s92, v22
    s_sub_u32 s92, s70, 0
    s_cmp_ge_u32 s92, 2
    s_cbranch_scc1 .Lcs_74
    ds_read_b64_tr_b16 v[36:37], v23 offset:32768
    ds_read_b64_tr_b16 v[38:39], v23 offset:33280
    ds_read_b64_tr_b16 v[40:41], v23 offset:34816
    ds_read_b64_tr_b16 v[42:43], v23 offset:35328
    ds_read_b64_tr_b16 v[44:45], v23 offset:36864
    ds_read_b64_tr_b16 v[46:47], v23 offset:37376
    ds_read_b64_tr_b16 v[48:49], v23 offset:38912
    ds_read_b64_tr_b16 v[50:51], v23 offset:39424
    s_waitcnt lgkmcnt(6)
    v_mfma_f32_16x16x32_bf16 v[28:31], v[36:39], v[24:27], v[28:31]
    ds_read_b64_tr_b16 v[52:53], v23 offset:40960
    ds_read_b64_tr_b16 v[54:55], v23 offset:41472
    s_waitcnt lgkmcnt(6)
    v_mfma_f32_16x16x32_bf16 v[32:35], v[40:43], v[24:27], v[32:35]
    ds_read_b64_tr_b16 v[36:37], v23 offset:43008
    ds_read_b64_tr_b16 v[38:39], v23 offset:43520
    s_waitcnt lgkmcnt(6)
    s_nop 0
    v_mfma_f32_16x16x32_bf16 v[28:31], v[44:47], v[24:27], v[28:31]
    ds_read_b64_tr_b16 v[40:41], v23 offset:45056
    ds_read_b64_tr_b16 v[42:43], v23 offset:45568
    s_waitcnt lgkmcnt(6)
    v_mfma_f32_16x16x32_bf16 v[32:35], v[48:51], v[24:27], v[32:35]
    ds_read_b64_tr_b16 v[44:45], v23 offset:47104
    ds_read_b64_tr_b16 v[46:47], v23 offset:47616
    s_waitcnt lgkmcnt(6)
    v_mfma_f32_16x16x32_bf16 v[28:31], v[52:55], v[24:27], v[28:31]
    ds_read_b64_tr_b16 v[48:49], v23 offset:49152
    ds_read_b64_tr_b16 v[50:51], v23 offset:49664
    s_waitcnt lgkmcnt(6)
    v_mfma_f32_16x16x32_bf16 v[32:35], v[36:39], v[24:27], v[32:35]
    ds_read_b64_tr_b16 v[52:53], v23 offset:51200
    ds_read_b64_tr_b16 v[54:55], v23 offset:51712
    s_waitcnt lgkmcnt(6)
    v_mfma_f32_16x16x32_bf16 v[28:31], v[40:43], v[24:27], v[28:31]
    ds_read_b64_tr_b16 v[36:37], v23 offset:53248
    ds_read_b64_tr_b16 v[38:39], v23 offset:53760
    s_waitcnt lgkmcnt(6)
    v_mfma_f32_16x16x32_bf16 v[32:35], v[44:47], v[24:27], v[32:35]
    ds_read_b64_tr_b16 v[40:41], v23 offset:55296
    ds_read_b64_tr_b16 v[42:43], v23 offset:55808
    s_waitcnt lgkmcnt(6)
    v_mfma_f32_16x16x32_bf16 v[28:31], v[48:51], v[24:27], v[28:31]
    ds_read_b64_tr_b16 v[44:45], v23 offset:57344
    ds_read_b64_tr_b16 v[46:47], v23 offset:57856
    s_waitcnt lgkmcnt(6)
    v_mfma_f32_16x16x32_bf16 v[32:35], v[52:55], v[24:27], v[32:35]
    ds_read_b64_tr_b16 v[48:49], v23 offset:59392
    ds_read_b64_tr_b16 v[50:51], v23 offset:59904
    s_waitcnt lgkmcnt(6)
    v_mfma_f32_16x16x32_bf16 v[28:31], v[36:39], v[24:27], v[28:31]
    ds_read_b64_tr_b16 v[52:53], v23 offset:61440
    ds_read_b64_tr_b16 v[54:55], v23 offset:61952
    s_waitcnt lgkmcnt(6)
    v_mfma_f32_16x16x32_bf16 v[32:35], v[40:43], v[24:27], v[32:35]
    ds_read_b64_tr_b16 v[36:37], v23 offset:63488
    ds_read_b64_tr_b16 v[38:39], v23 offset:64000
    s_waitcnt lgkmcnt(6)
    v_mfma_f32_16x16x32_bf16 v[28:31], v[44:47], v[24:27], v[28:31]
    s_waitcnt lgkmcnt(4)
    v_mfma_f32_16x16x32_bf16 v[32:35], v[48:51], v[24:27], v[32:35]
    s_waitcnt lgkmcnt(2)
    v_mfma_f32_16x16x32_bf16 v[28:31], v[52:55], v[24:27], v[28:31]
    s_waitcnt lgkmcnt(0)
    v_mfma_f32_16x16x32_bf16 v[32:35], v[36:39], v[24:27], v[32:35]
    s_nop 7
    v_add_f32 v28, v28, v32
    v_add_f32 v29, v29, v33
    v_add_f32 v30, v30, v34
    v_add_f32 v31, v31, v35
    ds_write_b128 v15, v[28:31]
.Lcs_74:
    v_bfe_u32 v13, v0, 3, 2
    v_mul_u32_u24 v13, 576, v13
    v_lshrrev_b32 v14, 5, v0
    v_lshl_add_u32 v13, v14, 7, v13
    v_and_b32 v14, 112, v1
    v_add_u32 v13, v13, v14
    v_add_u32 v13, 159744, v13
    ds_write_b128 v13, v[56:59]
    s_lshl_b32 s95, s3, 2
    s_add_u32 s95, s95, 163216
    v_mov_b32 v13, s95
    v_mov_b32 v14, 1
    ds_write_b32 v13, v14
    v_add_u32 v12, s40, v12
    v_add_u32 v12, 16, v12
    s_lshl_b32 s92, s66, 7
    s_lshl_b32 s93, s67, 2
    s_add_u32 s92, s92, s93
    s_add_u32 s92, s92, 4096
    s_cmp_lg_u32 s70, 0
    s_cbranch_scc1 .Lpub_75
    buffer_store_dword v12, off, s[4:7], s92 sc1
.Lpub_75:
    s_xor_b32 s48, s96, 0
    s_mul_i32 s48, s48, 176128
    s_add_u32 s48, s48, s77
    buffer_load_dwordx4 v[64:67], v8, s[28:31], s48 offen
    buffer_load_dwordx4 v[68:71], v9, s[28:31], s48 offen
    s_nop 0
    buffer_load_dwordx4 v[72:75], v10, s[28:31], s48 offen
    s_xor_b32 s48, s96, 0
    s_mul_i32 s48, s48, 176128
    s_add_u32 s48, s48, s77
    buffer_load_dwordx4 v[76:79], v8, s[32:35], s48 offen
    buffer_load_dwordx4 v[80:83], v9, s[32:35], s48 offen
    buffer_load_dwordx4 v[84:87], v10, s[32:35], s48 offen
    s_xor_b32 s48, s96, 1
    s_mul_i32 s48, s48, 176128
    s_add_u32 s48, s48, s77
    buffer_load_dwordx4 v[88:91], v8, s[28:31], s48 offen
    buffer_load_dwordx4 v[92:95], v9, s[28:31], s48 offen
    s_waitcnt vmcnt(8)
    s_nop 0
    s_lshl_b32 s95, s3, 2
    s_add_u32 s95, s95, 163232
    v_mov_b32 v13, s95
    v_mov_b32 v14, 1
    ds_write_b32 v13, v14
    s_cmp_lg_u32 s70, 2
    s_cbranch_scc1 .Lsq_76
    v_mov_b32 v14, 1
    v_and_b32 v13, 12, v3
    v_add_u32 v13, 163248, v13
.Lsig_77:
    ds_read_b32 v15, v13
    s_waitcnt lgkmcnt(0)
    v_cmp_ne_u32 vcc, v14, v15
    s_cbranch_vccz .Lsigd_78
    s_sub_u32 s72, s72, 1
    s_cbranch_scc0 .Lsig_77
    s_mov_b32 s72, 0
.Lsigd_78:
.Lsq_76:
    v_add_u32 v13, 65536, v20
    v_add_u32 v14, 65536, v21
    v_add_u32 v15, 162304, v22
    s_sub_u32 s92, s70, 2
    s_cmp_ge_u32 s92, 1
    s_cbranch_scc1 .Lcs_79
    ds_read_b64_tr_b16 v[36:37], v13 offset:0
    ds_read_b64_tr_b16 v[38:39], v13 offset:512
    ds_read_b64_tr_b16 v[40:41], v14 offset:0
    ds_read_b64_tr_b16 v[42:43], v14 offset:512
    ds_read_b64_tr_b16 v[44:45], v13 offset:2048
    ds_read_b64_tr_b16 v[46:47], v13 offset:2560
    ds_read_b64_tr_b16 v[48:49], v14 offset:2048
    ds_read_b64_tr_b16 v[50:51], v14 offset:2560
    s_waitcnt lgkmcnt(6)
    v_mfma_f32_16x16x32_bf16 v[28:31], v[36:39], v[24:27], 0
    ds_read_b64_tr_b16 v[52:53], v13 offset:4096
    ds_read_b64_tr_b16 v[54:55], v13 offset:4608
    s_waitcnt lgkmcnt(6)
    v_mfma_f32_16x16x32_bf16 v[32:35], v[40:43], v[24:27], 0
    ds_read_b64_tr_b16 v[36:37], v14 offset:4096
    ds_read_b64_tr_b16 v[38:39], v14 offset:4608
    s_waitcnt lgkmcnt(6)
    v_mfma_f32_16x16x32_bf16 v[28:31], v[44:47], v[24:27], v[28:31]
    ds_read_b64_tr_b16 v[40:41], v13 offset:6144
    ds_read_b64_tr_b16 v[42:43], v13 offset:6656
    s_waitcnt lgkmcnt(6)
    v_mfma_f32_16x16x32_bf16 v[32:35], v[48:51], v[24:27], v[32:35]
    ds_read_b64_tr_b16 v[44:45], v14 offset:6144
    ds_read_b64_tr_b16 v[46:47], v14 offset:6656
    s_waitcnt lgkmcnt(6)
    v_mfma_f32_16x16x32_bf16 v[28:31], v[52:55], v[24:27], v[28:31]
    ds_read_b64_tr_b16 v[48:49], v13 offset:8192
    ds_read_b64_tr_b16 v[50:51], v13 offset:8704
    s_waitcnt lgkmcnt(6)
    v_mfma_f32_16x16x32_bf16 v[32:35], v[36:39], v[24:27], v[32:35]
    ds_read_b64_tr_b16 v[52:53], v14 offset:8192
    ds_read_b64_tr_b16 v[54:55], v14 offset:8704
    s_waitcnt lgkmcnt(6)
    v_mfma_f32_16x16x32_bf16 v[28:31], v[40:43], v[24:27], v[28:31]
    ds_read_b64_tr_b16 v[36:37], v13 offset:10240
    ds_read_b64_tr_b16 v[38:39], v13 offset:10752
    s_waitcnt lgkmcnt(6)
    v_mfma_f32_16x16x32_bf16 v[32:35], v[44:47], v[24:27], v[32:35]
    ds_read_b64_tr_b16 v[40:41], v14 offset:10240
    ds_read_b64_tr_b16 v[42:43], v14 offset:10752
    s_waitcnt lgkmcnt(6)
    v_mfma_f32_16x16x32_bf16 v[28:31], v[48:51], v[24:27], v[28:31]
    s_nop 0
    ds_read_b64_tr_b16 v[44:45], v13 offset:12288
    ds_read_b64_tr_b16 v[46:47], v13 offset:12800
    s_waitcnt lgkmcnt(6)
    v_mfma_f32_16x16x32_bf16 v[32:35], v[52:55], v[24:27], v[32:35]
    ds_read_b64_tr_b16 v[48:49], v14 offset:12288
    ds_read_b64_tr_b16 v[50:51], v14 offset:12800
    s_waitcnt lgkmcnt(6)
    v_mfma_f32_16x16x32_bf16 v[28:31], v[36:39], v[24:27], v[28:31]
    ds_read_b64_tr_b16 v[52:53], v13 offset:14336
    ds_read_b64_tr_b16 v[54:55], v13 offset:14848
    s_waitcnt lgkmcnt(6)
    v_mfma_f32_16x16x32_bf16 v[32:35], v[40:43], v[24:27], v[32:35]
    ds_read_b64_tr_b16 v[36:37], v14 offset:14336
    ds_read_b64_tr_b16 v[38:39], v14 offset:14848
    s_waitcnt lgkmcnt(6)
    v_mfma_f32_16x16x32_bf16 v[28:31], v[44:47], v[24:27], v[28:31]
    ds_read_b64_tr_b16 v[40:41], v13 offset:16384
    ds_read_b64_tr_b16 v[42:43], v13 offset:16896
    s_waitcnt lgkmcnt(6)
    v_mfma_f32_16x16x32_bf16 v[32:35], v[48:51], v[24:27], v[32:35]
    ds_read_b64_tr_b16 v[44:45], v14 offset:16384
    ds_read_b64_tr_b16 v[46:47], v14 offset:16896
    s_waitcnt lgkmcnt(6)
    v_mfma_f32_16x16x32_bf16 v[28:31], v[52:55], v[24:27], v[28:31]
    ds_read_b64_tr_b16 v[48:49], v13 offset:18432
    ds_read_b64_tr_b16 v[50:51], v13 offset:18944
    s_waitcnt lgkmcnt(6)
    v_mfma_f32_16x16x32_bf16 v[32:35], v[36:39], v[24:27], v[32:35]
    ds_read_b64_tr_b16 v[52:53], v14 offset:18432
    ds_read_b64_tr_b16 v[54:55], v14 offset:18944
    s_waitcnt lgkmcnt(6)
    v_mfma_f32_16x16x32_bf16 v[28:31], v[40:43], v[24:27], v[28:31]
    ds_read_b64_tr_b16 v[36:37], v13 offset:20480
    ds_read_b64_tr_b16 v[38:39], v13 offset:20992
    s_waitcnt lgkmcnt(6)
    v_mfma_f32_16x16x32_bf16 v[32:35], v[44:47], v[24:27], v[32:35]
    ds_read_b64_tr_b16 v[40:41], v14 offset:20480
    ds_read_b64_tr_b16 v[42:43], v14 offset:20992
    s_waitcnt lgkmcnt(6)
    v_mfma_f32_16x16x32_bf16 v[28:31], v[48:51], v[24:27], v[28:31]
    ds_read_b64_tr_b16 v[44:45], v13 offset:22528
    ds_read_b64_tr_b16 v[46:47], v13 offset:23040
    s_waitcnt lgkmcnt(6)
    v_mfma_f32_16x16x32_bf16 v[32:35], v[52:55], v[24:27], v[32:35]
    ds_read_b64_tr_b16 v[48:49], v14 offset:22528
    ds_read_b64_tr_b16 v[50:51], v14 offset:23040
    s_waitcnt lgkmcnt(6)
    v_mfma_f32_16x16x32_bf16 v[28:31], v[36:39], v[24:27], v[28:31]
    ds_read_b64_tr_b16 v[52:53], v13 offset:24576
    ds_read_b64_tr_b16 v[54:55], v13 offset:25088
    s_waitcnt lgkmcnt(6)
    v_mfma_f32_16x16x32_bf16 v[32:35], v[40:43], v[24:27], v[32:35]
    ds_read_b64_tr_b16 v[36:37], v14 offset:24576
    ds_read_b64_tr_b16 v[38:39], v14 offset:25088
    s_waitcnt lgkmcnt(6)
    v_mfma_f32_16x16x32_bf16 v[28:31], v[44:47], v[24:27], v[28:31]
    ds_read_b64_tr_b16 v[40:41], v13 offset:26624
    ds_read_b64_tr_b16 v[42:43], v13 offset:27136
    s_waitcnt lgkmcnt(6)
    v_mfma_f32_16x16x32_bf16 v[32:35], v[48:51], v[24:27], v[32:35]
    ds_read_b64_tr_b16 v[44:45], v14 offset:26624
    ds_read_b64_tr_b16 v[46:47], v14 offset:27136
    s_waitcnt lgkmcnt(6)
    v_mfma_f32_16x16x32_bf16 v[28:31], v[52:55], v[24:27], v[28:31]
    ds_read_b64_tr_b16 v[48:49], v13 offset:28672
    ds_read_b64_tr_b16 v[50:51], v13 offset:29184
    s_waitcnt lgkmcnt(6)
    v_mfma_f32_16x16x32_bf16 v[32:35], v[36:39], v[24:27], v[32:35]
    ds_read_b64_tr_b16 v[52:53], v14 offset:28672
    ds_read_b64_tr_b16 v[54:55], v14 offset:29184
    s_waitcnt lgkmcnt(6)
    v_mfma_f32_16x16x32_bf16 v[28:31], v[40:43], v[24:27], v[28:31]
    s_nop 0
    ds_read_b64_tr_b16 v[36:37], v13 offset:30720
    ds_read_b64_tr_b16 v[38:39], v13 offset:31232
    s_waitcnt lgkmcnt(6)
    v_mfma_f32_16x16x32_bf16 v[32:35], v[44:47], v[24:27], v[32:35]
    ds_read_b64_tr_b16 v[40:41], v14 offset:30720
    ds_read_b64_tr_b16 v[42:43], v14 offset:31232
    s_waitcnt lgkmcnt(6)
    v_mfma_f32_16x16x32_bf16 v[28:31], v[48:51], v[24:27], v[28:31]
    s_waitcnt lgkmcnt(4)
    v_mfma_f32_16x16x32_bf16 v[32:35], v[52:55], v[24:27], v[32:35]
    s_waitcnt lgkmcnt(2)
    v_mfma_f32_16x16x32_bf16 v[28:31], v[36:39], v[24:27], v[28:31]
    s_waitcnt lgkmcnt(0)
    v_mfma_f32_16x16x32_bf16 v[32:35], v[40:43], v[24:27], v[32:35]
    s_nop 7
    v_add_f32 v28, v28, v32
    v_add_f32 v29, v29, v33
    v_add_f32 v30, v30, v34
    v_add_f32 v31, v31, v35
    ds_write_b128 v15, v[28:31]
.Lcs_79:
    s_lshl_b32 s95, s3, 2
    s_add_u32 s95, s95, 163200
    v_mov_b32 v13, s95
    v_mov_b32 v14, 1
    ds_write_b32 v13, v14
    buffer_load_dwordx4 v[96:99], v10, s[28:31], s48 offen
    s_xor_b32 s48, s96, 1
    s_mul_i32 s48, s48, 176128
    s_add_u32 s48, s48, s77
    buffer_load_dwordx4 v[100:103], v8, s[32:35], s48 offen
    buffer_load_dwordx4 v[104:107], v9, s[32:35], s48 offen
    buffer_load_dwordx4 v[108:111], v10, s[32:35], s48 offen
    s_xor_b32 s48, s96, 2
    s_mul_i32 s48, s48, 176128
    s_add_u32 s48, s48, s77
    buffer_load_dwordx4 v[112:115], v8, s[28:31], s48 offen
    buffer_load_dwordx4 v[116:119], v9, s[28:31], s48 offen
    buffer_load_dwordx4 v[120:123], v10, s[28:31], s48 offen
    s_xor_b32 s48, s96, 2
    s_mul_i32 s48, s48, 176128
    s_add_u32 s48, s48, s77
    buffer_load_dwordx4 v[124:127], v8, s[32:35], s48 offen
    buffer_load_dwordx4 v[128:131], v9, s[32:35], s48 offen
    buffer_load_dwordx4 v[132:135], v10, s[32:35], s48 offen
    s_xor_b32 s48, s96, 3
    s_mul_i32 s48, s48, 176128
    s_add_u32 s48, s48, s77
    buffer_load_dwordx4 v[136:139], v8, s[28:31], s48 offen
    buffer_load_dwordx4 v[140:143], v9, s[28:31], s48 offen
    buffer_load_dwordx4 v[144:147], v10, s[28:31], s48 offen
    s_xor_b32 s48, s96, 3
    s_mul_i32 s48, s48, 176128
    s_add_u32 s48, s48, s77
    buffer_load_dwordx4 v[148:151], v8, s[32:35], s48 offen
    buffer_load_dwordx4 v[152:155], v9, s[32:35], s48 offen
    buffer_load_dwordx4 v[156:159], v10, s[32:35], s48 offen
    s_xor_b32 s48, s96, 4
    s_mul_i32 s48, s48, 176128
    s_add_u32 s48, s48, s77
    buffer_load_dwordx4 v[160:163], v8, s[28:31], s48 offen
    buffer_load_dwordx4 v[164:167], v9, s[28:31], s48 offen
    buffer_load_dwordx4 v[168:171], v10, s[28:31], s48 offen
    s_xor_b32 s48, s96, 4
    s_mul_i32 s48, s48, 176128
    s_add_u32 s48, s48, s77
    buffer_load_dwordx4 v[172:175], v8, s[32:35], s48 offen
    buffer_load_dwordx4 v[176:179], v9, s[32:35], s48 offen
    buffer_load_dwordx4 v[180:183], v10, s[32:35], s48 offen
    s_xor_b32 s48, s96, 5
    s_mul_i32 s48, s48, 176128
    s_add_u32 s48, s48, s77
    buffer_load_dwordx4 v[184:187], v8, s[28:31], s48 offen
    buffer_load_dwordx4 v[188:191], v9, s[28:31], s48 offen
    buffer_load_dwordx4 v[192:195], v10, s[28:31], s48 offen
    s_xor_b32 s48, s96, 5
    s_mul_i32 s48, s48, 176128
    s_add_u32 s48, s48, s77
    buffer_load_dwordx4 v[196:199], v8, s[32:35], s48 offen
    buffer_load_dwordx4 v[200:203], v9, s[32:35], s48 offen
    s_nop 0
    buffer_load_dwordx4 v[204:207], v10, s[32:35], s48 offen
    v_mov_b32 v14, 2
    v_and_b32 v13, 12, v3
    v_add_u32 v13, 163232, v13
.Lsig_80:
    ds_read_b32 v15, v13
    s_waitcnt lgkmcnt(0)
    v_cmp_ne_u32 vcc, v14, v15
    s_cbranch_vccz .Lsigd_81
    s_sub_u32 s72, s72, 1
    s_cbranch_scc0 .Lsig_80
    s_mov_b32 s72, 0
.Lsigd_81:
    s_waitcnt vmcnt(35)
    ds_write_b128 v16, v[64:67] offset:0
    s_waitcnt vmcnt(34)
    ds_write_b128 v17, v[68:71] offset:0
    s_waitcnt vmcnt(33)
    ds_write_b128 v18, v[72:75] offset:0
    s_waitcnt vmcnt(32)
    ds_write_b128 v16, v[76:79] offset:224
    s_waitcnt vmcnt(31)
    ds_write_b128 v17, v[80:83] offset:224
    s_waitcnt vmcnt(30)
    ds_write_b128 v18, v[84:87] offset:224
    ds_read_b64_tr_b16 v[64:65], v19 offset:0
    ds_read_b64_tr_b16 v[66:67], v19 offset:1792
    ds_read_b64_tr_b16 v[68:69], v19 offset:32
    ds_read_b64_tr_b16 v[70:71], v19 offset:1824
    ds_read_b64_tr_b16 v[72:73], v19 offset:64
    ds_read_b64_tr_b16 v[74:75], v19 offset:1856
    ds_read_b64_tr_b16 v[76:77], v19 offset:96
    ds_read_b64_tr_b16 v[78:79], v19 offset:1888
    ds_read_b64_tr_b16 v[80:81], v19 offset:128
    ds_read_b64_tr_b16 v[82:83], v19 offset:1920
    ds_read_b64_tr_b16 v[84:85], v19 offset:160
    ds_read_b64_tr_b16 v[86:87], v19 offset:1952
    s_waitcnt vmcnt(29)
    ds_write_b128 v16, v[88:91] offset:0
    s_waitcnt vmcnt(28)
    ds_write_b128 v17, v[92:95] offset:0
    s_waitcnt vmcnt(27)
    ds_write_b128 v18, v[96:99] offset:0
    s_waitcnt vmcnt(26)
    ds_write_b128 v16, v[100:103] offset:224
    s_waitcnt vmcnt(25)
    ds_write_b128 v17, v[104:107] offset:224
    s_waitcnt vmcnt(24)
    ds_write_b128 v18, v[108:111] offset:224
    ds_read_b64_tr_b16 v[88:89], v19 offset:0
    ds_read_b64_tr_b16 v[90:91], v19 offset:1792
    ds_read_b64_tr_b16 v[92:93], v19 offset:32
    ds_read_b64_tr_b16 v[94:95], v19 offset:1824
    ds_read_b64_tr_b16 v[96:97], v19 offset:64
    ds_read_b64_tr_b16 v[98:99], v19 offset:1856
    ds_read_b64_tr_b16 v[100:101], v19 offset:96
    ds_read_b64_tr_b16 v[102:103], v19 offset:1888
    ds_read_b64_tr_b16 v[104:105], v19 offset:128
    ds_read_b64_tr_b16 v[106:107], v19 offset:1920
    ds_read_b64_tr_b16 v[108:109], v19 offset:160
    ds_read_b64_tr_b16 v[110:111], v19 offset:1952
    s_waitcnt lgkmcnt(15)
    v_mfma_f32_16x16x32_bf16 v[28:31], v[64:67], v[24:27], 0
    v_mfma_f32_16x16x32_bf16 v[32:35], v[68:71], v[24:27], 0
    v_mfma_f32_16x16x32_bf16 v[36:39], v[72:75], v[24:27], 0
    v_mfma_f32_16x16x32_bf16 v[40:43], v[76:79], v[24:27], 0
    v_mfma_f32_16x16x32_bf16 v[44:47], v[80:83], v[24:27], 0
    v_mfma_f32_16x16x32_bf16 v[48:51], v[84:87], v[24:27], 0
    s_waitcnt lgkmcnt(10)
    v_mfma_f32_16x16x32_bf16 v[28:31], v[88:91], v[24:27], v[28:31]
    s_waitcnt lgkmcnt(8)
    v_mfma_f32_16x16x32_bf16 v[32:35], v[92:95], v[24:27], v[32:35]
    s_waitcnt lgkmcnt(6)
    v_mfma_f32_16x16x32_bf16 v[36:39], v[96:99], v[24:27], v[36:39]
    s_waitcnt lgkmcnt(4)
    v_mfma_f32_16x16x32_bf16 v[40:43], v[100:103], v[24:27], v[40:43]
    s_waitcnt lgkmcnt(2)
    v_mfma_f32_16x16x32_bf16 v[44:47], v[104:107], v[24:27], v[44:47]
    s_waitcnt lgkmcnt(0)
    s_nop 0
    v_mfma_f32_16x16x32_bf16 v[48:51], v[108:111], v[24:27], v[48:51]
    s_xor_b32 s48, s96, 6
    s_mul_i32 s48, s48, 176128
    s_add_u32 s48, s48, s77
    buffer_load_dwordx4 v[208:211], v8, s[28:31], s48 offen
    buffer_load_dwordx4 v[212:215], v9, s[28:31], s48 offen
    buffer_load_dwordx4 v[216:219], v10, s[28:31], s48 offen
    s_xor_b32 s48, s96, 6
    s_mul_i32 s48, s48, 176128
    s_add_u32 s48, s48, s77
    buffer_load_dwordx4 v[220:223], v8, s[32:35], s48 offen
    buffer_load_dwordx4 v[224:227], v9, s[32:35], s48 offen
    buffer_load_dwordx4 v[228:231], v10, s[32:35], s48 offen
    s_xor_b32 s48, s96, 7
    s_mul_i32 s48, s48, 176128
    s_add_u32 s48, s48, s77
    buffer_load_dwordx4 v[232:235], v8, s[28:31], s48 offen
    buffer_load_dwordx4 v[236:239], v9, s[28:31], s48 offen
    buffer_load_dwordx4 v[240:243], v10, s[28:31], s48 offen
    s_xor_b32 s48, s96, 7
    s_mul_i32 s48, s48, 176128
    s_add_u32 s48, s48, s77
    buffer_load_dwordx4 v[244:247], v8, s[32:35], s48 offen
    buffer_load_dwordx4 v[248:251], v9, s[32:35], s48 offen
    buffer_load_dwordx4 v[252:255], v10, s[32:35], s48 offen
    s_waitcnt vmcnt(35)
    ds_write_b128 v16, v[112:115] offset:0
    s_waitcnt vmcnt(34)
    ds_write_b128 v17, v[116:119] offset:0
    s_waitcnt vmcnt(33)
    ds_write_b128 v18, v[120:123] offset:0
    s_waitcnt vmcnt(32)
    ds_write_b128 v16, v[124:127] offset:224
    s_waitcnt vmcnt(31)
    ds_write_b128 v17, v[128:131] offset:224
    s_waitcnt vmcnt(30)
    ds_write_b128 v18, v[132:135] offset:224
    ds_read_b64_tr_b16 v[112:113], v19 offset:0
    ds_read_b64_tr_b16 v[114:115], v19 offset:1792
    ds_read_b64_tr_b16 v[116:117], v19 offset:32
    ds_read_b64_tr_b16 v[118:119], v19 offset:1824
    ds_read_b64_tr_b16 v[120:121], v19 offset:64
    ds_read_b64_tr_b16 v[122:123], v19 offset:1856
    ds_read_b64_tr_b16 v[124:125], v19 offset:96
    ds_read_b64_tr_b16 v[126:127], v19 offset:1888
    ds_read_b64_tr_b16 v[128:129], v19 offset:128
    ds_read_b64_tr_b16 v[130:131], v19 offset:1920
    ds_read_b64_tr_b16 v[132:133], v19 offset:160
    ds_read_b64_tr_b16 v[134:135], v19 offset:1952
    s_waitcnt vmcnt(29)
    ds_write_b128 v16, v[136:139] offset:0
    s_waitcnt vmcnt(28)
    ds_write_b128 v17, v[140:143] offset:0
    s_waitcnt vmcnt(27)
    ds_write_b128 v18, v[144:147] offset:0
    s_waitcnt vmcnt(26)
    ds_write_b128 v16, v[148:151] offset:224
    s_waitcnt vmcnt(25)
    ds_write_b128 v17, v[152:155] offset:224
    s_waitcnt vmcnt(24)
    ds_write_b128 v18, v[156:159] offset:224
    ds_read_b64_tr_b16 v[136:137], v19 offset:0
    ds_read_b64_tr_b16 v[138:139], v19 offset:1792
    ds_read_b64_tr_b16 v[140:141], v19 offset:32
    ds_read_b64_tr_b16 v[142:143], v19 offset:1824
    ds_read_b64_tr_b16 v[144:145], v19 offset:64
    ds_read_b64_tr_b16 v[146:147], v19 offset:1856
    ds_read_b64_tr_b16 v[148:149], v19 offset:96
    ds_read_b64_tr_b16 v[150:151], v19 offset:1888
    ds_read_b64_tr_b16 v[152:153], v19 offset:128
    ds_read_b64_tr_b16 v[154:155], v19 offset:1920
    ds_read_b64_tr_b16 v[156:157], v19 offset:160
    ds_read_b64_tr_b16 v[158:159], v19 offset:1952
    s_waitcnt lgkmcnt(15)
    s_nop 0
    v_mfma_f32_16x16x32_bf16 v[28:31], v[112:115], v[24:27], v[28:31]
    v_mfma_f32_16x16x32_bf16 v[32:35], v[116:119], v[24:27], v[32:35]
    v_mfma_f32_16x16x32_bf16 v[36:39], v[120:123], v[24:27], v[36:39]
    v_mfma_f32_16x16x32_bf16 v[40:43], v[124:127], v[24:27], v[40:43]
    v_mfma_f32_16x16x32_bf16 v[44:47], v[128:131], v[24:27], v[44:47]
    v_mfma_f32_16x16x32_bf16 v[48:51], v[132:135], v[24:27], v[48:51]
    s_waitcnt lgkmcnt(10)
    v_mfma_f32_16x16x32_bf16 v[28:31], v[136:139], v[24:27], v[28:31]
    s_waitcnt lgkmcnt(8)
    v_mfma_f32_16x16x32_bf16 v[32:35], v[140:143], v[24:27], v[32:35]
    s_waitcnt lgkmcnt(6)
    v_mfma_f32_16x16x32_bf16 v[36:39], v[144:147], v[24:27], v[36:39]
    s_waitcnt lgkmcnt(4)
    v_mfma_f32_16x16x32_bf16 v[40:43], v[148:151], v[24:27], v[40:43]
    s_waitcnt lgkmcnt(2)
    v_mfma_f32_16x16x32_bf16 v[44:47], v[152:155], v[24:27], v[44:47]
    s_waitcnt lgkmcnt(0)
    v_mfma_f32_16x16x32_bf16 v[48:51], v[156:159], v[24:27], v[48:51]
    s_add_u32 m0, s74, 98304
    s_add_u32 s92, s76, 0
    buffer_load_dwordx4 v5, s[24:27], s92 offen lds
    s_add_u32 m0, s74, 99328
    s_add_u32 s92, s76, 8192
    buffer_load_dwordx4 v5, s[24:27], s92 offen lds
    s_add_u32 m0, s74, 100352
    s_add_u32 s92, s76, 16384
    buffer_load_dwordx4 v5, s[24:27], s92 offen lds
    s_add_u32 m0, s74, 101376
    s_add_u32 s92, s76, 24576
    buffer_load_dwordx4 v5, s[24:27], s92 offen lds
    s_add_u32 m0, s74, 102400
    s_add_u32 s92, s76, 32768
    buffer_load_dwordx4 v5, s[24:27], s92 offen lds
    s_add_u32 m0, s74, 103424
    s_add_u32 s92, s76, 40960
    buffer_load_dwordx4 v5, s[24:27], s92 offen lds
    s_add_u32 m0, s74, 104448
    s_add_u32 s92, s76, 49152
    buffer_load_dwordx4 v5, s[24:27], s92 offen lds
    s_add_u32 m0, s74, 105472
    s_add_u32 s92, s76, 57344
    buffer_load_dwordx4 v5, s[24:27], s92 offen lds
    s_add_u32 m0, s74, 0
    s_add_u32 s92, s76, 262144
    buffer_load_dwordx4 v5, s[24:27], s92 offen lds
    s_add_u32 m0, s74, 1024
    s_add_u32 s92, s76, 270336
    buffer_load_dwordx4 v5, s[24:27], s92 offen lds
    s_add_u32 m0, s74, 2048
    s_add_u32 s92, s76, 278528
    buffer_load_dwordx4 v5, s[24:27], s92 offen lds
    s_add_u32 m0, s74, 3072
    s_add_u32 s92, s76, 286720
    buffer_load_dwordx4 v5, s[24:27], s92 offen lds
    s_add_u32 m0, s74, 4096
    s_add_u32 s92, s76, 294912
    buffer_load_dwordx4 v5, s[24:27], s92 offen lds
    s_add_u32 m0, s74, 5120
    s_add_u32 s92, s76, 303104
    buffer_load_dwordx4 v5, s[24:27], s92 offen lds
    s_add_u32 m0, s74, 6144
    s_add_u32 s92, s76, 311296
    buffer_load_dwordx4 v5, s[24:27], s92 offen lds
    s_add_u32 m0, s74, 7168
    s_add_u32 s92, s76, 319488
    buffer_load_dwordx4 v5, s[24:27], s92 offen lds
    s_waitcnt vmcnt(39)
    ds_write_b128 v16, v[160:163] offset:0
    s_nop 0
    s_waitcnt vmcnt(38)
    ds_write_b128 v17, v[164:167] offset:0
    s_waitcnt vmcnt(37)
    ds_write_b128 v18, v[168:171] offset:0
    s_waitcnt vmcnt(36)
    ds_write_b128 v16, v[172:175] offset:224
    s_waitcnt vmcnt(35)
    ds_write_b128 v17, v[176:179] offset:224
    s_waitcnt vmcnt(34)
    ds_write_b128 v18, v[180:183] offset:224
    ds_read_b64_tr_b16 v[160:161], v19 offset:0
    ds_read_b64_tr_b16 v[162:163], v19 offset:1792
    ds_read_b64_tr_b16 v[164:165], v19 offset:32
    ds_read_b64_tr_b16 v[166:167], v19 offset:1824
    ds_read_b64_tr_b16 v[168:169], v19 offset:64
    ds_read_b64_tr_b16 v[170:171], v19 offset:1856
    ds_read_b64_tr_b16 v[172:173], v19 offset:96
    ds_read_b64_tr_b16 v[174:175], v19 offset:1888
    ds_read_b64_tr_b16 v[176:177], v19 offset:128
    ds_read_b64_tr_b16 v[178:179], v19 offset:1920
    ds_read_b64_tr_b16 v[180:181], v19 offset:160
    ds_read_b64_tr_b16 v[182:183], v19 offset:1952
    s_waitcnt vmcnt(33)
    ds_write_b128 v16, v[184:187] offset:0
    s_waitcnt vmcnt(32)
    ds_write_b128 v17, v[188:191] offset:0
    s_waitcnt vmcnt(31)
    ds_write_b128 v18, v[192:195] offset:0
    s_waitcnt vmcnt(30)
    ds_write_b128 v16, v[196:199] offset:224
    s_waitcnt vmcnt(29)
    ds_write_b128 v17, v[200:203] offset:224
    s_waitcnt vmcnt(28)
    ds_write_b128 v18, v[204:207] offset:224
    ds_read_b64_tr_b16 v[184:185], v19 offset:0
    ds_read_b64_tr_b16 v[186:187], v19 offset:1792
    ds_read_b64_tr_b16 v[188:189], v19 offset:32
    ds_read_b64_tr_b16 v[190:191], v19 offset:1824
    ds_read_b64_tr_b16 v[192:193], v19 offset:64
    ds_read_b64_tr_b16 v[194:195], v19 offset:1856
    ds_read_b64_tr_b16 v[196:197], v19 offset:96
    ds_read_b64_tr_b16 v[198:199], v19 offset:1888
    ds_read_b64_tr_b16 v[200:201], v19 offset:128
    ds_read_b64_tr_b16 v[202:203], v19 offset:1920
    ds_read_b64_tr_b16 v[204:205], v19 offset:160
    ds_read_b64_tr_b16 v[206:207], v19 offset:1952
    s_waitcnt lgkmcnt(15)
    v_mfma_f32_16x16x32_bf16 v[28:31], v[160:163], v[24:27], v[28:31]
    v_mfma_f32_16x16x32_bf16 v[32:35], v[164:167], v[24:27], v[32:35]
    v_mfma_f32_16x16x32_bf16 v[36:39], v[168:171], v[24:27], v[36:39]
    v_mfma_f32_16x16x32_bf16 v[40:43], v[172:175], v[24:27], v[40:43]
    v_mfma_f32_16x16x32_bf16 v[44:47], v[176:179], v[24:27], v[44:47]
    v_mfma_f32_16x16x32_bf16 v[48:51], v[180:183], v[24:27], v[48:51]
    s_waitcnt lgkmcnt(10)
    v_mfma_f32_16x16x32_bf16 v[28:31], v[184:187], v[24:27], v[28:31]
    s_waitcnt lgkmcnt(8)
    v_mfma_f32_16x16x32_bf16 v[32:35], v[188:191], v[24:27], v[32:35]
    s_waitcnt lgkmcnt(6)
    v_mfma_f32_16x16x32_bf16 v[36:39], v[192:195], v[24:27], v[36:39]
    s_waitcnt lgkmcnt(4)
    v_mfma_f32_16x16x32_bf16 v[40:43], v[196:199], v[24:27], v[40:43]
    s_waitcnt lgkmcnt(2)
    v_mfma_f32_16x16x32_bf16 v[44:47], v[200:203], v[24:27], v[44:47]
    s_waitcnt lgkmcnt(0)
    v_mfma_f32_16x16x32_bf16 v[48:51], v[204:207], v[24:27], v[48:51]
    s_lshl_b32 s92, s66, 2
    s_add_u32 s92, s92, s70
    s_mul_i32 s92, s92, 88064
    s_mul_i32 s93, s67, 2048
    s_add_u32 s92, s92, s93
    s_add_u32 s92, s92, 3407872
    v_min_u32 v13, 15, v0
    v_lshlrev_b32 v13, 7, v13
    buffer_load_dword v60, v13, s[4:7], s92 offen
    s_lshl_b32 s92, s66, 4
    s_add_u32 s92, s92, s67
    s_nop 0
    s_lshl_b32 s92, s92, 2
    s_add_u32 s92, s92, s70
    s_lshl_b32 s93, s92, 11
    s_add_u32 s93, s93, 1048576
    s_lshl_b32 s94, s92, 8
    s_add_u32 s94, s94, 3143680
    s_lshl_b32 s95, s66, 2
    s_add_u32 s95, s95, s70
    s_lshl_b32 s95, s95, 10
    s_add_u32 s95, s95, 63232
    v_mov_b32 v14, s93
    v_mov_b32 v15, s94
    v_cmp_le_u32 vcc, 16, v0
    s_nop 1
    v_cndmask_b32 v14, v14, v15, vcc
    v_mov_b32 v15, s95
    v_cmp_le_u32 vcc, 18, v0
    s_nop 1
    v_cndmask_b32 v14, v14, v15, vcc
    v_min_u32 v13, 22, v0
    v_lshl_add_u32 v13, v13, 7, v14
    buffer_load_dword v61, v13, s[4:7], 0 offen
    s_waitcnt vmcnt(29)
    ds_write_b128 v16, v[208:211] offset:0
    s_waitcnt vmcnt(28)
    ds_write_b128 v17, v[212:215] offset:0
    s_waitcnt vmcnt(27)
    ds_write_b128 v18, v[216:219] offset:0
    s_waitcnt vmcnt(26)
    ds_write_b128 v16, v[220:223] offset:224
    s_waitcnt vmcnt(25)
    ds_write_b128 v17, v[224:227] offset:224
    s_waitcnt vmcnt(24)
    ds_write_b128 v18, v[228:231] offset:224
    ds_read_b64_tr_b16 v[208:209], v19 offset:0
    ds_read_b64_tr_b16 v[210:211], v19 offset:1792
    ds_read_b64_tr_b16 v[212:213], v19 offset:32
    ds_read_b64_tr_b16 v[214:215], v19 offset:1824
    ds_read_b64_tr_b16 v[216:217], v19 offset:64
    ds_read_b64_tr_b16 v[218:219], v19 offset:1856
    ds_read_b64_tr_b16 v[220:221], v19 offset:96
    ds_read_b64_tr_b16 v[222:223], v19 offset:1888
    ds_read_b64_tr_b16 v[224:225], v19 offset:128
    ds_read_b64_tr_b16 v[226:227], v19 offset:1920
    ds_read_b64_tr_b16 v[228:229], v19 offset:160
    ds_read_b64_tr_b16 v[230:231], v19 offset:1952
    s_waitcnt vmcnt(23)
    ds_write_b128 v16, v[232:235] offset:0
    s_waitcnt vmcnt(22)
    ds_write_b128 v17, v[236:239] offset:0
    s_waitcnt vmcnt(21)
    ds_write_b128 v18, v[240:243] offset:0
    s_waitcnt vmcnt(20)
    ds_write_b128 v16, v[244:247] offset:224
    s_waitcnt vmcnt(19)
    ds_write_b128 v17, v[248:251] offset:224
    s_waitcnt vmcnt(18)
    ds_write_b128 v18, v[252:255] offset:224
    ds_read_b64_tr_b16 v[232:233], v19 offset:0
    ds_read_b64_tr_b16 v[234:235], v19 offset:1792
    ds_read_b64_tr_b16 v[236:237], v19 offset:32
    ds_read_b64_tr_b16 v[238:239], v19 offset:1824
    ds_read_b64_tr_b16 v[240:241], v19 offset:64
    ds_read_b64_tr_b16 v[242:243], v19 offset:1856
    ds_read_b64_tr_b16 v[244:245], v19 offset:96
    ds_read_b64_tr_b16 v[246:247], v19 offset:1888
    ds_read_b64_tr_b16 v[248:249], v19 offset:128
    ds_read_b64_tr_b16 v[250:251], v19 offset:1920
    ds_read_b64_tr_b16 v[252:253], v19 offset:160
    ds_read_b64_tr_b16 v[254:255], v19 offset:1952
    s_waitcnt lgkmcnt(15)
    v_mfma_f32_16x16x32_bf16 v[28:31], v[208:211], v[24:27], v[28:31]
    v_mfma_f32_16x16x32_bf16 v[32:35], v[212:215], v[24:27], v[32:35]
    v_mfma_f32_16x16x32_bf16 v[36:39], v[216:219], v[24:27], v[36:39]
    v_mfma_f32_16x16x32_bf16 v[40:43], v[220:223], v[24:27], v[40:43]
    v_mfma_f32_16x16x32_bf16 v[44:47], v[224:227], v[24:27], v[44:47]
    v_mfma_f32_16x16x32_bf16 v[48:51], v[228:231], v[24:27], v[48:51]
    s_waitcnt lgkmcnt(10)
    v_mfma_f32_16x16x32_bf16 v[28:31], v[232:235], v[24:27], v[28:31]
    s_nop 0
    s_waitcnt lgkmcnt(8)
    v_mfma_f32_16x16x32_bf16 v[32:35], v[236:239], v[24:27], v[32:35]
    s_waitcnt lgkmcnt(6)
    v_mfma_f32_16x16x32_bf16 v[36:39], v[240:243], v[24:27], v[36:39]
    s_waitcnt lgkmcnt(4)
    v_mfma_f32_16x16x32_bf16 v[40:43], v[244:247], v[24:27], v[40:43]
    s_waitcnt lgkmcnt(2)
    v_mfma_f32_16x16x32_bf16 v[44:47], v[248:251], v[24:27], v[44:47]
    s_waitcnt lgkmcnt(0)
    v_mfma_f32_16x16x32_bf16 v[48:51], v[252:255], v[24:27], v[48:51]
    s_waitcnt lgkmcnt(0)
    s_waitcnt vmcnt(2)
    s_barrier
    s_mul_i32 s92, s70, 768
    s_add_u32 s92, s92, 149504
    v_add_u32 v13, s92, v22
    ds_write_b128 v13, v[28:31] offset:0
    ds_write_b128 v13, v[32:35] offset:128
    ds_write_b128 v13, v[36:39] offset:256
    ds_write_b128 v13, v[40:43] offset:384
    ds_write_b128 v13, v[44:47] offset:512
    ds_write_b128 v13, v[48:51] offset:640
    ds_write_b128 v6, v[64:67] offset:32768
    ds_write_b128 v6, v[88:91] offset:36864
    ds_write_b128 v6, v[112:115] offset:40960
    ds_write_b128 v6, v[136:139] offset:45056
    ds_write_b128 v6, v[68:71] offset:49152
    ds_write_b128 v6, v[92:95] offset:53248
    ds_write_b128 v6, v[116:119] offset:57344
    ds_write_b128 v6, v[140:143] offset:61440
    ds_write_b128 v7, v[160:163] offset:0
    ds_write_b128 v7, v[184:187] offset:4096
    ds_write_b128 v7, v[208:211] offset:8192
    ds_write_b128 v7, v[232:235] offset:12288
    ds_write_b128 v7, v[164:167] offset:16384
    ds_write_b128 v7, v[188:191] offset:20480
    ds_write_b128 v7, v[212:215] offset:24576
    ds_write_b128 v7, v[236:239] offset:28672
    s_waitcnt lgkmcnt(0)
    s_lshr_b32 s90, s79, 4
    s_mul_i32 s90, s90, 3072
    s_and_b32 s91, s79, 15
    s_lshl_b32 s91, s91, 7
    s_add_u32 s91, s91, s90
    s_add_u32 s44, s46, s91
    s_addc_u32 s45, s47, 0
    s_load_dwordx2 s[86:87], s[44:45], 0x43c
    s_load_dwordx2 s[86:87], s[44:45], 0x643c
    s_load_dwordx2 s[86:87], s[44:45], 0xc43c
    s_load_dwordx2 s[86:87], s[44:45], 0x1243c
    s_load_dwordx2 s[86:87], s[44:45], 0x1843c
    s_load_dwordx2 s[86:87], s[44:45], 0x1e43c
    s_load_dwordx2 s[86:87], s[44:45], 0x2443c
    s_load_dwordx2 s[86:87], s[44:45], 0x2a43c
    s_load_dwordx2 s[86:87], s[44:45], 0x3043c
    s_load_dwordx2 s[86:87], s[44:45], 0x3643c
    s_load_dwordx2 s[86:87], s[44:45], 0x3c43c
    s_load_dwordx2 s[86:87], s[44:45], 0x4243c
    s_load_dwordx2 s[86:87], s[44:45], 0x4843c
    s_load_dwordx2 s[86:87], s[44:45], 0x4e43c
    s_load_dwordx2 s[86:87], s[44:45], 0x5443c
    s_load_dwordx2 s[86:87], s[44:45], 0x5a43c
    s_load_dwordx2 s[86:87], s[44:45], 0x6043c
    s_load_dwordx2 s[86:87], s[44:45], 0x6643c
    s_load_dwordx2 s[86:87], s[44:45], 0x6c43c
    s_load_dwordx2 s[86:87], s[44:45], 0x7243c
    s_load_dwordx2 s[86:87], s[44:45], 0x7843c
    s_barrier
    s_lshl_b32 s92, s66, 2
    s_add_u32 s92, s92, s70
    s_mul_i32 s92, s92, 88064
    s_mul_i32 s93, s67, 3456
    s_add_u32 s92, s92, s93
    s_add_u32 s92, s92, 3440640
.Lhp_65:
    s_cbranch_execz .Lhbrc
    v_min_u32 v13, 26, v0
    v_lshlrev_b32 v13, 7, v13
    buffer_load_dword v62, v13, s[4:7], s92 offen
    s_load_dwordx2 s[86:87], s[44:45], 0x7e43c
    s_load_dwordx2 s[86:87], s[44:45], 0x8443c
    s_load_dwordx2 s[86:87], s[44:45], 0x8a43c
    s_load_dwordx2 s[86:87], s[44:45], 0x9043c
    s_load_dwordx2 s[86:87], s[44:45], 0x9643c
    s_load_dwordx2 s[86:87], s[44:45], 0x9c43c
    s_load_dwordx2 s[86:87], s[44:45], 0xa243c
    s_barrier
    ds_write_b128 v7, v[72:75] offset:32768
    ds_write_b128 v7, v[96:99] offset:36864
    ds_write_b128 v7, v[120:123] offset:40960
    ds_write_b128 v7, v[144:147] offset:45056
    ds_write_b128 v7, v[168:171] offset:49152
    ds_write_b128 v7, v[192:195] offset:53248
    ds_write_b128 v7, v[216:219] offset:57344
    ds_write_b128 v7, v[240:243] offset:61440
    ds_write_b128 v6, v[76:79] offset:0
    ds_write_b128 v6, v[100:103] offset:4096
    ds_write_b128 v6, v[124:127] offset:8192
    ds_write_b128 v6, v[148:151] offset:12288
    ds_write_b128 v6, v[172:175] offset:16384
    ds_write_b128 v6, v[196:199] offset:20480
    ds_write_b128 v6, v[220:223] offset:24576
    ds_write_b128 v6, v[244:247] offset:28672
    s_waitcnt lgkmcnt(0)
    s_barrier
    v_min_u32 v23, 752, v1
    v_add_u32 v13, 149504, v23
    ds_read_b128 v[28:31], v13 offset:0
    ds_read_b128 v[32:35], v13 offset:768
    ds_read_b128 v[36:39], v13 offset:1536
    ds_read_b128 v[40:43], v13 offset:2304
    s_waitcnt lgkmcnt(2)
    v_add_f32 v28, v28, v32
    s_waitcnt lgkmcnt(0)
    v_add_f32 v36, v36, v40
    v_add_f32 v29, v29, v33
    v_add_f32 v37, v37, v41
    v_add_f32 v30, v30, v34
    v_add_f32 v38, v38, v42
    v_add_f32 v31, v31, v35
    v_add_f32 v39, v39, v43
    v_add_f32 v28, v28, v36
    v_add_f32 v29, v29, v37
    v_add_f32 v30, v30, v38
    v_add_f32 v31, v31, v39
    v_and_b32 v32, 4294901760, v28
    v_sub_f32 v28, v28, v32
    v_cvt_pk_bf16_f32 v28, v32, v28
    v_and_b32 v33, 4294901760, v29
    v_sub_f32 v29, v29, v33
    v_cvt_pk_bf16_f32 v29, v33, v29
    v_and_b32 v34, 4294901760, v30
    v_sub_f32 v30, v30, v34
    v_cvt_pk_bf16_f32 v30, v34, v30
    v_and_b32 v35, 4294901760, v31
    v_sub_f32 v31, v31, v35
    v_cvt_pk_bf16_f32 v31, v35, v31
    v_and_b32 v13, 896, v23
    v_and_b32 v14, 48, v23
    v_lshl_add_u32 v13, v14, 1, v13
    v_bfe_u32 v14, v23, 6, 1
    v_lshl_add_u32 v13, v14, 4, v13
    v_add_u32 v13, 162432, v13
    ds_write_b128 v13, v[28:31]
    v_bfe_u32 v13, v0, 3, 2
    v_mul_u32_u24 v13, 576, v13
    v_lshrrev_b32 v14, 5, v0
    v_lshl_add_u32 v13, v14, 7, v13
    v_and_b32 v14, 112, v1
    v_add_u32 v13, v13, v14
    v_add_u32 v13, 159744, v13
    ds_write_b128 v13, v[56:59]
.Lhsc_3_0:
.Lhp_66:
    s_cbranch_execz .Lhp_67
    s_waitcnt lgkmcnt(0)
    s_mul_i32 s90, s79, 1024
    s_add_u32 s100, s58, s90
    s_addc_u32 s101, s59, 0
    s_load_dwordx2 s[86:87], s[100:101], 0x1bc
    s_load_dwordx2 s[86:87], s[100:101], 0x201bc
    s_load_dwordx2 s[86:87], s[100:101], 0x401bc
    s_load_dwordx2 s[86:87], s[100:101], 0x601bc
    s_load_dwordx2 s[86:87], s[100:101], 0x801bc
    s_load_dwordx2 s[86:87], s[100:101], 0xa01bc
    s_load_dwordx2 s[86:87], s[100:101], 0xc01bc
    s_load_dwordx2 s[86:87], s[100:101], 0xe01bc
    s_add_u32 s100, s100, 1048576
    s_addc_u32 s101, s101, 0
    s_load_dwordx2 s[86:87], s[100:101], 0x1bc
    s_load_dwordx2 s[86:87], s[100:101], 0x201bc
    s_min_u32 s90, s79, 95
    s_sub_u32 s90, s79, s90
    s_lshl_b32 s90, s90, 10
    s_sub_u32 s100, s100, s90
    s_subb_u32 s101, s101, 0
    s_load_dwordx2 s[86:87], s[100:101], 0x401bc
    s_barrier
    ds_write_b128 v6, v[80:83] offset:32768
    ds_write_b128 v6, v[104:107] offset:36864
    ds_write_b128 v6, v[128:131] offset:40960
    ds_write_b128 v6, v[152:155] offset:45056
    ds_write_b128 v6, v[176:179] offset:49152
    ds_write_b128 v6, v[200:203] offset:53248
    ds_write_b128 v6, v[224:227] offset:57344
    ds_write_b128 v6, v[248:251] offset:61440
    s_mul_i32 s92, s79, 11008
    v_lshlrev_b32 v13, 7, v0
    buffer_load_dword v11, v13, s[36:39], s92 offen
    v_min_u32 v14, 21, v0
    v_lshlrev_b32 v14, 7, v14
    s_add_u32 s92, s92, 8192
    buffer_load_dword v60, v14, s[36:39], s92 offen
    s_barrier
    ds_write_b128 v7, v[84:87] offset:0
    ds_write_b128 v7, v[108:111] offset:4096
    ds_write_b128 v7, v[132:135] offset:8192
    ds_write_b128 v7, v[156:159] offset:12288
    ds_write_b128 v7, v[180:183] offset:16384
    ds_write_b128 v7, v[204:207] offset:20480
    ds_write_b128 v7, v[228:231] offset:24576
    ds_write_b128 v7, v[252:255] offset:28672
    s_waitcnt lgkmcnt(8)
    s_barrier
    s_add_u32 s92, s80, 65536
    buffer_load_dwordx4 v[16:19], v5, s[36:39], s92 offen
    s_add_u32 s92, s80, 73728
    buffer_load_dwordx4 v[20:23], v5, s[36:39], s92 offen
    s_add_u32 s92, s81, 65536
    buffer_load_dwordx4 v[24:27], v5, s[36:39], s92 offen
    s_add_u32 s92, s81, 73728
    buffer_load_dwordx4 v[28:31], v5, s[36:39], s92 offen
    s_add_u32 s92, s82, 65536
    buffer_load_dwordx4 v[32:35], v5, s[36:39], s92 offen
    s_add_u32 s92, s82, 73728
    buffer_load_dwordx4 v[36:39], v5, s[36:39], s92 offen
    s_add_u32 s92, s83, 65536
    buffer_load_dwordx4 v[40:43], v5, s[36:39], s92 offen
    s_add_u32 s92, s83, 73728
    buffer_load_dwordx4 v[44:47], v5, s[36:39], s92 offen
    s_mul_i32 s93, s70, 3
    s_add_u32 s93, s93, 0
    s_lshr_b32 s92, s93, 1
    s_mul_i32 s92, s92, 98304
    s_and_b32 s94, s93, 1
    s_lshl_b32 s94, s94, 13
    s_add_u32 s92, s92, s94
    s_add_u32 s92, s92, s78
    buffer_load_dwordx4 v[48:51], v5, s[36:39], s92 offen
    s_mul_i32 s93, s70, 3
.Lhsc_3_1:
.Lhp_67:
    s_cbranch_execz .Lhp_68
    s_add_u32 s93, s93, 1
    s_lshr_b32 s92, s93, 1
    s_mul_i32 s92, s92, 98304
    s_and_b32 s94, s93, 1
    s_lshl_b32 s94, s94, 13
    s_add_u32 s92, s92, s94
    s_add_u32 s92, s92, s78
    buffer_load_dwordx4 v[52:55], v5, s[36:39], s92 offen
    s_mul_i32 s93, s70, 3
    s_add_u32 s93, s93, 2
    s_lshr_b32 s92, s93, 1
    s_mul_i32 s92, s92, 98304
    s_and_b32 s94, s93, 1
    s_lshl_b32 s94, s94, 13
    s_add_u32 s92, s92, s94
    s_add_u32 s92, s92, s78
    buffer_load_dwordx4 v[56:59], v5, s[36:39], s92 offen
    s_waitcnt lgkmcnt(0)
    s_barrier
    s_add_u32 m0, s74, 98304
    s_add_u32 s92, s80, 0
    buffer_load_dwordx4 v5, s[36:39], s92 offen lds
    s_add_u32 m0, s74, 99328
    s_add_u32 s92, s80, 8192
    buffer_load_dwordx4 v5, s[36:39], s92 offen lds
    s_add_u32 m0, s74, 100352
    s_add_u32 s92, s81, 0
    buffer_load_dwordx4 v5, s[36:39], s92 offen lds
    s_add_u32 m0, s74, 101376
    s_add_u32 s92, s81, 8192
    buffer_load_dwordx4 v5, s[36:39], s92 offen lds
    s_add_u32 m0, s74, 102400
    s_add_u32 s92, s82, 0
    buffer_load_dwordx4 v5, s[36:39], s92 offen lds
    s_add_u32 m0, s74, 103424
    s_add_u32 s92, s82, 8192
    buffer_load_dwordx4 v5, s[36:39], s92 offen lds
    s_add_u32 m0, s74, 104448
    s_add_u32 s92, s83, 0
    buffer_load_dwordx4 v5, s[36:39], s92 offen lds
    s_add_u32 m0, s74, 105472
    s_add_u32 s92, s83, 8192
    buffer_load_dwordx4 v5, s[36:39], s92 offen lds
    s_add_u32 m0, s74, 0
    s_add_u32 s92, s80, 16384
    buffer_load_dwordx4 v5, s[36:39], s92 offen lds
    s_add_u32 m0, s74, 1024
    s_add_u32 s92, s80, 24576
    buffer_load_dwordx4 v5, s[36:39], s92 offen lds
    s_add_u32 m0, s74, 2048
    s_add_u32 s92, s81, 16384
    buffer_load_dwordx4 v5, s[36:39], s92 offen lds
    s_add_u32 m0, s74, 3072
    s_add_u32 s92, s81, 24576
    buffer_load_dwordx4 v5, s[36:39], s92 offen lds
    s_add_u32 m0, s74, 4096
    s_add_u32 s92, s82, 16384
    buffer_load_dwordx4 v5, s[36:39], s92 offen lds
    s_add_u32 m0, s74, 5120
    s_add_u32 s92, s82, 24576
    buffer_load_dwordx4 v5, s[36:39], s92 offen lds
    s_add_u32 m0, s74, 6144
    s_add_u32 s92, s83, 16384
    buffer_load_dwordx4 v5, s[36:39], s92 offen lds
    s_add_u32 m0, s74, 7168
    s_add_u32 s92, s83, 24576
    buffer_load_dwordx4 v5, s[36:39], s92 offen lds
    s_waitcnt vmcnt(8)
    s_barrier
    s_add_u32 m0, s74, 32768
    s_add_u32 s92, s80, 32768
    buffer_load_dwordx4 v5, s[36:39], s92 offen lds
    s_add_u32 m0, s74, 33792
    s_add_u32 s92, s80, 40960
    buffer_load_dwordx4 v5, s[36:39], s92 offen lds
.Lhsc_3_2:
.Lhp_68:
    s_cbranch_execz .Lhp_69
    s_add_u32 m0, s74, 34816
    s_add_u32 s92, s81, 32768
    buffer_load_dwordx4 v5, s[36:39], s92 offen lds
    s_add_u32 m0, s74, 35840
    s_add_u32 s92, s81, 40960
    buffer_load_dwordx4 v5, s[36:39], s92 offen lds
    s_add_u32 m0, s74, 36864
    s_add_u32 s92, s82, 32768
    buffer_load_dwordx4 v5, s[36:39], s92 offen lds
    s_add_u32 m0, s74, 37888
    s_add_u32 s92, s82, 40960
    buffer_load_dwordx4 v5, s[36:39], s92 offen lds
    s_add_u32 m0, s74, 38912
    s_add_u32 s92, s83, 32768
    buffer_load_dwordx4 v5, s[36:39], s92 offen lds
    s_add_u32 m0, s74, 39936
    s_add_u32 s92, s83, 40960
    buffer_load_dwordx4 v5, s[36:39], s92 offen lds
    s_load_dwordx2 s[86:87], s[44:45], 0xa843c
    s_load_dwordx2 s[86:87], s[44:45], 0xae43c
    s_load_dwordx2 s[86:87], s[44:45], 0xb443c
    s_load_dwordx2 s[86:87], s[44:45], 0xba43c
    s_barrier
    s_add_u32 m0, s74, 65536
    s_add_u32 s92, s80, 49152
    buffer_load_dwordx4 v5, s[36:39], s92 offen lds
    s_add_u32 m0, s74, 66560
    s_add_u32 s92, s80, 57344
    buffer_load_dwordx4 v5, s[36:39], s92 offen lds
    s_add_u32 m0, s74, 67584
    s_add_u32 s92, s81, 49152
    buffer_load_dwordx4 v5, s[36:39], s92 offen lds
    s_add_u32 m0, s74, 68608
    s_add_u32 s92, s81, 57344
    buffer_load_dwordx4 v5, s[36:39], s92 offen lds
    s_add_u32 m0, s74, 69632
    s_add_u32 s92, s82, 49152
    buffer_load_dwordx4 v5, s[36:39], s92 offen lds
    s_add_u32 m0, s74, 70656
    s_add_u32 s92, s82, 57344
    buffer_load_dwordx4 v5, s[36:39], s92 offen lds
    s_add_u32 m0, s74, 71680
    s_add_u32 s92, s83, 49152
    buffer_load_dwordx4 v5, s[36:39], s92 offen lds
    s_add_u32 m0, s74, 72704
    s_add_u32 s92, s83, 57344
    buffer_load_dwordx4 v5, s[36:39], s92 offen lds
    s_add_u32 s44, s44, 786432
    s_addc_u32 s45, s45, 0
    s_load_dwordx2 s[86:87], s[44:45], 0x43c
    s_load_dwordx2 s[86:87], s[44:45], 0x643c
    s_load_dwordx2 s[86:87], s[44:45], 0xc43c
    s_load_dwordx2 s[86:87], s[44:45], 0x1243c
    s_waitcnt vmcnt(16)
    s_barrier
    s_load_dwordx2 s[86:87], s[44:45], 0x1843c
    s_load_dwordx2 s[86:87], s[44:45], 0x1e43c
    s_load_dwordx2 s[86:87], s[44:45], 0x2443c
    s_load_dwordx2 s[86:87], s[44:45], 0x2a43c
    s_load_dwordx2 s[86:87], s[44:45], 0x3043c
    s_load_dwordx2 s[86:87], s[44:45], 0x3643c
    s_load_dwordx2 s[86:87], s[44:45], 0x3c43c
    s_waitcnt vmcnt(8)
    s_barrier
    s_add_u32 s92, s74, 98304
    v_add_u32 v13, s92, v1
    ds_write_b128 v13, v[16:19] offset:0
.Lhsc_3_3:
.Lhp_69:
    s_cbranch_execz .Lhp_70
    ds_write_b128 v13, v[20:23] offset:1024
    ds_write_b128 v13, v[24:27] offset:2048
    ds_write_b128 v13, v[28:31] offset:3072
    ds_write_b128 v13, v[32:35] offset:4096
    ds_write_b128 v13, v[36:39] offset:5120
    ds_write_b128 v13, v[40:43] offset:6144
    ds_write_b128 v13, v[44:47] offset:7168
    s_waitcnt lgkmcnt(0)
    s_load_dwordx2 s[86:87], s[44:45], 0x4243c
    s_load_dwordx2 s[86:87], s[44:45], 0x4843c
    s_load_dwordx2 s[86:87], s[44:45], 0x4e43c
    s_load_dwordx2 s[86:87], s[44:45], 0x5443c
    s_load_dwordx2 s[86:87], s[44:45], 0x5a43c
    s_load_dwordx2 s[86:87], s[44:45], 0x6043c
    s_load_dwordx2 s[86:87], s[44:45], 0x6643c
    s_waitcnt vmcnt(0)
    s_barrier
    s_mul_i32 s92, s70, 3072
    s_add_u32 s92, s92, 0
    v_add_u32 v13, s92, v1
    ds_write_b128 v13, v[48:51] offset:0
    ds_write_b128 v13, v[52:55] offset:1024
    ds_write_b128 v13, v[56:59] offset:2048
    s_waitcnt lgkmcnt(0)
    s_load_dwordx2 s[86:87], s[44:45], 0x6c43c
    s_load_dwordx2 s[86:87], s[44:45], 0x7243c
    s_load_dwordx2 s[86:87], s[44:45], 0x7843c
    s_load_dwordx2 s[86:87], s[44:45], 0x7e43c
    s_load_dwordx2 s[86:87], s[44:45], 0x8443c
    s_load_dwordx2 s[86:87], s[44:45], 0x8a43c
    s_load_dwordx2 s[86:87], s[44:45], 0x9043c
    s_barrier
    s_load_dwordx2 s[86:87], s[44:45], 0x9643c
    s_load_dwordx2 s[86:87], s[44:45], 0x9c43c
    s_load_dwordx2 s[86:87], s[44:45], 0xa243c
    s_load_dwordx2 s[86:87], s[44:45], 0xa843c
    s_load_dwordx2 s[86:87], s[44:45], 0xae43c
    s_load_dwordx2 s[86:87], s[44:45], 0xb443c
    s_load_dwordx2 s[86:87], s[44:45], 0xba43c
    s_barrier
    s_add_u32 m0, s74, 32768
    s_add_u32 s92, s75, 0
    buffer_load_dwordx4 v2, s[16:19], s92 offen lds
    s_add_u32 m0, s74, 33792
    s_add_u32 s92, s75, 24576
    buffer_load_dwordx4 v2, s[16:19], s92 offen lds
    s_add_u32 m0, s74, 34816
    s_add_u32 s92, s75, 49152
    buffer_load_dwordx4 v2, s[16:19], s92 offen lds
    s_add_u32 m0, s74, 35840
    s_add_u32 s92, s75, 73728
    buffer_load_dwordx4 v2, s[16:19], s92 offen lds
    s_add_u32 m0, s74, 36864
    s_add_u32 s92, s75, 98304
    buffer_load_dwordx4 v2, s[16:19], s92 offen lds
    s_add_u32 m0, s74, 37888
    s_add_u32 s92, s75, 122880
    buffer_load_dwordx4 v2, s[16:19], s92 offen lds
    s_add_u32 m0, s74, 38912
    s_add_u32 s92, s75, 147456
    buffer_load_dwordx4 v2, s[16:19], s92 offen lds
    s_add_u32 m0, s74, 39936
    s_add_u32 s92, s75, 172032
    buffer_load_dwordx4 v2, s[16:19], s92 offen lds
    s_barrier
    s_add_u32 m0, s74, 65536
    s_add_u32 s92, s75, 786432
    buffer_load_dwordx4 v2, s[16:19], s92 offen lds
.Lhp_70:
    s_cbranch_execz .Lhp_71
    s_add_u32 m0, s74, 66560
    s_add_u32 s92, s75, 811008
    buffer_load_dwordx4 v2, s[16:19], s92 offen lds
    s_add_u32 m0, s74, 67584
    s_add_u32 s92, s75, 835584
    buffer_load_dwordx4 v2, s[16:19], s92 offen lds
    s_add_u32 m0, s74, 68608
    s_add_u32 s92, s75, 860160
    buffer_load_dwordx4 v2, s[16:19], s92 offen lds
    s_add_u32 m0, s74, 69632
    s_add_u32 s92, s75, 884736
    buffer_load_dwordx4 v2, s[16:19], s92 offen lds
    s_add_u32 m0, s74, 70656
    s_add_u32 s92, s75, 909312
    buffer_load_dwordx4 v2, s[16:19], s92 offen lds
    s_add_u32 m0, s74, 71680
    s_add_u32 s92, s75, 933888
    buffer_load_dwordx4 v2, s[16:19], s92 offen lds
    s_add_u32 m0, s74, 72704
    s_add_u32 s92, s75, 958464
    buffer_load_dwordx4 v2, s[16:19], s92 offen lds
    s_mul_i32 s90, s79, 3072
    s_add_u32 s100, s46, s90
    s_addc_u32 s101, s47, 0
    s_load_dwordx2 s[86:87], s[100:101], 0x1bc
    s_load_dwordx2 s[86:87], s[100:101], 0x601bc
    s_load_dwordx2 s[86:87], s[100:101], 0xc01bc
    s_add_u32 s100, s100, 1048576
    s_addc_u32 s101, s101, 0
    s_load_dwordx2 s[86:87], s[100:101], 0x201bc
    s_mul_i32 s90, s79, 1024
    s_add_u32 s100, s50, s90
    s_addc_u32 s101, s51, 0
    s_load_dwordx2 s[86:87], s[100:101], 0x1bc
    s_load_dwordx2 s[86:87], s[100:101], 0x201bc
    s_load_dwordx2 s[86:87], s[100:101], 0x401bc
    s_load_dwordx2 s[86:87], s[100:101], 0x601bc
    s_waitcnt vmcnt(8)
    s_barrier
    s_waitcnt vmcnt(0)
    s_barrier
    s_barrier
    s_add_u32 m0, s74, 98304
    s_add_u32 s92, s75, 0
    buffer_load_dwordx4 v4, s[16:19], s92 offen lds
    s_add_u32 m0, s74, 99328
    s_add_u32 s92, s75, 24576
    buffer_load_dwordx4 v4, s[16:19], s92 offen lds
    s_add_u32 m0, s74, 100352
    s_add_u32 s92, s75, 49152
    buffer_load_dwordx4 v4, s[16:19], s92 offen lds
    s_add_u32 m0, s74, 101376
    s_add_u32 s92, s75, 73728
    buffer_load_dwordx4 v4, s[16:19], s92 offen lds
    s_add_u32 m0, s74, 102400
    s_add_u32 s92, s75, 98304
    buffer_load_dwordx4 v4, s[16:19], s92 offen lds
    s_add_u32 m0, s74, 103424
    s_add_u32 s92, s75, 122880
    buffer_load_dwordx4 v4, s[16:19], s92 offen lds
    s_add_u32 m0, s74, 104448
    s_add_u32 s92, s75, 147456
    buffer_load_dwordx4 v4, s[16:19], s92 offen lds
    s_add_u32 m0, s74, 105472
    s_add_u32 s92, s75, 172032
    buffer_load_dwordx4 v4, s[16:19], s92 offen lds
    s_waitcnt vmcnt(0)
    s_nop 0
    s_lshl_b32 s95, s3, 2
    s_add_u32 s95, s95, 163200
    v_mov_b32 v13, s95
.Lhsc_3_4:
.Lhp_71:
    s_cbranch_execz .Lhp_72
    v_mov_b32 v14, 2
    ds_write_b32 v13, v14
    s_add_u32 m0, s74, 0
    s_add_u32 s92, s76, 0
    buffer_load_dwordx4 v5, s[24:27], s92 offen lds
    s_add_u32 m0, s74, 1024
    s_add_u32 s92, s76, 8192
    buffer_load_dwordx4 v5, s[24:27], s92 offen lds
    s_add_u32 m0, s74, 2048
    s_add_u32 s92, s76, 16384
    buffer_load_dwordx4 v5, s[24:27], s92 offen lds
    s_add_u32 m0, s74, 3072
    s_add_u32 s92, s76, 24576
    buffer_load_dwordx4 v5, s[24:27], s92 offen lds
    s_add_u32 m0, s74, 4096
    s_add_u32 s92, s76, 32768
    buffer_load_dwordx4 v5, s[24:27], s92 offen lds
    s_add_u32 m0, s74, 5120
    s_add_u32 s92, s76, 40960
    buffer_load_dwordx4 v5, s[24:27], s92 offen lds
    s_add_u32 m0, s74, 6144
    s_add_u32 s92, s76, 49152
    buffer_load_dwordx4 v5, s[24:27], s92 offen lds
    s_add_u32 m0, s74, 7168
    s_add_u32 s92, s76, 57344
    buffer_load_dwordx4 v5, s[24:27], s92 offen lds
    s_add_u32 m0, s74, 32768
    s_add_u32 s92, s76, 262144
    buffer_load_dwordx4 v5, s[24:27], s92 offen lds
    s_add_u32 m0, s74, 33792
    s_add_u32 s92, s76, 270336
    buffer_load_dwordx4 v5, s[24:27], s92 offen lds
    s_add_u32 m0, s74, 34816
    s_add_u32 s92, s76, 278528
    buffer_load_dwordx4 v5, s[24:27], s92 offen lds
    s_add_u32 m0, s74, 35840
    s_add_u32 s92, s76, 286720
    buffer_load_dwordx4 v5, s[24:27], s92 offen lds
    s_add_u32 m0, s74, 36864
    s_add_u32 s92, s76, 294912
    buffer_load_dwordx4 v5, s[24:27], s92 offen lds
    s_add_u32 m0, s74, 37888
    s_add_u32 s92, s76, 303104
    buffer_load_dwordx4 v5, s[24:27], s92 offen lds
    s_add_u32 m0, s74, 38912
    s_add_u32 s92, s76, 311296
    buffer_load_dwordx4 v5, s[24:27], s92 offen lds
    s_add_u32 m0, s74, 39936
    s_add_u32 s92, s76, 319488
    buffer_load_dwordx4 v5, s[24:27], s92 offen lds
    s_waitcnt lgkmcnt(0)
    s_waitcnt vmcnt(0)
    s_barrier
    ds_write_b128 v7, v[64:67] offset:0
    ds_write_b128 v7, v[88:91] offset:4096
    ds_write_b128 v7, v[112:115] offset:8192
    ds_write_b128 v7, v[136:139] offset:12288
    ds_write_b128 v7, v[68:71] offset:16384
    ds_write_b128 v7, v[92:95] offset:20480
    ds_write_b128 v7, v[116:119] offset:24576
    ds_write_b128 v7, v[140:143] offset:28672
    ds_write_b128 v7, v[160:163] offset:32768
    ds_write_b128 v7, v[184:187] offset:36864
    ds_write_b128 v7, v[208:211] offset:40960
    ds_write_b128 v7, v[232:235] offset:45056
    ds_write_b128 v7, v[164:167] offset:49152
    ds_write_b128 v7, v[188:191] offset:53248
.Lhsc_3_5:
.Lhp_72:
    s_cbranch_execz .Lhp_73
    ds_write_b128 v7, v[212:215] offset:57344
    ds_write_b128 v7, v[236:239] offset:61440
    s_waitcnt lgkmcnt(0)
    s_barrier
    s_mul_i32 s92, s79, 4096
    v_min_u32 v13, 31, v0
    v_lshlrev_b32 v13, 7, v13
    buffer_load_dword v61, v13, s[36:39], s92 offen
    s_barrier
    ds_write_b128 v6, v[72:75] offset:0
    ds_write_b128 v6, v[96:99] offset:4096
    ds_write_b128 v6, v[120:123] offset:8192
    ds_write_b128 v6, v[144:147] offset:12288
    ds_write_b128 v6, v[168:171] offset:16384
    ds_write_b128 v6, v[192:195] offset:20480
    ds_write_b128 v6, v[216:219] offset:24576
    ds_write_b128 v6, v[240:243] offset:28672
    ds_write_b128 v6, v[76:79] offset:32768
    ds_write_b128 v6, v[100:103] offset:36864
    ds_write_b128 v6, v[124:127] offset:40960
    ds_write_b128 v6, v[148:151] offset:45056
    ds_write_b128 v6, v[172:175] offset:49152
    ds_write_b128 v6, v[196:199] offset:53248
    ds_write_b128 v6, v[220:223] offset:57344
    ds_write_b128 v6, v[244:247] offset:61440
    s_waitcnt lgkmcnt(0)
    s_barrier
    s_barrier
    ds_write_b128 v7, v[80:83] offset:0
    ds_write_b128 v7, v[104:107] offset:4096
    ds_write_b128 v7, v[128:131] offset:8192
    ds_write_b128 v7, v[152:155] offset:12288
    ds_write_b128 v7, v[176:179] offset:16384
    ds_write_b128 v7, v[200:203] offset:20480
    ds_write_b128 v7, v[224:227] offset:24576
    ds_write_b128 v7, v[248:251] offset:28672
    s_mul_i32 s92, s79, 6912
    s_add_u32 s92, s92, 524288
    v_min_u32 v13, 53, v0
    v_lshlrev_b32 v13, 7, v13
    buffer_load_dword v62, v13, s[36:39], s92 offen
    s_barrier
    ds_write_b128 v7, v[84:87] offset:32768
    ds_write_b128 v7, v[108:111] offset:36864
    ds_write_b128 v7, v[132:135] offset:40960
    ds_write_b128 v7, v[156:159] offset:45056
    ds_write_b128 v7, v[180:183] offset:49152
    ds_write_b128 v7, v[204:207] offset:53248
    ds_write_b128 v7, v[228:231] offset:57344
    ds_write_b128 v7, v[252:255] offset:61440
    s_waitcnt lgkmcnt(8)
    s_barrier
    s_add_u32 m0, s74, 0
    s_add_u32 s92, s80, 0
    buffer_load_dwordx4 v5, s[36:39], s92 offen lds
    s_add_u32 m0, s74, 1024
    s_add_u32 s92, s80, 8192
    buffer_load_dwordx4 v5, s[36:39], s92 offen lds
    s_add_u32 m0, s74, 2048
    s_add_u32 s92, s81, 0
    buffer_load_dwordx4 v5, s[36:39], s92 offen lds
    s_add_u32 m0, s74, 3072
    s_add_u32 s92, s81, 8192
    buffer_load_dwordx4 v5, s[36:39], s92 offen lds
    s_add_u32 m0, s74, 4096
    s_add_u32 s92, s82, 0
    buffer_load_dwordx4 v5, s[36:39], s92 offen lds
    s_add_u32 m0, s74, 5120
    s_add_u32 s92, s82, 8192
    buffer_load_dwordx4 v5, s[36:39], s92 offen lds
    s_add_u32 m0, s74, 6144
    s_add_u32 s92, s83, 0
.Lhsc_3_6:
.Lhp_73:
    s_cbranch_execz .Lhp_74
    buffer_load_dwordx4 v5, s[36:39], s92 offen lds
    s_add_u32 m0, s74, 7168
    s_add_u32 s92, s83, 8192
    buffer_load_dwordx4 v5, s[36:39], s92 offen lds
    s_add_u32 s92, s80, 65536
    buffer_load_dwordx4 v[160:163], v5, s[36:39], s92 offen
    s_add_u32 s92, s80, 73728
    buffer_load_dwordx4 v[164:167], v5, s[36:39], s92 offen
    s_add_u32 s92, s81, 65536
    buffer_load_dwordx4 v[184:187], v5, s[36:39], s92 offen
    s_add_u32 s92, s81, 73728
    buffer_load_dwordx4 v[188:191], v5, s[36:39], s92 offen
    s_add_u32 s92, s82, 65536
    buffer_load_dwordx4 v[208:211], v5, s[36:39], s92 offen
    s_add_u32 s92, s82, 73728
    buffer_load_dwordx4 v[212:215], v5, s[36:39], s92 offen
    s_add_u32 s92, s83, 65536
    buffer_load_dwordx4 v[232:235], v5, s[36:39], s92 offen
    s_add_u32 s92, s83, 73728
    buffer_load_dwordx4 v[236:239], v5, s[36:39], s92 offen
    s_mul_i32 s93, s70, 3
    s_add_u32 s93, s93, 0
    s_lshr_b32 s92, s93, 1
    s_mul_i32 s92, s92, 98304
    s_and_b32 s94, s93, 1
    s_lshl_b32 s94, s94, 13
    s_add_u32 s92, s92, s94
    s_add_u32 s92, s92, s78
    buffer_load_dwordx4 v[168:171], v5, s[36:39], s92 offen
    s_mul_i32 s93, s70, 3
    s_add_u32 s93, s93, 1
    s_lshr_b32 s92, s93, 1
    s_mul_i32 s92, s92, 98304
    s_and_b32 s94, s93, 1
    s_lshl_b32 s94, s94, 13
    s_add_u32 s92, s92, s94
    s_add_u32 s92, s92, s78
    buffer_load_dwordx4 v[172:175], v5, s[36:39], s92 offen
    s_mul_i32 s93, s70, 3
    s_add_u32 s93, s93, 2
    s_lshr_b32 s92, s93, 1
    s_mul_i32 s92, s92, 98304
    s_and_b32 s94, s93, 1
    s_lshl_b32 s94, s94, 13
    s_add_u32 s92, s92, s94
    s_add_u32 s92, s92, s78
    buffer_load_dwordx4 v[192:195], v5, s[36:39], s92 offen
    s_waitcnt lgkmcnt(0)
    s_barrier
    s_add_u32 m0, s74, 32768
    s_add_u32 s92, s80, 16384
    buffer_load_dwordx4 v5, s[36:39], s92 offen lds
    s_add_u32 m0, s74, 33792
    s_add_u32 s92, s80, 24576
    buffer_load_dwordx4 v5, s[36:39], s92 offen lds
    s_add_u32 m0, s74, 34816
    s_add_u32 s92, s81, 16384
    buffer_load_dwordx4 v5, s[36:39], s92 offen lds
    s_add_u32 m0, s74, 35840
    s_add_u32 s92, s81, 24576
    buffer_load_dwordx4 v5, s[36:39], s92 offen lds
    s_add_u32 m0, s74, 36864
    s_add_u32 s92, s82, 16384
    buffer_load_dwordx4 v5, s[36:39], s92 offen lds
    s_add_u32 m0, s74, 37888
    s_add_u32 s92, s82, 24576
    buffer_load_dwordx4 v5, s[36:39], s92 offen lds
    s_add_u32 m0, s74, 38912
    s_add_u32 s92, s83, 16384
    buffer_load_dwordx4 v5, s[36:39], s92 offen lds
    s_add_u32 m0, s74, 39936
    s_add_u32 s92, s83, 24576
    buffer_load_dwordx4 v5, s[36:39], s92 offen lds
    s_waitcnt vmcnt(19)
    s_barrier
    s_add_u32 m0, s74, 65536
.Lhsc_3_7:
.Lhp_74:
    s_cbranch_execz .Lhp_75
    s_add_u32 s92, s80, 32768
    buffer_load_dwordx4 v5, s[36:39], s92 offen lds
    s_add_u32 m0, s74, 66560
    s_add_u32 s92, s80, 40960
    buffer_load_dwordx4 v5, s[36:39], s92 offen lds
    s_add_u32 m0, s74, 67584
    s_add_u32 s92, s81, 32768
    buffer_load_dwordx4 v5, s[36:39], s92 offen lds
    s_add_u32 m0, s74, 68608
    s_add_u32 s92, s81, 40960
    buffer_load_dwordx4 v5, s[36:39], s92 offen lds
    s_add_u32 m0, s74, 69632
    s_add_u32 s92, s82, 32768
    buffer_load_dwordx4 v5, s[36:39], s92 offen lds
    s_add_u32 m0, s74, 70656
    s_add_u32 s92, s82, 40960
    buffer_load_dwordx4 v5, s[36:39], s92 offen lds
    s_add_u32 m0, s74, 71680
    s_add_u32 s92, s83, 32768
    buffer_load_dwordx4 v5, s[36:39], s92 offen lds
    s_add_u32 m0, s74, 72704
    s_add_u32 s92, s83, 40960
    buffer_load_dwordx4 v5, s[36:39], s92 offen lds
    s_barrier
    s_add_u32 m0, s74, 98304
    s_add_u32 s92, s80, 49152
    buffer_load_dwordx4 v5, s[36:39], s92 offen lds
    s_add_u32 m0, s74, 99328
    s_add_u32 s92, s80, 57344
    buffer_load_dwordx4 v5, s[36:39], s92 offen lds
    s_add_u32 m0, s74, 100352
    s_add_u32 s92, s81, 49152
    buffer_load_dwordx4 v5, s[36:39], s92 offen lds
    s_add_u32 m0, s74, 101376
    s_add_u32 s92, s81, 57344
    buffer_load_dwordx4 v5, s[36:39], s92 offen lds
    s_add_u32 m0, s74, 102400
    s_add_u32 s92, s82, 49152
    buffer_load_dwordx4 v5, s[36:39], s92 offen lds
    s_add_u32 m0, s74, 103424
    s_add_u32 s92, s82, 57344
    buffer_load_dwordx4 v5, s[36:39], s92 offen lds
    s_add_u32 m0, s74, 104448
    s_add_u32 s92, s83, 49152
    buffer_load_dwordx4 v5, s[36:39], s92 offen lds
    s_add_u32 m0, s74, 105472
    s_add_u32 s92, s83, 57344
    buffer_load_dwordx4 v5, s[36:39], s92 offen lds
    s_waitcnt vmcnt(16)
    s_barrier
    s_waitcnt vmcnt(8)
    s_barrier
    s_add_u32 s92, s74, 0
    v_add_u32 v13, s92, v1
    ds_write_b128 v13, v[160:163] offset:0
    ds_write_b128 v13, v[164:167] offset:1024
    ds_write_b128 v13, v[184:187] offset:2048
    ds_write_b128 v13, v[188:191] offset:3072
    ds_write_b128 v13, v[208:211] offset:4096
    ds_write_b128 v13, v[212:215] offset:5120
    ds_write_b128 v13, v[232:235] offset:6144
    ds_write_b128 v13, v[236:239] offset:7168
    s_waitcnt lgkmcnt(0)
    s_waitcnt vmcnt(0)
    s_barrier
    s_mul_i32 s92, s70, 3072
    s_add_u32 s92, s92, 32768
    v_add_u32 v13, s92, v1
    ds_write_b128 v13, v[168:171] offset:0
.Lhp_75:
    s_cbranch_execz .Lhbrc
    ds_write_b128 v13, v[172:175] offset:1024
    ds_write_b128 v13, v[192:195] offset:2048
    s_waitcnt lgkmcnt(0)
    s_barrier
    s_barrier
    s_barrier
    s_branch .Lend
.Lslow:
.Lpair_s:
.Lpoll_82:
    buffer_load_dword v13, v3, s[4:7], s76 offen offset:0 sc1
    s_waitcnt vmcnt(0)
    v_cmp_ne_u32 vcc, s71, v13
    s_cbranch_vccz .Lpdone_83
    s_sub_u32 s72, s72, 1
    s_cbranch_scc0 .Lpoll_82
    s_mov_b32 s72, 0
.Lpdone_83:
    s_add_u32 s48, s74, 0
    buffer_load_dwordx4 v[128:131], v1, s[4:7], s48 offen offset:0 sc1
    buffer_load_dwordx4 v[132:135], v1, s[4:7], s48 offen offset:1024 sc1
    buffer_load_dwordx4 v[136:139], v1, s[4:7], s48 offen offset:2048 sc1
    buffer_load_dwordx4 v[140:143], v1, s[4:7], s48 offen offset:3072 sc1
    s_add_u32 s48, s74, 4096
    buffer_load_dwordx4 v[144:147], v1, s[4:7], s48 offen offset:0 sc1
    buffer_load_dwordx4 v[148:151], v1, s[4:7], s48 offen offset:1024 sc1
    buffer_load_dwordx4 v[152:155], v1, s[4:7], s48 offen offset:2048 sc1
    buffer_load_dwordx4 v[156:159], v1, s[4:7], s48 offen offset:3072 sc1
    s_add_u32 s48, s74, 8192
    buffer_load_dwordx4 v[160:163], v1, s[4:7], s48 offen offset:0 sc1
    buffer_load_dwordx4 v[164:167], v1, s[4:7], s48 offen offset:1024 sc1
    s_add_u32 s71, s71, 1
    v_add_u32 v12, 1, v12
    s_barrier
    ds_read_b64_tr_b16 v[64:65], v2 offset:0
    ds_read_b64_tr_b16 v[66:67], v2 offset:512
    ds_read_b64_tr_b16 v[68:69], v121 offset:0
    ds_read_b64_tr_b16 v[70:71], v121 offset:512
    ds_read_b64_tr_b16 v[72:73], v2 offset:2048
    ds_read_b64_tr_b16 v[74:75], v2 offset:2560
    ds_read_b64_tr_b16 v[76:77], v121 offset:2048
    ds_read_b64_tr_b16 v[78:79], v121 offset:2560
    ds_read_b64_tr_b16 v[80:81], v2 offset:4096
    ds_read_b64_tr_b16 v[82:83], v2 offset:4608
    s_waitcnt vmcnt(9) lgkmcnt(8)
    v_mfma_f32_32x32x16_bf16 v[16:31], v[64:67], v[128:131], 0
    ds_read_b64_tr_b16 v[84:85], v121 offset:4096
    ds_read_b64_tr_b16 v[86:87], v121 offset:4608
    s_waitcnt lgkmcnt(8)
    v_mfma_f32_32x32x16_bf16 v[32:47], v[68:71], v[128:131], 0
    ds_read_b64_tr_b16 v[64:65], v2 offset:6144
    ds_read_b64_tr_b16 v[66:67], v2 offset:6656
    buffer_load_dwordx4 v[168:171], v1, s[4:7], s48 offen offset:2048 sc1
    s_waitcnt vmcnt(9) lgkmcnt(8)
    v_mfma_f32_32x32x16_bf16 v[16:31], v[72:75], v[132:135], v[16:31]
    ds_read_b64_tr_b16 v[68:69], v121 offset:6144
    ds_read_b64_tr_b16 v[70:71], v121 offset:6656
    v_lshrrev_b32 v14, 5, v0
    v_and_b32 v13, 1, v0
    s_waitcnt lgkmcnt(8)
    v_mfma_f32_32x32x16_bf16 v[32:47], v[76:79], v[132:135], v[32:47]
    ds_read_b64_tr_b16 v[72:73], v2 offset:8192
    ds_read_b64_tr_b16 v[74:75], v2 offset:8704
    buffer_load_dwordx4 v[172:175], v1, s[4:7], s48 offen offset:3072 sc1
    v_cmp_eq_u32 vcc, v13, v14
    v_lshlrev_b32 v116, 6, v14
    s_waitcnt vmcnt(9) lgkmcnt(8)
    v_mfma_f32_32x32x16_bf16 v[16:31], v[80:83], v[136:139], v[16:31]
    ds_read_b64_tr_b16 v[76:77], v121 offset:8192
    ds_read_b64_tr_b16 v[78:79], v121 offset:8704
    v_add_u32 v116, 162048, v116
    v_lshlrev_b32 v119, 7, v14
    s_waitcnt lgkmcnt(8)
    v_mfma_f32_32x32x16_bf16 v[32:47], v[84:87], v[136:139], v[32:47]
    ds_read_b64_tr_b16 v[80:81], v2 offset:10240
    ds_read_b64_tr_b16 v[82:83], v2 offset:10752
    s_add_u32 s48, s74, 12288
    buffer_load_dwordx4 v[176:179], v1, s[4:7], s48 offen offset:0 sc1
    v_and_b32 v13, 12, v0
    v_lshl_add_u32 v119, v13, 3, v119
    s_waitcnt vmcnt(9) lgkmcnt(8)
    v_mfma_f32_32x32x16_bf16 v[16:31], v[64:67], v[140:143], v[16:31]
    ds_read_b64_tr_b16 v[84:85], v121 offset:10240
    ds_read_b64_tr_b16 v[86:87], v121 offset:10752
    v_and_b32 v13, 16, v0
    v_add_u32 v119, v119, v13
    s_waitcnt lgkmcnt(8)
    v_mfma_f32_32x32x16_bf16 v[32:47], v[68:71], v[140:143], v[32:47]
    ds_read_b64_tr_b16 v[64:65], v2 offset:12288
    ds_read_b64_tr_b16 v[66:67], v2 offset:12800
    buffer_load_dwordx4 v[180:183], v1, s[4:7], s48 offen offset:1024 sc1
    v_and_b32 v13, 2, v0
    v_lshl_add_u32 v119, v13, 2, v119
    s_waitcnt vmcnt(9) lgkmcnt(8)
    v_mfma_f32_32x32x16_bf16 v[16:31], v[72:75], v[144:147], v[16:31]
    ds_read_b64_tr_b16 v[68:69], v121 offset:12288
    ds_read_b64_tr_b16 v[70:71], v121 offset:12800
    v_mov_b32 v13, 544
    v_cndmask_b32 v119, v13, v119, vcc
    s_waitcnt lgkmcnt(8)
    v_mfma_f32_32x32x16_bf16 v[32:47], v[76:79], v[144:147], v[32:47]
    ds_read_b64_tr_b16 v[72:73], v2 offset:14336
    ds_read_b64_tr_b16 v[74:75], v2 offset:14848
    buffer_load_dwordx4 v[184:187], v1, s[4:7], s48 offen offset:2048 sc1
    v_add_u32 v119, 159744, v119
    v_and_b32 v13, 31, v0
    s_waitcnt vmcnt(9) lgkmcnt(8)
    v_mfma_f32_32x32x16_bf16 v[16:31], v[80:83], v[148:151], v[16:31]
    ds_read_b64_tr_b16 v[76:77], v121 offset:14336
    ds_read_b64_tr_b16 v[78:79], v121 offset:14848
    s_lshl_b32 s92, s70, 5
    v_add_u32 v13, s92, v13
    s_waitcnt lgkmcnt(8)
    v_mfma_f32_32x32x16_bf16 v[32:47], v[84:87], v[148:151], v[32:47]
    ds_read_b64_tr_b16 v[80:81], v2 offset:16384
    ds_read_b64_tr_b16 v[82:83], v2 offset:16896
    buffer_load_dwordx4 v[188:191], v1, s[4:7], s48 offen offset:3072 sc1
    v_mul_u32_u24 v117, 144, v13
    v_lshl_add_u32 v117, v14, 6, v117
    s_waitcnt vmcnt(9) lgkmcnt(8)
    v_mfma_f32_32x32x16_bf16 v[16:31], v[64:67], v[152:155], v[16:31]
    ds_read_b64_tr_b16 v[84:85], v121 offset:16384
    ds_read_b64_tr_b16 v[86:87], v121 offset:16896
    v_add_u32 v117, 131072, v117
    v_mul_u32_u24 v118, 80, v13
    s_waitcnt lgkmcnt(8)
    v_mfma_f32_32x32x16_bf16 v[32:47], v[68:71], v[152:155], v[32:47]
    ds_read_b64_tr_b16 v[64:65], v2 offset:18432
    ds_read_b64_tr_b16 v[66:67], v2 offset:18944
    s_add_u32 s48, s74, 16384
    buffer_load_dwordx4 v[192:195], v1, s[4:7], s48 offen offset:0 sc1
    v_lshl_add_u32 v118, v14, 5, v118
    v_add_u32 v118, 149504, v118
    s_waitcnt vmcnt(9) lgkmcnt(8)
    v_mfma_f32_32x32x16_bf16 v[16:31], v[72:75], v[156:159], v[16:31]
    ds_read_b64_tr_b16 v[68:69], v121 offset:18432
    ds_read_b64_tr_b16 v[70:71], v121 offset:18944
    ds_read_b128 v[48:51], v116 offset:0
    ds_read_b128 v[52:55], v116 offset:16
    s_waitcnt lgkmcnt(10)
    v_mfma_f32_32x32x16_bf16 v[32:47], v[76:79], v[156:159], v[32:47]
    ds_read_b64_tr_b16 v[72:73], v2 offset:20480
    ds_read_b64_tr_b16 v[74:75], v2 offset:20992
    buffer_load_dwordx4 v[196:199], v1, s[4:7], s48 offen offset:1024 sc1
    ds_read_b128 v[56:59], v116 offset:32
    ds_read_b128 v[60:63], v116 offset:48
    s_waitcnt vmcnt(9) lgkmcnt(12)
    v_mfma_f32_32x32x16_bf16 v[16:31], v[80:83], v[160:163], v[16:31]
    ds_read_b64_tr_b16 v[76:77], v121 offset:20480
    ds_read_b64_tr_b16 v[78:79], v121 offset:20992
    ds_read_b64_tr_b16 v[88:89], v119 offset:0
    ds_read_b64_tr_b16 v[90:91], v119 offset:576
    s_waitcnt lgkmcnt(14)
    v_mfma_f32_32x32x16_bf16 v[32:47], v[84:87], v[160:163], v[32:47]
    ds_read_b64_tr_b16 v[80:81], v2 offset:22528
    ds_read_b64_tr_b16 v[82:83], v2 offset:23040
    buffer_load_dwordx4 v[200:203], v1, s[4:7], s48 offen offset:2048 sc1
    ds_read_b64_tr_b16 v[92:93], v119 offset:1152
    ds_read_b64_tr_b16 v[94:95], v119 offset:1728
    s_waitcnt vmcnt(9) lgkmcnt(15)
    v_mfma_f32_32x32x16_bf16 v[16:31], v[64:67], v[164:167], v[16:31]
    ds_read_b64_tr_b16 v[84:85], v121 offset:22528
    ds_read_b64_tr_b16 v[86:87], v121 offset:23040
    s_waitcnt lgkmcnt(15)
    v_mfma_f32_32x32x16_bf16 v[32:47], v[68:71], v[164:167], v[32:47]
    ds_read_b64_tr_b16 v[64:65], v2 offset:24576
    ds_read_b64_tr_b16 v[66:67], v2 offset:25088
    buffer_load_dwordx4 v[204:207], v1, s[4:7], s48 offen offset:3072 sc1
    s_waitcnt vmcnt(9) lgkmcnt(14)
    v_mfma_f32_32x32x16_bf16 v[16:31], v[72:75], v[168:171], v[16:31]
    s_barrier
    ds_read_b64_tr_b16 v[68:69], v121 offset:24576
    ds_read_b64_tr_b16 v[70:71], v121 offset:25088
    s_waitcnt lgkmcnt(12)
    v_mfma_f32_32x32x16_bf16 v[32:47], v[76:79], v[168:171], v[32:47]
    ds_read_b64_tr_b16 v[72:73], v2 offset:26624
    ds_read_b64_tr_b16 v[74:75], v2 offset:27136
    s_add_u32 s48, s74, 20480
    buffer_load_dwordx4 v[208:211], v1, s[4:7], s48 offen offset:0 sc1
    s_waitcnt vmcnt(9) lgkmcnt(10)
    v_mfma_f32_32x32x16_bf16 v[16:31], v[80:83], v[172:175], v[16:31]
    ds_read_b64_tr_b16 v[76:77], v121 offset:26624
    ds_read_b64_tr_b16 v[78:79], v121 offset:27136
    s_waitcnt lgkmcnt(8)
    v_mfma_f32_32x32x16_bf16 v[32:47], v[84:87], v[172:175], v[32:47]
    ds_read_b64_tr_b16 v[80:81], v2 offset:28672
    ds_read_b64_tr_b16 v[82:83], v2 offset:29184
    buffer_load_dwordx4 v[212:215], v1, s[4:7], s48 offen offset:1024 sc1
    s_waitcnt vmcnt(9) lgkmcnt(8)
    v_mfma_f32_32x32x16_bf16 v[16:31], v[64:67], v[176:179], v[16:31]
    ds_read_b64_tr_b16 v[84:85], v121 offset:28672
    ds_read_b64_tr_b16 v[86:87], v121 offset:29184
    s_waitcnt lgkmcnt(8)
    v_mfma_f32_32x32x16_bf16 v[32:47], v[68:71], v[176:179], v[32:47]
    ds_read_b64_tr_b16 v[64:65], v2 offset:30720
    ds_read_b64_tr_b16 v[66:67], v2 offset:31232
    buffer_load_dwordx4 v[96:99], v15, s[4:7], s75 offen offset:0 sc1
    buffer_load_dwordx4 v[100:103], v15, s[4:7], s75 offen offset:512 sc1
    buffer_load_dwordx4 v[104:107], v15, s[4:7], s75 offen offset:1024 sc1
    buffer_load_dwordx4 v[108:111], v15, s[4:7], s75 offen offset:1536 sc1
    s_waitcnt vmcnt(12) lgkmcnt(8)
    v_mfma_f32_32x32x16_bf16 v[16:31], v[72:75], v[180:183], v[16:31]
    ds_read_b64_tr_b16 v[68:69], v121 offset:30720
    ds_read_b64_tr_b16 v[70:71], v121 offset:31232
    s_waitcnt lgkmcnt(8)
    v_mfma_f32_32x32x16_bf16 v[32:47], v[76:79], v[180:183], v[32:47]
    s_add_u32 s44, s44, 32768
    s_and_b32 s44, s44, 131071
    v_add_u32 v2, s44, v122
    v_xor_b32 v121, 64, v2
    ds_read_b64_tr_b16 v[72:73], v2 offset:0
    ds_read_b64_tr_b16 v[74:75], v2 offset:512
    buffer_load_dwordx4 v[216:219], v1, s[4:7], s48 offen offset:2048 sc1
    s_waitcnt vmcnt(12) lgkmcnt(8)
    v_mfma_f32_32x32x16_bf16 v[16:31], v[80:83], v[184:187], v[16:31]
    ds_read_b64_tr_b16 v[76:77], v121 offset:0
    ds_read_b64_tr_b16 v[78:79], v121 offset:512
    s_waitcnt lgkmcnt(8)
    v_mfma_f32_32x32x16_bf16 v[32:47], v[84:87], v[184:187], v[32:47]
    ds_read_b64_tr_b16 v[80:81], v2 offset:2048
    ds_read_b64_tr_b16 v[82:83], v2 offset:2560
    buffer_load_dwordx4 v[220:223], v1, s[4:7], s48 offen offset:3072 sc1
    s_waitcnt vmcnt(12) lgkmcnt(8)
    v_mfma_f32_32x32x16_bf16 v[16:31], v[64:67], v[188:191], v[16:31]
    ds_read_b64_tr_b16 v[84:85], v121 offset:2048
    ds_read_b64_tr_b16 v[86:87], v121 offset:2560
    s_waitcnt lgkmcnt(8)
    v_mfma_f32_32x32x16_bf16 v[32:47], v[68:71], v[188:191], v[32:47]
    ds_read_b64_tr_b16 v[64:65], v2 offset:4096
    ds_read_b64_tr_b16 v[66:67], v2 offset:4608
    s_add_u32 s48, s74, 24576
    buffer_load_dwordx4 v[224:227], v1, s[4:7], s48 offen offset:0 sc1
    s_waitcnt vmcnt(12) lgkmcnt(8)
    v_mfma_f32_32x32x16_bf16 v[16:31], v[72:75], v[192:195], v[16:31]
    ds_read_b64_tr_b16 v[68:69], v121 offset:4096
    ds_read_b64_tr_b16 v[70:71], v121 offset:4608
    s_waitcnt lgkmcnt(8)
    v_mfma_f32_32x32x16_bf16 v[32:47], v[76:79], v[192:195], v[32:47]
    ds_read_b64_tr_b16 v[72:73], v2 offset:6144
    ds_read_b64_tr_b16 v[74:75], v2 offset:6656
    buffer_load_dwordx4 v[228:231], v1, s[4:7], s48 offen offset:1024 sc1
    s_waitcnt vmcnt(12) lgkmcnt(8)
    v_mfma_f32_32x32x16_bf16 v[16:31], v[80:83], v[196:199], v[16:31]
    ds_read_b64_tr_b16 v[76:77], v121 offset:6144
    ds_read_b64_tr_b16 v[78:79], v121 offset:6656
    s_waitcnt lgkmcnt(8)
    v_mfma_f32_32x32x16_bf16 v[32:47], v[84:87], v[196:199], v[32:47]
    ds_read_b64_tr_b16 v[80:81], v2 offset:8192
    ds_read_b64_tr_b16 v[82:83], v2 offset:8704
    buffer_load_dwordx4 v[232:235], v1, s[4:7], s48 offen offset:2048 sc1
    s_waitcnt vmcnt(12) lgkmcnt(8)
    v_mfma_f32_32x32x16_bf16 v[16:31], v[64:67], v[200:203], v[16:31]
    ds_read_b64_tr_b16 v[84:85], v121 offset:8192
    ds_read_b64_tr_b16 v[86:87], v121 offset:8704
    s_waitcnt lgkmcnt(8)
    v_mfma_f32_32x32x16_bf16 v[32:47], v[68:71], v[200:203], v[32:47]
    ds_read_b64_tr_b16 v[64:65], v2 offset:10240
    ds_read_b64_tr_b16 v[66:67], v2 offset:10752
    buffer_load_dwordx4 v[236:239], v1, s[4:7], s48 offen offset:3072 sc1
    s_waitcnt vmcnt(12) lgkmcnt(8)
    v_mfma_f32_32x32x16_bf16 v[16:31], v[72:75], v[204:207], v[16:31]
    ds_read_b64_tr_b16 v[68:69], v121 offset:10240
    ds_read_b64_tr_b16 v[70:71], v121 offset:10752
    s_waitcnt lgkmcnt(8)
    v_mfma_f32_32x32x16_bf16 v[32:47], v[76:79], v[204:207], v[32:47]
    ds_read_b64_tr_b16 v[72:73], v2 offset:12288
    ds_read_b64_tr_b16 v[74:75], v2 offset:12800
    s_add_u32 s48, s74, 28672
    buffer_load_dwordx4 v[240:243], v1, s[4:7], s48 offen offset:0 sc1
    s_waitcnt vmcnt(12) lgkmcnt(8)
    v_mfma_f32_32x32x16_bf16 v[16:31], v[80:83], v[208:211], v[16:31]
    ds_read_b64_tr_b16 v[76:77], v121 offset:12288
    ds_read_b64_tr_b16 v[78:79], v121 offset:12800
    s_waitcnt lgkmcnt(8)
    v_mfma_f32_32x32x16_bf16 v[32:47], v[84:87], v[208:211], v[32:47]
    ds_read_b64_tr_b16 v[80:81], v2 offset:14336
    ds_read_b64_tr_b16 v[82:83], v2 offset:14848
    buffer_load_dwordx4 v[244:247], v1, s[4:7], s48 offen offset:1024 sc1
    s_waitcnt vmcnt(12) lgkmcnt(8)
    v_mfma_f32_32x32x16_bf16 v[16:31], v[64:67], v[212:215], v[16:31]
    ds_read_b64_tr_b16 v[84:85], v121 offset:14336
    ds_read_b64_tr_b16 v[86:87], v121 offset:14848
    s_waitcnt lgkmcnt(8)
    v_mfma_f32_32x32x16_bf16 v[32:47], v[68:71], v[212:215], v[32:47]
    ds_read_b64_tr_b16 v[64:65], v2 offset:16384
    ds_read_b64_tr_b16 v[66:67], v2 offset:16896
    buffer_load_dwordx4 v[248:251], v1, s[4:7], s48 offen offset:2048 sc1
    s_waitcnt vmcnt(8) lgkmcnt(8)
    v_mfma_f32_32x32x16_bf16 v[16:31], v[72:75], v[216:219], v[16:31]
    ds_read_b64_tr_b16 v[68:69], v121 offset:16384
    ds_read_b64_tr_b16 v[70:71], v121 offset:16896
    s_waitcnt lgkmcnt(8)
    v_mfma_f32_32x32x16_bf16 v[32:47], v[76:79], v[216:219], v[32:47]
    ds_read_b64_tr_b16 v[72:73], v2 offset:18432
    ds_read_b64_tr_b16 v[74:75], v2 offset:18944
    buffer_load_dwordx4 v[252:255], v1, s[4:7], s48 offen offset:3072 sc1
    s_waitcnt vmcnt(8) lgkmcnt(8)
    v_mfma_f32_32x32x16_bf16 v[16:31], v[80:83], v[220:223], v[16:31]
    ds_read_b64_tr_b16 v[76:77], v121 offset:18432
    ds_read_b64_tr_b16 v[78:79], v121 offset:18944
    v_add_f32 v96, v96, v100
    v_add_f32 v97, v97, v101
    s_waitcnt lgkmcnt(8)
    v_mfma_f32_32x32x16_bf16 v[32:47], v[84:87], v[220:223], v[32:47]
    ds_read_b64_tr_b16 v[80:81], v2 offset:20480
    ds_read_b64_tr_b16 v[82:83], v2 offset:20992
    v_add_f32 v98, v98, v102
    v_add_f32 v99, v99, v103
    s_waitcnt vmcnt(7) lgkmcnt(8)
    v_mfma_f32_32x32x16_bf16 v[16:31], v[64:67], v[224:227], v[16:31]
    ds_read_b64_tr_b16 v[84:85], v121 offset:20480
    ds_read_b64_tr_b16 v[86:87], v121 offset:20992
    v_add_f32 v104, v104, v108
    v_add_f32 v105, v105, v109
    s_waitcnt lgkmcnt(8)
    v_mfma_f32_32x32x16_bf16 v[32:47], v[68:71], v[224:227], v[32:47]
    ds_read_b64_tr_b16 v[64:65], v2 offset:22528
    ds_read_b64_tr_b16 v[66:67], v2 offset:23040
    v_add_f32 v106, v106, v110
    v_add_f32 v107, v107, v111
    s_waitcnt vmcnt(6) lgkmcnt(8)
    v_mfma_f32_32x32x16_bf16 v[16:31], v[72:75], v[228:231], v[16:31]
    ds_read_b64_tr_b16 v[68:69], v121 offset:22528
    ds_read_b64_tr_b16 v[70:71], v121 offset:23040
    v_add_f32 v96, v96, v104
    v_add_f32 v97, v97, v105
    s_waitcnt lgkmcnt(8)
    v_mfma_f32_32x32x16_bf16 v[32:47], v[76:79], v[228:231], v[32:47]
    ds_read_b64_tr_b16 v[72:73], v2 offset:24576
    ds_read_b64_tr_b16 v[74:75], v2 offset:25088
    v_add_f32 v98, v98, v106
    v_add_f32 v99, v99, v107
    s_waitcnt vmcnt(5) lgkmcnt(8)
    v_mfma_f32_32x32x16_bf16 v[16:31], v[80:83], v[232:235], v[16:31]
    ds_read_b64_tr_b16 v[76:77], v121 offset:24576
    ds_read_b64_tr_b16 v[78:79], v121 offset:25088
    v_add_f32 v96, v96, v98
    v_add_f32 v97, v97, v99
    s_waitcnt lgkmcnt(8)
    v_mfma_f32_32x32x16_bf16 v[32:47], v[84:87], v[232:235], v[32:47]
    ds_read_b64_tr_b16 v[80:81], v2 offset:26624
    ds_read_b64_tr_b16 v[82:83], v2 offset:27136
    v_mov_b32 v98, v96
    v_mov_b32 v99, v97
    s_waitcnt vmcnt(4) lgkmcnt(8)
    v_mfma_f32_32x32x16_bf16 v[16:31], v[64:67], v[236:239], v[16:31]
    ds_read_b64_tr_b16 v[84:85], v121 offset:26624
    ds_read_b64_tr_b16 v[86:87], v121 offset:27136
    v_permlane32_swap_b32 v96, v98
    v_permlane32_swap_b32 v97, v99
    s_waitcnt lgkmcnt(8)
    v_mfma_f32_32x32x16_bf16 v[32:47], v[68:71], v[236:239], v[32:47]
    ds_read_b64_tr_b16 v[64:65], v2 offset:28672
    ds_read_b64_tr_b16 v[66:67], v2 offset:29184
    v_add_f32 v96, v96, v98
    v_add_f32 v97, v97, v99
    s_waitcnt vmcnt(3) lgkmcnt(8)
    v_mfma_f32_32x32x16_bf16 v[16:31], v[72:75], v[240:243], v[16:31]
    s_barrier
    ds_read_b64_tr_b16 v[68:69], v121 offset:28672
    ds_read_b64_tr_b16 v[70:71], v121 offset:29184
    v_mul_f32 v112, 0xbb000000, v96
    v_mul_f32 v97, 0x3b000000, v97
    s_waitcnt lgkmcnt(8)
    v_mfma_f32_32x32x16_bf16 v[32:47], v[76:79], v[240:243], v[32:47]
    ds_read_b64_tr_b16 v[72:73], v2 offset:30720
    ds_read_b64_tr_b16 v[74:75], v2 offset:31232
    v_fma_f32 v114, -v112, v112, v97
    v_max_f32 v114, 0, v114
    s_waitcnt vmcnt(2) lgkmcnt(8)
    v_mfma_f32_32x32x16_bf16 v[16:31], v[80:83], v[244:247], v[16:31]
    ds_read_b64_tr_b16 v[76:77], v121 offset:30720
    ds_read_b64_tr_b16 v[78:79], v121 offset:31232
    v_add_f32 v114, 0x3727c5ac, v114
    s_waitcnt lgkmcnt(8)
    v_mfma_f32_32x32x16_bf16 v[32:47], v[84:87], v[244:247], v[32:47]
    v_rsq_f32 v113, v114
    s_waitcnt vmcnt(1) lgkmcnt(6)
    v_mfma_f32_32x32x16_bf16 v[16:31], v[64:67], v[248:251], v[16:31]
    v_mul_f32 v115, s96, v113
    ds_read_b128 v[96:99], v116 offset:128
    s_waitcnt lgkmcnt(5)
    v_mfma_f32_32x32x16_bf16 v[32:47], v[68:71], v[248:251], v[32:47]
    ds_read_b128 v[100:103], v116 offset:144
    ds_read_b128 v[104:107], v116 offset:160
    s_waitcnt vmcnt(0) lgkmcnt(5)
    v_mfma_f32_32x32x16_bf16 v[16:31], v[72:75], v[252:255], v[16:31]
    ds_read_b128 v[108:111], v116 offset:176
    s_waitcnt lgkmcnt(4)
    v_mfma_f32_32x32x16_bf16 v[32:47], v[76:79], v[252:255], v[32:47]
    s_nop 8
    v_pk_fma_f32 v[16:17], v[48:49], v[112:113], v[16:17] op_sel:[0,0,0] op_sel_hi:[1,0,1]
    v_pk_fma_f32 v[18:19], v[50:51], v[112:113], v[18:19] op_sel:[0,0,0] op_sel_hi:[1,0,1]
    v_pk_fma_f32 v[20:21], v[52:53], v[112:113], v[20:21] op_sel:[0,0,0] op_sel_hi:[1,0,1]
    v_pk_fma_f32 v[22:23], v[54:55], v[112:113], v[22:23] op_sel:[0,0,0] op_sel_hi:[1,0,1]
    v_pk_fma_f32 v[24:25], v[56:57], v[112:113], v[24:25] op_sel:[0,0,0] op_sel_hi:[1,0,1]
    v_pk_fma_f32 v[26:27], v[58:59], v[112:113], v[26:27] op_sel:[0,0,0] op_sel_hi:[1,0,1]
    v_pk_fma_f32 v[28:29], v[60:61], v[112:113], v[28:29] op_sel:[0,0,0] op_sel_hi:[1,0,1]
    v_pk_fma_f32 v[30:31], v[62:63], v[112:113], v[30:31] op_sel:[0,0,0] op_sel_hi:[1,0,1]
    v_cvt_pk_bf16_f32 v64, v16, v17
    v_cvt_pk_bf16_f32 v65, v18, v19
    v_cvt_pk_bf16_f32 v66, v20, v21
    v_cvt_pk_bf16_f32 v67, v22, v23
    v_cvt_pk_bf16_f32 v68, v24, v25
    v_cvt_pk_bf16_f32 v69, v26, v27
    v_cvt_pk_bf16_f32 v70, v28, v29
    v_cvt_pk_bf16_f32 v71, v30, v31
    v_mfma_f32_32x32x16_bf16 v[16:31], v[88:91], v[64:67], 0
    s_nop 0
    v_mfma_f32_32x32x16_bf16 v[16:31], v[92:95], v[68:71], v[16:31]
    s_waitcnt lgkmcnt(3)
    v_fma_f32 v32, v96, v112, v32
    v_fma_f32 v33, v97, v112, v33
    v_fma_f32 v34, v98, v112, v34
    v_fma_f32 v35, v99, v112, v35
    s_waitcnt lgkmcnt(2)
    v_fma_f32 v36, v100, v112, v36
    v_fma_f32 v37, v101, v112, v37
    v_fma_f32 v38, v102, v112, v38
    v_fma_f32 v39, v103, v112, v39
    s_waitcnt lgkmcnt(1)
    v_fma_f32 v40, v104, v112, v40
    v_fma_f32 v41, v105, v112, v41
    v_fma_f32 v42, v106, v112, v42
    v_fma_f32 v43, v107, v112, v43
    s_waitcnt lgkmcnt(0)
    v_fma_f32 v44, v108, v112, v44
    v_fma_f32 v45, v109, v112, v45
    v_fma_f32 v46, v110, v112, v46
    v_fma_f32 v47, v111, v112, v47
    v_pk_mul_f32 v[32:33], v[112:113], v[32:33] op_sel:[1,0] op_sel_hi:[1,1]
    v_pk_mul_f32 v[34:35], v[112:113], v[34:35] op_sel:[1,0] op_sel_hi:[1,1]
    v_pk_mul_f32 v[36:37], v[112:113], v[36:37] op_sel:[1,0] op_sel_hi:[1,1]
    v_pk_mul_f32 v[38:39], v[112:113], v[38:39] op_sel:[1,0] op_sel_hi:[1,1]
    v_pk_mul_f32 v[40:41], v[112:113], v[40:41] op_sel:[1,0] op_sel_hi:[1,1]
    v_pk_mul_f32 v[42:43], v[112:113], v[42:43] op_sel:[1,0] op_sel_hi:[1,1]
    v_pk_mul_f32 v[44:45], v[112:113], v[44:45] op_sel:[1,0] op_sel_hi:[1,1]
    v_pk_mul_f32 v[46:47], v[112:113], v[46:47] op_sel:[1,0] op_sel_hi:[1,1]
    v_cvt_pk_bf16_f32 v32, v32, v33
    v_cvt_pk_bf16_f32 v33, v34, v35
    v_cvt_pk_bf16_f32 v34, v36, v37
    v_cvt_pk_bf16_f32 v35, v38, v39
    v_cvt_pk_bf16_f32 v36, v40, v41
    v_cvt_pk_bf16_f32 v37, v42, v43
    v_cvt_pk_bf16_f32 v38, v44, v45
    v_cvt_pk_bf16_f32 v39, v46, v47
    ds_write_b128 v118, v[32:35]
    ds_write_b128 v118, v[36:39] offset:16
    v_max3_f32 v64, v16, v17, v18
    v_min3_f32 v65, v16, v17, v18
    v_max3_f32 v64, v64, v19, v20
    v_min3_f32 v65, v65, v19, v20
    v_max3_f32 v64, v64, v21, v22
    v_min3_f32 v65, v65, v21, v22
    v_max3_f32 v64, v64, v23, v24
    v_min3_f32 v65, v65, v23, v24
    v_max3_f32 v64, v64, v25, v26
    v_min3_f32 v65, v65, v25, v26
    v_max3_f32 v64, v64, v27, v28
    v_min3_f32 v65, v65, v27, v28
    v_max3_f32 v64, v64, v29, v30
    v_min3_f32 v65, v65, v29, v30
    v_max_f32 v64, v64, v31
    v_min_f32 v65, v65, v31
    v_pk_mul_f32 v[64:65], v[114:115], v[64:65] op_sel:[1,0] op_sel_hi:[1,1]
    v_pk_fma_f32 v[96:97], v[16:17], v[114:115], v[64:65] op_sel:[0,1,0] op_sel_hi:[1,1,0] neg_lo:[0,0,1] neg_hi:[0,0,1]
    v_pk_fma_f32 v[48:49], v[16:17], v[114:115], v[64:65] op_sel:[0,1,1] op_sel_hi:[1,1,1] neg_lo:[1,0,0] neg_hi:[1,0,0]
    v_pk_fma_f32 v[98:99], v[18:19], v[114:115], v[64:65] op_sel:[0,1,0] op_sel_hi:[1,1,0] neg_lo:[0,0,1] neg_hi:[0,0,1]
    v_pk_fma_f32 v[50:51], v[18:19], v[114:115], v[64:65] op_sel:[0,1,1] op_sel_hi:[1,1,1] neg_lo:[1,0,0] neg_hi:[1,0,0]
    v_pk_fma_f32 v[100:101], v[20:21], v[114:115], v[64:65] op_sel:[0,1,0] op_sel_hi:[1,1,0] neg_lo:[0,0,1] neg_hi:[0,0,1]
    v_pk_fma_f32 v[52:53], v[20:21], v[114:115], v[64:65] op_sel:[0,1,1] op_sel_hi:[1,1,1] neg_lo:[1,0,0] neg_hi:[1,0,0]
    v_pk_fma_f32 v[102:103], v[22:23], v[114:115], v[64:65] op_sel:[0,1,0] op_sel_hi:[1,1,0] neg_lo:[0,0,1] neg_hi:[0,0,1]
    v_pk_fma_f32 v[54:55], v[22:23], v[114:115], v[64:65] op_sel:[0,1,1] op_sel_hi:[1,1,1] neg_lo:[1,0,0] neg_hi:[1,0,0]
    v_pk_fma_f32 v[104:105], v[24:25], v[114:115], v[64:65] op_sel:[0,1,0] op_sel_hi:[1,1,0] neg_lo:[0,0,1] neg_hi:[0,0,1]
    v_pk_fma_f32 v[56:57], v[24:25], v[114:115], v[64:65] op_sel:[0,1,1] op_sel_hi:[1,1,1] neg_lo:[1,0,0] neg_hi:[1,0,0]
    v_pk_fma_f32 v[106:107], v[26:27], v[114:115], v[64:65] op_sel:[0,1,0] op_sel_hi:[1,1,0] neg_lo:[0,0,1] neg_hi:[0,0,1]
    v_pk_fma_f32 v[58:59], v[26:27], v[114:115], v[64:65] op_sel:[0,1,1] op_sel_hi:[1,1,1] neg_lo:[1,0,0] neg_hi:[1,0,0]
    v_pk_fma_f32 v[108:109], v[28:29], v[114:115], v[64:65] op_sel:[0,1,0] op_sel_hi:[1,1,0] neg_lo:[0,0,1] neg_hi:[0,0,1]
    v_pk_fma_f32 v[60:61], v[28:29], v[114:115], v[64:65] op_sel:[0,1,1] op_sel_hi:[1,1,1] neg_lo:[1,0,0] neg_hi:[1,0,0]
    v_pk_fma_f32 v[110:111], v[30:31], v[114:115], v[64:65] op_sel:[0,1,0] op_sel_hi:[1,1,0] neg_lo:[0,0,1] neg_hi:[0,0,1]
    v_pk_fma_f32 v[62:63], v[30:31], v[114:115], v[64:65] op_sel:[0,1,1] op_sel_hi:[1,1,1] neg_lo:[1,0,0] neg_hi:[1,0,0]
    v_exp_f32 v96, v96
    v_exp_f32 v48, v48
    v_exp_f32 v97, v97
    v_exp_f32 v49, v49
    v_exp_f32 v98, v98
    v_exp_f32 v50, v50
    v_exp_f32 v99, v99
    v_exp_f32 v51, v51
    v_exp_f32 v100, v100
    v_exp_f32 v52, v52
    v_exp_f32 v101, v101
    v_exp_f32 v53, v53
    v_exp_f32 v102, v102
    v_exp_f32 v54, v54
    v_exp_f32 v103, v103
    v_exp_f32 v55, v55
    v_exp_f32 v104, v104
    v_exp_f32 v56, v56
    v_exp_f32 v105, v105
    v_exp_f32 v57, v57
    v_exp_f32 v106, v106
    v_exp_f32 v58, v58
    v_exp_f32 v107, v107
    v_exp_f32 v59, v59
    v_exp_f32 v108, v108
    v_exp_f32 v60, v60
    v_exp_f32 v109, v109
    v_exp_f32 v61, v61
    v_exp_f32 v110, v110
    v_exp_f32 v62, v62
    v_exp_f32 v111, v111
    v_exp_f32 v63, v63
    v_pk_add_f32 v[66:67], v[96:97], v[98:99] op_sel:[0,0] op_sel_hi:[1,1]
    v_pk_add_f32 v[68:69], v[48:49], v[50:51] op_sel:[0,0] op_sel_hi:[1,1]
    v_pk_add_f32 v[66:67], v[66:67], v[100:101] op_sel:[0,0] op_sel_hi:[1,1]
    v_pk_add_f32 v[68:69], v[68:69], v[52:53] op_sel:[0,0] op_sel_hi:[1,1]
    v_pk_add_f32 v[66:67], v[66:67], v[102:103] op_sel:[0,0] op_sel_hi:[1,1]
    v_pk_add_f32 v[68:69], v[68:69], v[54:55] op_sel:[0,0] op_sel_hi:[1,1]
    v_pk_add_f32 v[66:67], v[66:67], v[104:105] op_sel:[0,0] op_sel_hi:[1,1]
    v_pk_add_f32 v[68:69], v[68:69], v[56:57] op_sel:[0,0] op_sel_hi:[1,1]
    v_pk_add_f32 v[66:67], v[66:67], v[106:107] op_sel:[0,0] op_sel_hi:[1,1]
    v_pk_add_f32 v[68:69], v[68:69], v[58:59] op_sel:[0,0] op_sel_hi:[1,1]
    v_pk_add_f32 v[66:67], v[66:67], v[108:109] op_sel:[0,0] op_sel_hi:[1,1]
    v_pk_add_f32 v[68:69], v[68:69], v[60:61] op_sel:[0,0] op_sel_hi:[1,1]
    v_pk_add_f32 v[66:67], v[66:67], v[110:111] op_sel:[0,0] op_sel_hi:[1,1]
    v_pk_add_f32 v[68:69], v[68:69], v[62:63] op_sel:[0,0] op_sel_hi:[1,1]
    v_add_f32 v66, v66, v67
    v_add_f32 v68, v68, v69
    v_rcp_f32 v66, v66
    v_rcp_f32 v68, v68
    v_pk_mul_f32 v[96:97], v[66:67], v[96:97] op_sel:[0,0] op_sel_hi:[0,1]
    v_pk_mul_f32 v[48:49], v[68:69], v[48:49] op_sel:[0,0] op_sel_hi:[0,1]
    v_pk_mul_f32 v[98:99], v[66:67], v[98:99] op_sel:[0,0] op_sel_hi:[0,1]
    v_pk_mul_f32 v[50:51], v[68:69], v[50:51] op_sel:[0,0] op_sel_hi:[0,1]
    v_pk_mul_f32 v[100:101], v[66:67], v[100:101] op_sel:[0,0] op_sel_hi:[0,1]
    v_pk_mul_f32 v[52:53], v[68:69], v[52:53] op_sel:[0,0] op_sel_hi:[0,1]
    v_pk_mul_f32 v[102:103], v[66:67], v[102:103] op_sel:[0,0] op_sel_hi:[0,1]
    v_pk_mul_f32 v[54:55], v[68:69], v[54:55] op_sel:[0,0] op_sel_hi:[0,1]
    v_pk_mul_f32 v[104:105], v[66:67], v[104:105] op_sel:[0,0] op_sel_hi:[0,1]
    v_pk_mul_f32 v[56:57], v[68:69], v[56:57] op_sel:[0,0] op_sel_hi:[0,1]
    v_pk_mul_f32 v[106:107], v[66:67], v[106:107] op_sel:[0,0] op_sel_hi:[0,1]
    v_pk_mul_f32 v[58:59], v[68:69], v[58:59] op_sel:[0,0] op_sel_hi:[0,1]
    v_pk_mul_f32 v[108:109], v[66:67], v[108:109] op_sel:[0,0] op_sel_hi:[0,1]
    v_pk_mul_f32 v[60:61], v[68:69], v[60:61] op_sel:[0,0] op_sel_hi:[0,1]
    v_pk_mul_f32 v[110:111], v[66:67], v[110:111] op_sel:[0,0] op_sel_hi:[0,1]
    v_pk_mul_f32 v[62:63], v[68:69], v[62:63] op_sel:[0,0] op_sel_hi:[0,1]
    v_cvt_pk_bf16_f32 v96, v96, v97
    v_cvt_pk_bf16_f32 v48, v48, v49
    v_cvt_pk_bf16_f32 v97, v98, v99
    v_cvt_pk_bf16_f32 v49, v50, v51
    v_cvt_pk_bf16_f32 v98, v100, v101
    v_cvt_pk_bf16_f32 v50, v52, v53
    v_cvt_pk_bf16_f32 v99, v102, v103
    v_cvt_pk_bf16_f32 v51, v54, v55
    v_cvt_pk_bf16_f32 v100, v104, v105
    v_cvt_pk_bf16_f32 v52, v56, v57
    v_cvt_pk_bf16_f32 v101, v106, v107
    v_cvt_pk_bf16_f32 v53, v58, v59
    v_cvt_pk_bf16_f32 v102, v108, v109
    v_cvt_pk_bf16_f32 v54, v60, v61
    v_cvt_pk_bf16_f32 v103, v110, v111
    v_cvt_pk_bf16_f32 v55, v62, v63
    ds_write_b128 v117, v[96:99]
    ds_write_b128 v117, v[100:103] offset:16
    ds_write_b128 v117, v[48:51] offset:32
    ds_write_b128 v117, v[52:55] offset:48
    s_lshl_b32 s95, s3, 2
    s_add_u32 s95, s95, 163200
    v_mov_b32 v124, s95
    v_add_u32 v125, 1, s73
    ds_write_b32 v124, v125
    v_and_b32 v124, 12, v3
    v_add_u32 v124, 163200, v124
    ds_read_b32 v126, v124
    v_lshrrev_b32 v13, 4, v0
    v_lshlrev_b32 v13, 3, v13
    v_bfe_u32 v14, v0, 2, 2
    v_add_u32 v13, v13, v14
    v_and_b32 v14, 3, v0
    v_lshlrev_b32 v14, 3, v14
    s_lshl_b32 s92, s70, 5
    s_add_u32 s92, s92, 131072
    v_mul_u32_u24 v119, 144, v13
    v_add3_u32 v119, v119, v14, s92
    s_lshl_b32 s92, s46, 5
    s_add_u32 s92, s92, 149504
    v_mul_u32_u24 v120, 80, v13
    v_add3_u32 v120, v120, v14, s92
    s_add_u32 s44, s44, 32768
    s_and_b32 s44, s44, 131071
    v_add_u32 v2, s44, v122
    v_xor_b32 v121, 64, v2
    s_waitcnt lgkmcnt(0)
    v_cmp_ne_u32 vcc, v125, v126
    s_cbranch_vccz .Lsigd_85
.Lsig_84:
    ds_read_b32 v126, v124
    s_waitcnt lgkmcnt(0)
    v_cmp_ne_u32 vcc, v125, v126
    s_cbranch_vccz .Lsigd_85
    s_sub_u32 s72, s72, 1
    s_cbranch_scc0 .Lsig_84
    s_mov_b32 s72, 0
.Lsigd_85:
    v_and_b32 v124, 12, v3
    v_add_u32 v124, 163216, v124
    ds_read_b32 v126, v124
    ds_read_b64_tr_b16 v[16:17], v119 offset:0
    ds_read_b64_tr_b16 v[32:33], v120 offset:0
    ds_read_b64_tr_b16 v[18:19], v119 offset:576
    ds_read_b64_tr_b16 v[34:35], v120 offset:320
    ds_read_b64_tr_b16 v[20:21], v119 offset:4608
    ds_read_b64_tr_b16 v[36:37], v120 offset:2560
    ds_read_b64_tr_b16 v[22:23], v119 offset:5184
    ds_read_b64_tr_b16 v[38:39], v120 offset:2880
    ds_read_b64_tr_b16 v[24:25], v119 offset:9216
    ds_read_b64_tr_b16 v[40:41], v120 offset:5120
    ds_read_b64_tr_b16 v[26:27], v119 offset:9792
    ds_read_b64_tr_b16 v[42:43], v120 offset:5440
    ds_read_b64_tr_b16 v[28:29], v119 offset:13824
    ds_read_b64_tr_b16 v[44:45], v120 offset:7680
    ds_read_b64_tr_b16 v[30:31], v119 offset:14400
    ds_read_b64_tr_b16 v[46:47], v120 offset:8000
    v_mov_b32 v96, s97
    v_mov_b32 v97, s97
    v_mov_b32 v98, s97
    v_mov_b32 v99, s97
    s_waitcnt lgkmcnt(13)
    s_nop 0
    v_mfma_f32_16x16x32_bf16 v[104:107], v[96:99], v[16:19], 0
    s_waitcnt lgkmcnt(12)
    v_mfma_f32_16x16x32_bf16 v[100:103], v[16:19], v[32:35], 0
    s_waitcnt lgkmcnt(9)
    v_mfma_f32_16x16x32_bf16 v[104:107], v[96:99], v[20:23], v[104:107]
    s_waitcnt lgkmcnt(8)
    v_mfma_f32_16x16x32_bf16 v[100:103], v[20:23], v[36:39], v[100:103]
    s_waitcnt lgkmcnt(5)
    v_mfma_f32_16x16x32_bf16 v[104:107], v[96:99], v[24:27], v[104:107]
    s_waitcnt lgkmcnt(4)
    v_mfma_f32_16x16x32_bf16 v[100:103], v[24:27], v[40:43], v[100:103]
    s_waitcnt lgkmcnt(1)
    v_mfma_f32_16x16x32_bf16 v[104:107], v[96:99], v[28:31], v[104:107]
    s_waitcnt lgkmcnt(0)
    v_mfma_f32_16x16x32_bf16 v[100:103], v[28:31], v[44:47], v[100:103]
    v_and_b32 v111, 3221209087, v12
    s_nop 4
    v_and_b32 v105, 4294901760, v104
    v_sub_f32 v104, v104, v105
    v_cvt_pk_bf16_f32 v110, v105, v104
    v_cvt_pk_bf16_f32 v106, v100, v101
    v_cvt_pk_bf16_f32 v107, v102, v103
    v_cvt_pk_bf16_f32 v108, v100, v101
    v_cvt_pk_bf16_f32 v109, v102, v103
    v_permlane16_swap_b32 v106, v107
    s_nop 1
    v_permlane32_swap_b32 v107, v110
    s_mov_b32 exec_hi, 65535
    buffer_store_dwordx4 v[108:111], v1, s[4:7], s88 offen sc1
    s_mov_b32 exec_hi, -1
    s_waitcnt lgkmcnt(0)
    v_cmp_ne_u32 vcc, v125, v126
    s_cbranch_vccz .Lsigd_87
.Lsig_86:
    ds_read_b32 v126, v124
    s_waitcnt lgkmcnt(0)
    v_cmp_ne_u32 vcc, v125, v126
    s_cbranch_vccz .Lsigd_87
    s_sub_u32 s72, s72, 1
    s_cbranch_scc0 .Lsig_86
    s_mov_b32 s72, 0
.Lsigd_87:
    ds_read_b64_tr_b16 v[64:65], v2 offset:0
    ds_read_b64_tr_b16 v[66:67], v2 offset:512
    ds_read_b64_tr_b16 v[68:69], v121 offset:0
    ds_read_b64_tr_b16 v[70:71], v121 offset:512
    ds_read_b64_tr_b16 v[72:73], v2 offset:2048
    ds_read_b64_tr_b16 v[74:75], v2 offset:2560
    ds_read_b64_tr_b16 v[76:77], v121 offset:2048
    ds_read_b64_tr_b16 v[78:79], v121 offset:2560
    ds_read_b64_tr_b16 v[80:81], v2 offset:4096
    ds_read_b64_tr_b16 v[82:83], v2 offset:4608
    s_waitcnt lgkmcnt(8)
    v_mfma_f32_32x32x16_bf16 v[48:63], v[64:67], v[128:131], 0
    ds_read_b64_tr_b16 v[84:85], v121 offset:4096
    ds_read_b64_tr_b16 v[86:87], v121 offset:4608
    s_waitcnt lgkmcnt(8)
    v_mfma_f32_32x32x16_bf16 v[48:63], v[68:71], v[192:195], v[48:63]
    ds_read_b64_tr_b16 v[64:65], v2 offset:6144
    ds_read_b64_tr_b16 v[66:67], v2 offset:6656
    s_waitcnt lgkmcnt(8)
    v_mfma_f32_32x32x16_bf16 v[48:63], v[72:75], v[132:135], v[48:63]
    ds_read_b64_tr_b16 v[68:69], v121 offset:6144
    ds_read_b64_tr_b16 v[70:71], v121 offset:6656
    s_waitcnt lgkmcnt(8)
    v_mfma_f32_32x32x16_bf16 v[48:63], v[76:79], v[196:199], v[48:63]
    ds_read_b64_tr_b16 v[72:73], v2 offset:8192
    ds_read_b64_tr_b16 v[74:75], v2 offset:8704
    s_waitcnt lgkmcnt(8)
    v_mfma_f32_32x32x16_bf16 v[48:63], v[80:83], v[136:139], v[48:63]
    ds_read_b64_tr_b16 v[76:77], v121 offset:8192
    ds_read_b64_tr_b16 v[78:79], v121 offset:8704
    ds_read_b128 v[16:19], v116 offset:256
    ds_read_b128 v[20:23], v116 offset:272
    ds_read_b128 v[24:27], v116 offset:288
    s_waitcnt lgkmcnt(11)
    v_mfma_f32_32x32x16_bf16 v[48:63], v[84:87], v[200:203], v[48:63]
    ds_read_b64_tr_b16 v[80:81], v2 offset:10240
    ds_read_b64_tr_b16 v[82:83], v2 offset:10752
    ds_read_b128 v[28:31], v116 offset:304
    v_and_b32 v119, 15, v0
    v_mul_u32_u24 v119, 768, v119
    s_waitcnt lgkmcnt(12)
    v_mfma_f32_32x32x16_bf16 v[48:63], v[64:67], v[140:143], v[48:63]
    ds_read_b64_tr_b16 v[84:85], v121 offset:10240
    ds_read_b64_tr_b16 v[86:87], v121 offset:10752
    v_subrev_u32 v14, 256, v1
    v_cmp_gt_u32 vcc, 48, v0
    s_nop 1
    v_cndmask_b32 v118, v14, v1, vcc
    s_waitcnt lgkmcnt(12)
    v_mfma_f32_32x32x16_bf16 v[48:63], v[68:71], v[204:207], v[48:63]
    ds_read_b64_tr_b16 v[64:65], v2 offset:12288
    ds_read_b64_tr_b16 v[66:67], v2 offset:12800
    s_waitcnt lgkmcnt(12)
    v_mfma_f32_32x32x16_bf16 v[48:63], v[72:75], v[144:147], v[48:63]
    ds_read_b64_tr_b16 v[68:69], v121 offset:12288
    ds_read_b64_tr_b16 v[70:71], v121 offset:12800
    s_waitcnt lgkmcnt(12)
    v_mfma_f32_32x32x16_bf16 v[48:63], v[76:79], v[208:211], v[48:63]
    ds_read_b64_tr_b16 v[72:73], v2 offset:14336
    ds_read_b64_tr_b16 v[74:75], v2 offset:14848
    s_waitcnt lgkmcnt(9)
    v_mfma_f32_32x32x16_bf16 v[48:63], v[80:83], v[148:151], v[48:63]
    ds_read_b64_tr_b16 v[76:77], v121 offset:14336
    ds_read_b64_tr_b16 v[78:79], v121 offset:14848
    v_and_b32 v14, 1, v0
    v_lshlrev_b32 v14, 4, v14
    v_mov_b32 v15, 16256
    s_waitcnt lgkmcnt(8)
    v_mfma_f32_32x32x16_bf16 v[48:63], v[84:87], v[212:215], v[48:63]
    ds_read_b64_tr_b16 v[80:81], v2 offset:16384
    ds_read_b64_tr_b16 v[82:83], v2 offset:16896
    v_lshlrev_b32 v14, v14, v15
    v_bfe_u32 v13, v0, 2, 2
    v_bfe_u32 v15, v0, 1, 1
    s_waitcnt lgkmcnt(8)
    v_mfma_f32_32x32x16_bf16 v[48:63], v[64:67], v[152:155], v[48:63]
    ds_read_b64_tr_b16 v[84:85], v121 offset:16384
    ds_read_b64_tr_b16 v[86:87], v121 offset:16896
    v_cmp_eq_u32 vcc, 3, v13
    s_nop 1
    v_cndmask_b32 v13, v13, v15, vcc
    v_cndmask_b32 v15, v15, 2, vcc
    s_waitcnt lgkmcnt(8)
    v_mfma_f32_32x32x16_bf16 v[48:63], v[68:71], v[216:219], v[48:63]
    ds_read_b64_tr_b16 v[64:65], v2 offset:18432
    ds_read_b64_tr_b16 v[66:67], v2 offset:18944
    v_lshrrev_b32 v202, 4, v0
    v_cmp_eq_u32 vcc, v13, v202
    s_nop 1
    v_cndmask_b32 v14, 0, v14, vcc
    s_waitcnt lgkmcnt(8)
    v_mfma_f32_32x32x16_bf16 v[48:63], v[72:75], v[156:159], v[48:63]
    ds_read_b64_tr_b16 v[68:69], v121 offset:18432
    ds_read_b64_tr_b16 v[70:71], v121 offset:18944
    v_cmp_eq_u32 vcc, 0, v15
    s_nop 1
    v_cndmask_b32 v192, 0, v14, vcc
    v_cmp_eq_u32 vcc, 1, v15
    s_waitcnt lgkmcnt(8)
    v_mfma_f32_32x32x16_bf16 v[48:63], v[76:79], v[220:223], v[48:63]
    ds_read_b64_tr_b16 v[72:73], v2 offset:20480
    ds_read_b64_tr_b16 v[74:75], v2 offset:20992
    v_cndmask_b32 v193, 0, v14, vcc
    v_cmp_eq_u32 vcc, 2, v15
    s_nop 1
    v_cndmask_b32 v194, 0, v14, vcc
    s_waitcnt lgkmcnt(8)
    v_mfma_f32_32x32x16_bf16 v[48:63], v[80:83], v[160:163], v[48:63]
    ds_read_b64_tr_b16 v[76:77], v121 offset:20480
    ds_read_b64_tr_b16 v[78:79], v121 offset:20992
    v_mov_b32 v195, 0
    s_mul_i32 s92, s45, 1152
    s_add_u32 s92, s92, 159744
    s_waitcnt lgkmcnt(8)
    v_mfma_f32_32x32x16_bf16 v[48:63], v[84:87], v[224:227], v[48:63]
    ds_read_b64_tr_b16 v[80:81], v2 offset:22528
    ds_read_b64_tr_b16 v[82:83], v2 offset:23040
    s_lshl_b32 s93, s46, 6
    s_add_u32 s93, s93, s92
    v_lshrrev_b32 v14, 5, v0
    s_waitcnt lgkmcnt(8)
    v_mfma_f32_32x32x16_bf16 v[48:63], v[64:67], v[164:167], v[48:63]
    ds_read_b64_tr_b16 v[84:85], v121 offset:22528
    ds_read_b64_tr_b16 v[86:87], v121 offset:23040
    v_mul_u32_u24 v117, 576, v14
    v_bfe_u32 v13, v0, 2, 2
    v_lshl_add_u32 v117, v13, 7, v117
    s_waitcnt lgkmcnt(8)
    v_mfma_f32_32x32x16_bf16 v[48:63], v[68:71], v[228:231], v[48:63]
    ds_read_b64_tr_b16 v[64:65], v2 offset:24576
    ds_read_b64_tr_b16 v[66:67], v2 offset:25088
    v_and_b32 v13, 3, v0
    v_lshl_add_u32 v117, v13, 4, v117
    v_bfe_u32 v13, v0, 4, 1
    s_waitcnt lgkmcnt(8)
    v_mfma_f32_32x32x16_bf16 v[48:63], v[72:75], v[168:171], v[48:63]
    ds_read_b64_tr_b16 v[68:69], v121 offset:24576
    ds_read_b64_tr_b16 v[70:71], v121 offset:25088
    v_lshl_add_u32 v117, v13, 3, v117
    v_add_u32 v117, s93, v117
    s_lshl_b32 s93, s46, 4
    s_waitcnt lgkmcnt(8)
    v_mfma_f32_32x32x16_bf16 v[48:63], v[76:79], v[232:235], v[48:63]
    ds_read_b64_tr_b16 v[72:73], v2 offset:26624
    ds_read_b64_tr_b16 v[74:75], v2 offset:27136
    s_add_u32 s93, s93, s92
    s_add_u32 s93, s93, 512
    v_bfe_u32 v13, v0, 3, 1
    s_waitcnt lgkmcnt(8)
    v_mfma_f32_32x32x16_bf16 v[48:63], v[80:83], v[172:175], v[48:63]
    ds_read_b64_tr_b16 v[76:77], v121 offset:26624
    ds_read_b64_tr_b16 v[78:79], v121 offset:27136
    v_mul_u32_u24 v203, 576, v13
    v_and_b32 v13, 7, v0
    v_lshl_add_u32 v203, v13, 1, v203
    s_waitcnt lgkmcnt(8)
    v_mfma_f32_32x32x16_bf16 v[48:63], v[84:87], v[236:239], v[48:63]
    ds_read_b64_tr_b16 v[80:81], v2 offset:28672
    ds_read_b64_tr_b16 v[82:83], v2 offset:29184
    v_add_u32 v203, s93, v203
    v_mov_b32 v15, 160304
    v_cmp_gt_u32 vcc, 32, v0
    s_waitcnt lgkmcnt(8)
    v_mfma_f32_32x32x16_bf16 v[48:63], v[64:67], v[176:179], v[48:63]
    ds_read_b64_tr_b16 v[84:85], v121 offset:28672
    ds_read_b64_tr_b16 v[86:87], v121 offset:29184
    v_cndmask_b32 v203, v203, v15, vcc
    v_and_b32 v13, 31, v0
    v_lshlrev_b32 v13, 4, v13
    s_waitcnt lgkmcnt(8)
    v_mfma_f32_32x32x16_bf16 v[48:63], v[68:71], v[240:243], v[48:63]
    ds_read_b64_tr_b16 v[64:65], v2 offset:30720
    ds_read_b64_tr_b16 v[66:67], v2 offset:31232
    v_bfe_u32 v15, v0, 2, 1
    v_cmp_eq_u32 vcc, v15, v14
    v_mov_b32 v15, 544
    s_waitcnt lgkmcnt(8)
    v_mfma_f32_32x32x16_bf16 v[48:63], v[72:75], v[180:183], v[48:63]
    ds_read_b64_tr_b16 v[68:69], v121 offset:30720
    ds_read_b64_tr_b16 v[70:71], v121 offset:31232
    v_cndmask_b32 v13, v15, v13, vcc
    v_add_u32 v120, 159744, v13
    s_waitcnt lgkmcnt(8)
    v_mfma_f32_32x32x16_bf16 v[48:63], v[76:79], v[244:247], v[48:63]
    s_waitcnt lgkmcnt(6)
    v_mfma_f32_32x32x16_bf16 v[48:63], v[80:83], v[184:187], v[48:63]
    s_waitcnt lgkmcnt(4)
    v_mfma_f32_32x32x16_bf16 v[48:63], v[84:87], v[248:251], v[48:63]
    s_waitcnt lgkmcnt(2)
    v_mfma_f32_32x32x16_bf16 v[48:63], v[64:67], v[188:191], v[48:63]
    s_waitcnt lgkmcnt(0)
    v_mfma_f32_32x32x16_bf16 v[48:63], v[68:71], v[252:255], v[48:63]
    s_nop 11
    v_pk_fma_f32 v[48:49], v[16:17], v[112:113], v[48:49] op_sel:[0,0,0] op_sel_hi:[1,0,1]
    v_pk_fma_f32 v[50:51], v[18:19], v[112:113], v[50:51] op_sel:[0,0,0] op_sel_hi:[1,0,1]
    v_pk_fma_f32 v[52:53], v[20:21], v[112:113], v[52:53] op_sel:[0,0,0] op_sel_hi:[1,0,1]
    v_pk_fma_f32 v[54:55], v[22:23], v[112:113], v[54:55] op_sel:[0,0,0] op_sel_hi:[1,0,1]
    v_pk_fma_f32 v[56:57], v[24:25], v[112:113], v[56:57] op_sel:[0,0,0] op_sel_hi:[1,0,1]
    v_pk_fma_f32 v[58:59], v[26:27], v[112:113], v[58:59] op_sel:[0,0,0] op_sel_hi:[1,0,1]
    v_pk_fma_f32 v[60:61], v[28:29], v[112:113], v[60:61] op_sel:[0,0,0] op_sel_hi:[1,0,1]
    v_pk_fma_f32 v[62:63], v[30:31], v[112:113], v[62:63] op_sel:[0,0,0] op_sel_hi:[1,0,1]
    v_cvt_pk_bf16_f32 v64, v48, v49
    v_cvt_pk_bf16_f32 v65, v50, v51
    v_cvt_pk_bf16_f32 v66, v52, v53
    v_cvt_pk_bf16_f32 v67, v54, v55
    v_cvt_pk_bf16_f32 v68, v56, v57
    v_cvt_pk_bf16_f32 v69, v58, v59
    v_cvt_pk_bf16_f32 v70, v60, v61
    v_cvt_pk_bf16_f32 v71, v62, v63
    v_mfma_f32_32x32x16_bf16 v[48:63], v[88:91], v[64:67], 0
    s_nop 0
    v_mfma_f32_32x32x16_bf16 v[48:63], v[92:95], v[68:71], v[48:63]
    s_nop 11
    v_max3_f32 v64, v48, v49, v50
    v_min3_f32 v65, v48, v49, v50
    v_max3_f32 v64, v64, v51, v52
    v_min3_f32 v65, v65, v51, v52
    v_max3_f32 v64, v64, v53, v54
    v_min3_f32 v65, v65, v53, v54
    v_max3_f32 v64, v64, v55, v56
    v_min3_f32 v65, v65, v55, v56
    v_max3_f32 v64, v64, v57, v58
    v_min3_f32 v65, v65, v57, v58
    v_max3_f32 v64, v64, v59, v60
    v_min3_f32 v65, v65, v59, v60
    v_max3_f32 v64, v64, v61, v62
    v_min3_f32 v65, v65, v61, v62
    v_max_f32 v64, v64, v63
    v_min_f32 v65, v65, v63
    v_pk_mul_f32 v[64:65], v[114:115], v[64:65] op_sel:[1,0] op_sel_hi:[1,1]
    v_pk_fma_f32 v[16:17], v[48:49], v[114:115], v[64:65] op_sel:[0,1,0] op_sel_hi:[1,1,0] neg_lo:[0,0,1] neg_hi:[0,0,1]
    buffer_load_dwordx4 v[128:131], v118, s[4:7], s89 offen offset:0 sc1
    v_pk_fma_f32 v[32:33], v[48:49], v[114:115], v[64:65] op_sel:[0,1,1] op_sel_hi:[1,1,1] neg_lo:[1,0,0] neg_hi:[1,0,0]
    v_pk_fma_f32 v[18:19], v[50:51], v[114:115], v[64:65] op_sel:[0,1,0] op_sel_hi:[1,1,0] neg_lo:[0,0,1] neg_hi:[0,0,1]
    v_pk_fma_f32 v[34:35], v[50:51], v[114:115], v[64:65] op_sel:[0,1,1] op_sel_hi:[1,1,1] neg_lo:[1,0,0] neg_hi:[1,0,0]
    buffer_load_dwordx4 v[132:135], v118, s[4:7], s89 offen offset:768 sc1
    v_pk_fma_f32 v[20:21], v[52:53], v[114:115], v[64:65] op_sel:[0,1,0] op_sel_hi:[1,1,0] neg_lo:[0,0,1] neg_hi:[0,0,1]
    v_pk_fma_f32 v[36:37], v[52:53], v[114:115], v[64:65] op_sel:[0,1,1] op_sel_hi:[1,1,1] neg_lo:[1,0,0] neg_hi:[1,0,0]
    v_pk_fma_f32 v[22:23], v[54:55], v[114:115], v[64:65] op_sel:[0,1,0] op_sel_hi:[1,1,0] neg_lo:[0,0,1] neg_hi:[0,0,1]
    buffer_load_dwordx4 v[136:139], v118, s[4:7], s89 offen offset:1536 sc1
    v_pk_fma_f32 v[38:39], v[54:55], v[114:115], v[64:65] op_sel:[0,1,1] op_sel_hi:[1,1,1] neg_lo:[1,0,0] neg_hi:[1,0,0]
    v_pk_fma_f32 v[24:25], v[56:57], v[114:115], v[64:65] op_sel:[0,1,0] op_sel_hi:[1,1,0] neg_lo:[0,0,1] neg_hi:[0,0,1]
    v_pk_fma_f32 v[40:41], v[56:57], v[114:115], v[64:65] op_sel:[0,1,1] op_sel_hi:[1,1,1] neg_lo:[1,0,0] neg_hi:[1,0,0]
    buffer_load_dwordx4 v[140:143], v118, s[4:7], s89 offen offset:2304 sc1
    v_pk_fma_f32 v[26:27], v[58:59], v[114:115], v[64:65] op_sel:[0,1,0] op_sel_hi:[1,1,0] neg_lo:[0,0,1] neg_hi:[0,0,1]
    v_pk_fma_f32 v[42:43], v[58:59], v[114:115], v[64:65] op_sel:[0,1,1] op_sel_hi:[1,1,1] neg_lo:[1,0,0] neg_hi:[1,0,0]
    v_pk_fma_f32 v[28:29], v[60:61], v[114:115], v[64:65] op_sel:[0,1,0] op_sel_hi:[1,1,0] neg_lo:[0,0,1] neg_hi:[0,0,1]
    s_add_u32 s92, s89, 3072
    buffer_load_dwordx4 v[144:147], v118, s[4:7], s92 offen offset:0 sc1
    v_pk_fma_f32 v[44:45], v[60:61], v[114:115], v[64:65] op_sel:[0,1,1] op_sel_hi:[1,1,1] neg_lo:[1,0,0] neg_hi:[1,0,0]
    v_pk_fma_f32 v[30:31], v[62:63], v[114:115], v[64:65] op_sel:[0,1,0] op_sel_hi:[1,1,0] neg_lo:[0,0,1] neg_hi:[0,0,1]
    v_pk_fma_f32 v[46:47], v[62:63], v[114:115], v[64:65] op_sel:[0,1,1] op_sel_hi:[1,1,1] neg_lo:[1,0,0] neg_hi:[1,0,0]
    buffer_load_dwordx4 v[148:151], v118, s[4:7], s92 offen offset:768 sc1
    v_exp_f32 v16, v16
    v_exp_f32 v32, v32
    v_exp_f32 v17, v17
    buffer_load_dwordx4 v[152:155], v118, s[4:7], s92 offen offset:1536 sc1
    v_exp_f32 v33, v33
    v_exp_f32 v18, v18
    v_exp_f32 v34, v34
    buffer_load_dwordx4 v[156:159], v118, s[4:7], s92 offen offset:2304 sc1
    v_exp_f32 v19, v19
    v_exp_f32 v35, v35
    v_exp_f32 v20, v20
    s_add_u32 s92, s89, 6144
    buffer_load_dwordx4 v[160:163], v118, s[4:7], s92 offen offset:0 sc1
    v_exp_f32 v36, v36
    v_exp_f32 v21, v21
    v_exp_f32 v37, v37
    buffer_load_dwordx4 v[164:167], v118, s[4:7], s92 offen offset:768 sc1
    v_exp_f32 v22, v22
    v_exp_f32 v38, v38
    v_exp_f32 v23, v23
    buffer_load_dwordx4 v[168:171], v118, s[4:7], s92 offen offset:1536 sc1
    v_exp_f32 v39, v39
    v_exp_f32 v24, v24
    v_exp_f32 v40, v40
    buffer_load_dwordx4 v[172:175], v118, s[4:7], s92 offen offset:2304 sc1
    v_exp_f32 v25, v25
    v_exp_f32 v41, v41
    v_exp_f32 v26, v26
    s_add_u32 s92, s89, 9216
    buffer_load_dwordx4 v[176:179], v118, s[4:7], s92 offen offset:0 sc1
    v_exp_f32 v42, v42
    v_exp_f32 v27, v27
    v_exp_f32 v43, v43
    buffer_load_dwordx4 v[180:183], v118, s[4:7], s92 offen offset:768 sc1
    v_exp_f32 v28, v28
    v_exp_f32 v44, v44
    v_exp_f32 v29, v29
    buffer_load_dwordx4 v[184:187], v118, s[4:7], s92 offen offset:1536 sc1
    v_exp_f32 v45, v45
    v_exp_f32 v30, v30
    v_exp_f32 v46, v46
    buffer_load_dwordx4 v[188:191], v118, s[4:7], s92 offen offset:2304 sc1
    v_exp_f32 v31, v31
    v_exp_f32 v47, v47
    v_pk_add_f32 v[66:67], v[16:17], v[18:19] op_sel:[0,0] op_sel_hi:[1,1]
    v_pk_add_f32 v[68:69], v[32:33], v[34:35] op_sel:[0,0] op_sel_hi:[1,1]
    v_pk_add_f32 v[66:67], v[66:67], v[20:21] op_sel:[0,0] op_sel_hi:[1,1]
    v_pk_add_f32 v[68:69], v[68:69], v[36:37] op_sel:[0,0] op_sel_hi:[1,1]
    v_pk_add_f32 v[66:67], v[66:67], v[22:23] op_sel:[0,0] op_sel_hi:[1,1]
    v_pk_add_f32 v[68:69], v[68:69], v[38:39] op_sel:[0,0] op_sel_hi:[1,1]
    v_pk_add_f32 v[66:67], v[66:67], v[24:25] op_sel:[0,0] op_sel_hi:[1,1]
    v_pk_add_f32 v[68:69], v[68:69], v[40:41] op_sel:[0,0] op_sel_hi:[1,1]
    v_pk_add_f32 v[66:67], v[66:67], v[26:27] op_sel:[0,0] op_sel_hi:[1,1]
    v_pk_add_f32 v[68:69], v[68:69], v[42:43] op_sel:[0,0] op_sel_hi:[1,1]
    v_pk_add_f32 v[66:67], v[66:67], v[28:29] op_sel:[0,0] op_sel_hi:[1,1]
    v_pk_add_f32 v[68:69], v[68:69], v[44:45] op_sel:[0,0] op_sel_hi:[1,1]
    v_pk_add_f32 v[66:67], v[66:67], v[30:31] op_sel:[0,0] op_sel_hi:[1,1]
    v_pk_add_f32 v[68:69], v[68:69], v[46:47] op_sel:[0,0] op_sel_hi:[1,1]
    v_add_f32 v66, v66, v67
    v_add_f32 v68, v68, v69
    v_rcp_f32 v66, v66
    v_rcp_f32 v68, v68
    v_pk_mul_f32 v[16:17], v[66:67], v[16:17] op_sel:[0,0] op_sel_hi:[0,1]
    v_pk_mul_f32 v[32:33], v[68:69], v[32:33] op_sel:[0,0] op_sel_hi:[0,1]
    v_pk_mul_f32 v[18:19], v[66:67], v[18:19] op_sel:[0,0] op_sel_hi:[0,1]
    v_pk_mul_f32 v[34:35], v[68:69], v[34:35] op_sel:[0,0] op_sel_hi:[0,1]
    v_pk_mul_f32 v[20:21], v[66:67], v[20:21] op_sel:[0,0] op_sel_hi:[0,1]
    v_pk_mul_f32 v[36:37], v[68:69], v[36:37] op_sel:[0,0] op_sel_hi:[0,1]
    v_pk_mul_f32 v[22:23], v[66:67], v[22:23] op_sel:[0,0] op_sel_hi:[0,1]
    v_pk_mul_f32 v[38:39], v[68:69], v[38:39] op_sel:[0,0] op_sel_hi:[0,1]
    v_pk_mul_f32 v[24:25], v[66:67], v[24:25] op_sel:[0,0] op_sel_hi:[0,1]
    v_pk_mul_f32 v[40:41], v[68:69], v[40:41] op_sel:[0,0] op_sel_hi:[0,1]
    v_pk_mul_f32 v[26:27], v[66:67], v[26:27] op_sel:[0,0] op_sel_hi:[0,1]
    v_pk_mul_f32 v[42:43], v[68:69], v[42:43] op_sel:[0,0] op_sel_hi:[0,1]
    v_pk_mul_f32 v[28:29], v[66:67], v[28:29] op_sel:[0,0] op_sel_hi:[0,1]
    v_pk_mul_f32 v[44:45], v[68:69], v[44:45] op_sel:[0,0] op_sel_hi:[0,1]
    v_pk_mul_f32 v[30:31], v[66:67], v[30:31] op_sel:[0,0] op_sel_hi:[0,1]
    v_pk_mul_f32 v[46:47], v[68:69], v[46:47] op_sel:[0,0] op_sel_hi:[0,1]
    v_cvt_pk_bf16_f32 v16, v16, v17
    v_cvt_pk_bf16_f32 v32, v32, v33
    v_cvt_pk_bf16_f32 v17, v18, v19
    v_cvt_pk_bf16_f32 v33, v34, v35
    v_cvt_pk_bf16_f32 v18, v20, v21
    v_cvt_pk_bf16_f32 v34, v36, v37
    v_cvt_pk_bf16_f32 v19, v22, v23
    v_cvt_pk_bf16_f32 v35, v38, v39
    v_cvt_pk_bf16_f32 v20, v24, v25
    v_cvt_pk_bf16_f32 v36, v40, v41
    v_cvt_pk_bf16_f32 v21, v26, v27
    v_cvt_pk_bf16_f32 v37, v42, v43
    v_cvt_pk_bf16_f32 v22, v28, v29
    v_cvt_pk_bf16_f32 v38, v44, v45
    v_cvt_pk_bf16_f32 v23, v30, v31
    v_cvt_pk_bf16_f32 v39, v46, v47
    s_and_b32 s95, s71, 3221209087
.Lkvv_88:
    s_waitcnt vmcnt(15)
    v_dot2_f32_bf16 v201, v130, s97, 0
    v_xor_b32 v202, s95, v131
    v_mfma_f32_16x16x32_bf16 v[196:199], v[192:195], v[128:131], 0
    s_waitcnt vmcnt(14)
    v_dot2_f32_bf16 v201, v134, s97, v201
    v_xor_b32 v13, s95, v135
    v_or_b32 v202, v13, v202
    v_mfma_f32_16x16x32_bf16 v[196:199], v[192:195], v[132:135], v[196:199]
    s_waitcnt vmcnt(13)
    v_dot2_f32_bf16 v201, v138, s97, v201
    v_xor_b32 v13, s95, v139
    v_or_b32 v202, v13, v202
    v_mfma_f32_16x16x32_bf16 v[196:199], v[192:195], v[136:139], v[196:199]
    s_waitcnt vmcnt(12)
    v_dot2_f32_bf16 v201, v142, s97, v201
    v_xor_b32 v13, s95, v143
    v_or_b32 v202, v13, v202
    v_mfma_f32_16x16x32_bf16 v[196:199], v[192:195], v[140:143], v[196:199]
    s_waitcnt vmcnt(11)
    v_dot2_f32_bf16 v201, v146, s97, v201
    v_xor_b32 v13, s95, v147
    v_or_b32 v202, v13, v202
    v_mfma_f32_16x16x32_bf16 v[196:199], v[192:195], v[144:147], v[196:199]
    s_waitcnt vmcnt(10)
    v_dot2_f32_bf16 v201, v150, s97, v201
    v_xor_b32 v13, s95, v151
    v_or_b32 v202, v13, v202
    v_mfma_f32_16x16x32_bf16 v[196:199], v[192:195], v[148:151], v[196:199]
    s_waitcnt vmcnt(9)
    v_dot2_f32_bf16 v201, v154, s97, v201
    v_xor_b32 v13, s95, v155
    v_or_b32 v202, v13, v202
    v_mfma_f32_16x16x32_bf16 v[196:199], v[192:195], v[152:155], v[196:199]
    s_waitcnt vmcnt(8)
    v_dot2_f32_bf16 v201, v158, s97, v201
    v_xor_b32 v13, s95, v159
    v_or_b32 v202, v13, v202
    v_mfma_f32_16x16x32_bf16 v[196:199], v[192:195], v[156:159], v[196:199]
    s_waitcnt vmcnt(7)
    v_dot2_f32_bf16 v201, v162, s97, v201
    v_xor_b32 v13, s95, v163
    v_or_b32 v202, v13, v202
    v_mfma_f32_16x16x32_bf16 v[196:199], v[192:195], v[160:163], v[196:199]
    s_waitcnt vmcnt(6)
    v_dot2_f32_bf16 v201, v166, s97, v201
    v_xor_b32 v13, s95, v167
    v_or_b32 v202, v13, v202
    v_mfma_f32_16x16x32_bf16 v[196:199], v[192:195], v[164:167], v[196:199]
    s_waitcnt vmcnt(5)
    v_dot2_f32_bf16 v201, v170, s97, v201
    v_xor_b32 v13, s95, v171
    v_or_b32 v202, v13, v202
    v_mfma_f32_16x16x32_bf16 v[196:199], v[192:195], v[168:171], v[196:199]
    s_waitcnt vmcnt(4)
    v_dot2_f32_bf16 v201, v174, s97, v201
    v_xor_b32 v13, s95, v175
    v_or_b32 v202, v13, v202
    v_mfma_f32_16x16x32_bf16 v[196:199], v[192:195], v[172:175], v[196:199]
    s_waitcnt vmcnt(3)
    v_dot2_f32_bf16 v201, v178, s97, v201
    v_xor_b32 v13, s95, v179
    v_or_b32 v202, v13, v202
    v_mfma_f32_16x16x32_bf16 v[196:199], v[192:195], v[176:179], v[196:199]
    s_waitcnt vmcnt(2)
    v_dot2_f32_bf16 v201, v182, s97, v201
    v_xor_b32 v13, s95, v183
    v_or_b32 v202, v13, v202
    v_mfma_f32_16x16x32_bf16 v[196:199], v[192:195], v[180:183], v[196:199]
    s_waitcnt vmcnt(1)
    v_dot2_f32_bf16 v201, v186, s97, v201
    v_xor_b32 v13, s95, v187
    v_or_b32 v202, v13, v202
    v_mfma_f32_16x16x32_bf16 v[196:199], v[192:195], v[184:187], v[196:199]
    s_waitcnt vmcnt(0)
    v_dot2_f32_bf16 v201, v190, s97, v201
    v_xor_b32 v13, s95, v191
    v_or_b32 v202, v13, v202
    v_mfma_f32_16x16x32_bf16 v[196:199], v[192:195], v[188:191], v[196:199]
    v_cmp_ne_u32 vcc, 0, v202
    s_cbranch_vccnz .Lkvx_89
.Lkvd_90:
    s_add_u32 s71, s71, 1
    v_add_u32 v12, 1, v12
    v_mov_b32 v119, v120
    v_lshrrev_b32 v14, 5, v0
    v_lshlrev_b32 v14, 4, v14
    v_add_u32 v120, 160256, v14
    v_cvt_pk_bf16_f32 v201, v201, v201
    ds_write_b16 v203, v201
    v_cvt_pk_bf16_f32 v196, v196, v197
    v_cvt_pk_bf16_f32 v197, v198, v199
    ds_write_b64 v117, v[196:197]
.Lg_s:
    s_waitcnt lgkmcnt(0)
    s_barrier
    ds_read_b128 v[128:131], v119 offset:0
    ds_read_b128 v[132:135], v119 offset:576
    ds_read_b128 v[136:139], v119 offset:1152
    ds_read_b128 v[140:143], v119 offset:1728
    ds_read_b128 v[144:147], v120 offset:0
    ds_read_b128 v[148:151], v120 offset:576
    ds_read_b128 v[152:155], v120 offset:1152
    ds_read_b128 v[156:159], v120 offset:1728
    v_mov_b32 v64, 0x358637bd
    v_mov_b32 v65, 0
    v_lshrrev_b32 v14, 5, v0
    v_lshl_add_u32 v117, v14, 9, v1
    s_waitcnt lgkmcnt(7)
    v_mfma_f32_32x32x16_bf16 v[48:63], v[128:131], v[16:19], 0
    s_waitcnt lgkmcnt(3)
    v_dot2_f32_bf16 v64, v16, v144, v64
    v_dot2_f32_bf16 v65, v17, v145, v65
    v_dot2_f32_bf16 v64, v18, v146, v64
    v_dot2_f32_bf16 v65, v19, v147, v65
    v_mfma_f32_32x32x16_bf16 v[48:63], v[132:135], v[20:23], v[48:63]
    s_waitcnt lgkmcnt(2)
    v_dot2_f32_bf16 v64, v20, v148, v64
    v_dot2_f32_bf16 v65, v21, v149, v65
    v_dot2_f32_bf16 v64, v22, v150, v64
    v_dot2_f32_bf16 v65, v23, v151, v65
    v_mfma_f32_32x32x16_bf16 v[48:63], v[136:139], v[32:35], v[48:63]
    s_waitcnt lgkmcnt(1)
    v_dot2_f32_bf16 v64, v32, v152, v64
    v_dot2_f32_bf16 v65, v33, v153, v65
    v_dot2_f32_bf16 v64, v34, v154, v64
    v_dot2_f32_bf16 v65, v35, v155, v65
    v_mfma_f32_32x32x16_bf16 v[48:63], v[140:143], v[36:39], v[48:63]
    s_waitcnt lgkmcnt(0)
    v_dot2_f32_bf16 v64, v36, v156, v64
    v_dot2_f32_bf16 v65, v37, v157, v65
    v_dot2_f32_bf16 v64, v38, v158, v64
    v_dot2_f32_bf16 v65, v39, v159, v65
    s_nop 2
    v_add_f32 v64, v64, v65
    v_rcp_f32 v64, v64
    s_nop 1
    v_pk_mul_f32 v[48:49], v[64:65], v[48:49] op_sel:[0,0] op_sel_hi:[0,1]
    v_pk_mul_f32 v[50:51], v[64:65], v[50:51] op_sel:[0,0] op_sel_hi:[0,1]
    v_pk_mul_f32 v[52:53], v[64:65], v[52:53] op_sel:[0,0] op_sel_hi:[0,1]
    v_pk_mul_f32 v[54:55], v[64:65], v[54:55] op_sel:[0,0] op_sel_hi:[0,1]
    v_pk_mul_f32 v[56:57], v[64:65], v[56:57] op_sel:[0,0] op_sel_hi:[0,1]
    v_pk_mul_f32 v[58:59], v[64:65], v[58:59] op_sel:[0,0] op_sel_hi:[0,1]
    v_pk_mul_f32 v[60:61], v[64:65], v[60:61] op_sel:[0,0] op_sel_hi:[0,1]
    v_pk_mul_f32 v[62:63], v[64:65], v[62:63] op_sel:[0,0] op_sel_hi:[0,1]
    v_cvt_pk_bf16_f32 v48, v48, v49
    v_cvt_pk_bf16_f32 v49, v50, v51
    v_cvt_pk_bf16_f32 v50, v52, v53
    v_cvt_pk_bf16_f32 v51, v54, v55
    v_cvt_pk_bf16_f32 v52, v56, v57
    v_cvt_pk_bf16_f32 v53, v58, v59
    v_cvt_pk_bf16_f32 v54, v60, v61
    v_cvt_pk_bf16_f32 v55, v62, v63
    buffer_store_dwordx4 v[48:51], v117, s[4:7], s80 offen sc1
    buffer_store_dwordx4 v[52:55], v117, s[4:7], s80 offen offset:512 sc1
    s_add_u32 s44, s44, 32768
    s_and_b32 s44, s44, 131071
    v_add_u32 v2, s44, v123
    v_xor_b32 v121, 64, v2
    v_lshlrev_b32 v16, 16, v4
    v_and_b32 v17, 4294901760, v4
    v_lshlrev_b32 v18, 16, v5
    v_and_b32 v19, 4294901760, v5
    v_lshlrev_b32 v20, 16, v6
    v_and_b32 v21, 4294901760, v6
    v_lshlrev_b32 v22, 16, v7
    v_and_b32 v23, 4294901760, v7
    v_lshlrev_b32 v24, 16, v8
    v_and_b32 v25, 4294901760, v8
    v_lshlrev_b32 v26, 16, v9
    v_and_b32 v27, 4294901760, v9
    v_lshlrev_b32 v28, 16, v10
    v_and_b32 v29, 4294901760, v10
    v_lshlrev_b32 v30, 16, v11
    v_and_b32 v31, 4294901760, v11
    s_lshl_b32 s92, s70, 12
    s_add_u32 s92, s92, 131072
    v_add_u32 v126, s92, v1
    s_waitcnt vmcnt(0)
    buffer_store_dword v12, off, s[4:7], s82 offset:128 sc1
    s_add_u32 s88, s88, 786432
    s_add_u32 s89, s89, 786432
.Lpoll_123:
    buffer_load_dword v13, v3, s[4:7], s81 offen offset:128 sc1
    s_waitcnt vmcnt(0)
    v_cmp_ne_u32 vcc, s71, v13
    s_cbranch_vccz .Lpdone_124
    s_sub_u32 s72, s72, 1
    s_cbranch_scc0 .Lpoll_123
    s_mov_b32 s72, 0
.Lpdone_124:
    s_add_u32 s48, s84, 0
    buffer_load_dwordx4 v[128:131], v1, s[4:7], s48 offen offset:0 sc1
    buffer_load_dwordx4 v[132:135], v1, s[4:7], s48 offen offset:2048 sc1
    s_add_u32 s48, s84, 4096
    buffer_load_dwordx4 v[136:139], v1, s[4:7], s48 offen offset:0 sc1
    buffer_load_dwordx4 v[140:143], v1, s[4:7], s48 offen offset:2048 sc1
    s_add_u32 s48, s84, 8192
    buffer_load_dwordx4 v[144:147], v1, s[4:7], s48 offen offset:0 sc1
    buffer_load_dwordx4 v[148:151], v1, s[4:7], s48 offen offset:2048 sc1
    s_add_u32 s48, s84, 12288
    buffer_load_dwordx4 v[152:155], v1, s[4:7], s48 offen offset:0 sc1
    buffer_load_dwordx4 v[156:159], v1, s[4:7], s48 offen offset:2048 sc1
    s_add_u32 s48, s84, 16384
    buffer_load_dwordx4 v[160:163], v1, s[4:7], s48 offen offset:0 sc1
    buffer_load_dwordx4 v[164:167], v1, s[4:7], s48 offen offset:2048 sc1
    ds_read_b64_tr_b16 v[48:49], v2 offset:0
    ds_read_b64_tr_b16 v[50:51], v2 offset:512
    ds_read_b64_tr_b16 v[52:53], v121 offset:0
    ds_read_b64_tr_b16 v[54:55], v121 offset:512
    ds_read_b64_tr_b16 v[56:57], v2 offset:4096
    ds_read_b64_tr_b16 v[58:59], v2 offset:4608
    ds_read_b64_tr_b16 v[60:61], v121 offset:4096
    ds_read_b64_tr_b16 v[62:63], v121 offset:4608
    ds_read_b64_tr_b16 v[64:65], v2 offset:8192
    ds_read_b64_tr_b16 v[66:67], v2 offset:8704
    s_waitcnt vmcnt(9) lgkmcnt(8)
    v_mfma_f32_32x32x16_bf16 v[16:31], v[48:51], v[128:131], v[16:31]
    ds_read_b64_tr_b16 v[68:69], v121 offset:8192
    ds_read_b64_tr_b16 v[70:71], v121 offset:8704
    s_add_u32 s71, s71, 1
    v_add_u32 v12, 1, v12
    s_waitcnt lgkmcnt(8)
    v_mfma_f32_32x32x16_bf16 v[32:47], v[52:55], v[128:131], 0
    ds_read_b64_tr_b16 v[48:49], v2 offset:12288
    ds_read_b64_tr_b16 v[50:51], v2 offset:12800
    s_add_u32 s48, s84, 20480
    buffer_load_dwordx4 v[168:171], v1, s[4:7], s48 offen offset:0 sc1
    s_waitcnt vmcnt(9) lgkmcnt(8)
    v_mfma_f32_32x32x16_bf16 v[16:31], v[56:59], v[132:135], v[16:31]
    ds_read_b64_tr_b16 v[52:53], v121 offset:12288
    ds_read_b64_tr_b16 v[54:55], v121 offset:12800
    s_waitcnt lgkmcnt(8)
    v_mfma_f32_32x32x16_bf16 v[32:47], v[60:63], v[132:135], v[32:47]
    ds_read_b64_tr_b16 v[56:57], v2 offset:16384
    ds_read_b64_tr_b16 v[58:59], v2 offset:16896
    buffer_load_dwordx4 v[172:175], v1, s[4:7], s48 offen offset:2048 sc1
    s_waitcnt vmcnt(9) lgkmcnt(8)
    v_mfma_f32_32x32x16_bf16 v[16:31], v[64:67], v[136:139], v[16:31]
    ds_read_b64_tr_b16 v[60:61], v121 offset:16384
    ds_read_b64_tr_b16 v[62:63], v121 offset:16896
    s_waitcnt lgkmcnt(8)
    v_mfma_f32_32x32x16_bf16 v[32:47], v[68:71], v[136:139], v[32:47]
    ds_read_b64_tr_b16 v[64:65], v2 offset:20480
    ds_read_b64_tr_b16 v[66:67], v2 offset:20992
    s_add_u32 s48, s84, 24576
    buffer_load_dwordx4 v[176:179], v1, s[4:7], s48 offen offset:0 sc1
    s_waitcnt vmcnt(9) lgkmcnt(8)
    v_mfma_f32_32x32x16_bf16 v[16:31], v[48:51], v[140:143], v[16:31]
    ds_read_b64_tr_b16 v[68:69], v121 offset:20480
    ds_read_b64_tr_b16 v[70:71], v121 offset:20992
    s_waitcnt lgkmcnt(8)
    v_mfma_f32_32x32x16_bf16 v[32:47], v[52:55], v[140:143], v[32:47]
    ds_read_b64_tr_b16 v[48:49], v2 offset:24576
    ds_read_b64_tr_b16 v[50:51], v2 offset:25088
    buffer_load_dwordx4 v[180:183], v1, s[4:7], s48 offen offset:2048 sc1
    s_waitcnt vmcnt(9) lgkmcnt(8)
    v_mfma_f32_32x32x16_bf16 v[16:31], v[56:59], v[144:147], v[16:31]
    ds_read_b64_tr_b16 v[52:53], v121 offset:24576
    ds_read_b64_tr_b16 v[54:55], v121 offset:25088
    s_waitcnt lgkmcnt(8)
    v_mfma_f32_32x32x16_bf16 v[32:47], v[60:63], v[144:147], v[32:47]
    ds_read_b64_tr_b16 v[56:57], v2 offset:28672
    ds_read_b64_tr_b16 v[58:59], v2 offset:29184
    s_add_u32 s48, s84, 28672
    buffer_load_dwordx4 v[184:187], v1, s[4:7], s48 offen offset:0 sc1
    s_waitcnt vmcnt(9) lgkmcnt(8)
    v_mfma_f32_32x32x16_bf16 v[16:31], v[64:67], v[148:151], v[16:31]
    ds_read_b64_tr_b16 v[60:61], v121 offset:28672
    ds_read_b64_tr_b16 v[62:63], v121 offset:29184
    s_waitcnt lgkmcnt(8)
    v_mfma_f32_32x32x16_bf16 v[32:47], v[68:71], v[148:151], v[32:47]
    s_add_u32 s44, s44, 32768
    s_and_b32 s44, s44, 131071
    v_add_u32 v2, s44, v123
    v_xor_b32 v121, 64, v2
    ds_read_b64_tr_b16 v[64:65], v2 offset:0
    ds_read_b64_tr_b16 v[66:67], v2 offset:512
    buffer_load_dwordx4 v[188:191], v1, s[4:7], s48 offen offset:2048 sc1
    s_waitcnt vmcnt(9) lgkmcnt(8)
    v_mfma_f32_32x32x16_bf16 v[16:31], v[48:51], v[152:155], v[16:31]
    s_barrier
    ds_read_b64_tr_b16 v[68:69], v121 offset:0
    ds_read_b64_tr_b16 v[70:71], v121 offset:512
    s_waitcnt lgkmcnt(8)
    v_mfma_f32_32x32x16_bf16 v[32:47], v[52:55], v[152:155], v[32:47]
    ds_read_b64_tr_b16 v[48:49], v2 offset:4096
    ds_read_b64_tr_b16 v[50:51], v2 offset:4608
    s_waitcnt vmcnt(8) lgkmcnt(8)
    v_mfma_f32_32x32x16_bf16 v[16:31], v[56:59], v[156:159], v[16:31]
    ds_read_b64_tr_b16 v[52:53], v121 offset:4096
    ds_read_b64_tr_b16 v[54:55], v121 offset:4608
    s_waitcnt lgkmcnt(8)
    v_mfma_f32_32x32x16_bf16 v[32:47], v[60:63], v[156:159], v[32:47]
    ds_read_b64_tr_b16 v[56:57], v2 offset:8192
    ds_read_b64_tr_b16 v[58:59], v2 offset:8704
    s_waitcnt vmcnt(7) lgkmcnt(8)
    v_mfma_f32_32x32x16_bf16 v[16:31], v[64:67], v[160:163], v[16:31]
    ds_read_b64_tr_b16 v[60:61], v121 offset:8192
    ds_read_b64_tr_b16 v[62:63], v121 offset:8704
    s_waitcnt lgkmcnt(8)
    v_mfma_f32_32x32x16_bf16 v[32:47], v[68:71], v[160:163], v[32:47]
    ds_read_b64_tr_b16 v[64:65], v2 offset:12288
    ds_read_b64_tr_b16 v[66:67], v2 offset:12800
    s_waitcnt vmcnt(6) lgkmcnt(8)
    v_mfma_f32_32x32x16_bf16 v[16:31], v[48:51], v[164:167], v[16:31]
    ds_read_b64_tr_b16 v[68:69], v121 offset:12288
    ds_read_b64_tr_b16 v[70:71], v121 offset:12800
    s_waitcnt lgkmcnt(8)
    v_mfma_f32_32x32x16_bf16 v[32:47], v[52:55], v[164:167], v[32:47]
    ds_read_b64_tr_b16 v[48:49], v2 offset:16384
    ds_read_b64_tr_b16 v[50:51], v2 offset:16896
    s_waitcnt vmcnt(5) lgkmcnt(8)
    v_mfma_f32_32x32x16_bf16 v[16:31], v[56:59], v[168:171], v[16:31]
    ds_read_b64_tr_b16 v[52:53], v121 offset:16384
    ds_read_b64_tr_b16 v[54:55], v121 offset:16896
    s_waitcnt lgkmcnt(8)
    v_mfma_f32_32x32x16_bf16 v[32:47], v[60:63], v[168:171], v[32:47]
    ds_read_b64_tr_b16 v[56:57], v121 offset:20480
    ds_read_b64_tr_b16 v[58:59], v121 offset:20992
    s_waitcnt vmcnt(4) lgkmcnt(8)
    v_mfma_f32_32x32x16_bf16 v[16:31], v[64:67], v[172:175], v[16:31]
    ds_read_b64_tr_b16 v[60:61], v121 offset:24576
    ds_read_b64_tr_b16 v[62:63], v121 offset:25088
    s_waitcnt lgkmcnt(8)
    v_mfma_f32_32x32x16_bf16 v[32:47], v[68:71], v[172:175], v[32:47]
    ds_read_b64_tr_b16 v[64:65], v121 offset:28672
    ds_read_b64_tr_b16 v[66:67], v121 offset:29184
    s_waitcnt vmcnt(3) lgkmcnt(8)
    v_mfma_f32_32x32x16_bf16 v[16:31], v[48:51], v[176:179], v[16:31]
    ds_read_b64_tr_b16 v[68:69], v2 offset:20480
    ds_read_b64_tr_b16 v[70:71], v2 offset:20992
    s_waitcnt lgkmcnt(8)
    v_mfma_f32_32x32x16_bf16 v[32:47], v[52:55], v[176:179], v[32:47]
    ds_read_b64_tr_b16 v[48:49], v2 offset:24576
    ds_read_b64_tr_b16 v[50:51], v2 offset:25088
    s_waitcnt vmcnt(2) lgkmcnt(8)
    v_mfma_f32_32x32x16_bf16 v[32:47], v[56:59], v[180:183], v[32:47]
    ds_read_b64_tr_b16 v[52:53], v2 offset:28672
    ds_read_b64_tr_b16 v[54:55], v2 offset:29184
    s_waitcnt vmcnt(1) lgkmcnt(8)
    v_mfma_f32_32x32x16_bf16 v[32:47], v[60:63], v[184:187], v[32:47]
    s_waitcnt vmcnt(0) lgkmcnt(6)
    v_mfma_f32_32x32x16_bf16 v[32:47], v[64:67], v[188:191], v[32:47]
    s_waitcnt lgkmcnt(4)
    v_mfma_f32_32x32x16_bf16 v[16:31], v[68:71], v[180:183], v[16:31]
    s_nop 9
    ds_write_b128 v126, v[32:35] offset:0
    ds_write_b128 v126, v[36:39] offset:1024
    ds_write_b128 v126, v[40:43] offset:2048
    ds_write_b128 v126, v[44:47] offset:3072
    s_waitcnt lgkmcnt(6)
    v_mfma_f32_32x32x16_bf16 v[16:31], v[48:51], v[184:187], v[16:31]
    s_waitcnt lgkmcnt(4)
    v_mfma_f32_32x32x16_bf16 v[16:31], v[52:55], v[188:191], v[16:31]
    v_xor_b32 v126, 4096, v126
    s_waitcnt lgkmcnt(0)
    s_barrier
    ds_read_b128 v[48:51], v126 offset:0
    ds_read_b128 v[52:55], v126 offset:1024
    ds_read_b128 v[56:59], v126 offset:2048
    ds_read_b128 v[60:63], v126 offset:3072
    v_and_b32 v126, 31, v0
    v_lshlrev_b32 v126, 4, v126
    v_lshrrev_b32 v13, 5, v0
    v_lshl_add_u32 v126, v13, 2, v126
    s_waitcnt lgkmcnt(3)
    v_pk_add_f32 v[16:17], v[16:17], v[48:49] op_sel:[0,0] op_sel_hi:[1,1]
    v_pk_add_f32 v[18:19], v[18:19], v[50:51] op_sel:[0,0] op_sel_hi:[1,1]
    v_cvt_pk_bf16_f32 v4, v16, v17
    v_cvt_pk_bf16_f32 v5, v18, v19
    s_waitcnt lgkmcnt(2)
    v_pk_add_f32 v[20:21], v[20:21], v[52:53] op_sel:[0,0] op_sel_hi:[1,1]
    v_pk_add_f32 v[22:23], v[22:23], v[54:55] op_sel:[0,0] op_sel_hi:[1,1]
    v_cvt_pk_bf16_f32 v6, v20, v21
    v_cvt_pk_bf16_f32 v7, v22, v23
    s_waitcnt lgkmcnt(1)
    v_pk_add_f32 v[24:25], v[24:25], v[56:57] op_sel:[0,0] op_sel_hi:[1,1]
    v_pk_add_f32 v[26:27], v[26:27], v[58:59] op_sel:[0,0] op_sel_hi:[1,1]
    v_cvt_pk_bf16_f32 v8, v24, v25
    v_cvt_pk_bf16_f32 v9, v26, v27
    s_waitcnt lgkmcnt(0)
    v_pk_add_f32 v[28:29], v[28:29], v[60:61] op_sel:[0,0] op_sel_hi:[1,1]
    v_pk_add_f32 v[30:31], v[30:31], v[62:63] op_sel:[0,0] op_sel_hi:[1,1]
    v_cvt_pk_bf16_f32 v10, v28, v29
    v_cvt_pk_bf16_f32 v11, v30, v31
    buffer_store_dwordx4 v[4:7], v1, s[4:7], s77 offen offset:0 sc1
    buffer_store_dwordx4 v[8:11], v1, s[4:7], s77 offen offset:1024 sc1
    v_dot2_f32_bf16 v16, v4, s97, 0
    v_dot2_f32_bf16 v17, v4, v4, 0
    v_dot2_f32_bf16 v18, v5, s97, 0
    v_dot2_f32_bf16 v19, v5, v5, 0
    v_dot2_f32_bf16 v16, v6, s97, v16
    v_dot2_f32_bf16 v17, v6, v6, v17
    v_dot2_f32_bf16 v18, v7, s97, v18
    v_dot2_f32_bf16 v19, v7, v7, v19
    v_dot2_f32_bf16 v16, v8, s97, v16
    v_dot2_f32_bf16 v17, v8, v8, v17
    v_dot2_f32_bf16 v18, v9, s97, v18
    v_dot2_f32_bf16 v19, v9, v9, v19
    v_dot2_f32_bf16 v16, v10, s97, v16
    v_dot2_f32_bf16 v17, v10, v10, v17
    v_dot2_f32_bf16 v18, v11, s97, v18
    v_dot2_f32_bf16 v19, v11, v11, v19
    s_nop 2
    v_pk_add_f32 v[16:17], v[16:17], v[18:19] op_sel:[0,0] op_sel_hi:[1,1]
    s_nop 1
    v_permlane32_swap_b32 v16, v17
    v_add_f32 v16, v16, v17
    buffer_store_dword v16, v126, s[4:7], s78 offen sc1
    v_and_b32 v14, 31, v0
    v_lshlrev_b32 v120, 2, v14
    v_add_u32 v120, 162432, v120
    s_add_u32 s44, s44, 32768
    s_and_b32 s44, s44, 131071
    v_add_u32 v2, s44, v1
    v_lshrrev_b32 v15, 5, v0
    v_lshlrev_b32 v15, 11, v15
    v_and_b32 v14, 31, v0
    v_lshl_add_u32 v15, v14, 4, v15
    s_add_u32 s92, s44, 65536
    s_and_b32 s92, s92, 131071
    v_add_u32 v121, s92, v1
    s_lshl_b32 s92, s70, 12
    s_add_u32 s92, s92, 131072
    v_add_u32 v126, s92, v1
    s_waitcnt vmcnt(0)
    buffer_store_dword v12, off, s[4:7], s79 sc1
.Lpoll_126:
    buffer_load_dword v13, v3, s[4:7], s76 offen offset:0 sc1
    s_waitcnt vmcnt(0)
    v_cmp_ne_u32 vcc, s71, v13
    s_cbranch_vccz .Lpdone_127
    s_sub_u32 s72, s72, 1
    s_cbranch_scc0 .Lpoll_126
    s_mov_b32 s72, 0
.Lpdone_127:
    s_xor_b32 s48, s91, 0
    buffer_load_dwordx4 v[128:131], v1, s[4:7], s48 offen offset:0 sc1
    buffer_load_dwordx4 v[132:135], v1, s[4:7], s48 offen offset:1024 sc1
    buffer_load_dwordx4 v[136:139], v1, s[4:7], s48 offen offset:2048 sc1
    buffer_load_dwordx4 v[140:143], v1, s[4:7], s48 offen offset:3072 sc1
    s_xor_b32 s48, s91, 4096
    buffer_load_dwordx4 v[144:147], v1, s[4:7], s48 offen offset:0 sc1
    buffer_load_dwordx4 v[148:151], v1, s[4:7], s48 offen offset:1024 sc1
    buffer_load_dwordx4 v[152:155], v1, s[4:7], s48 offen offset:2048 sc1
    buffer_load_dwordx4 v[156:159], v1, s[4:7], s48 offen offset:3072 sc1
    s_xor_b32 s48, s91, 8192
    buffer_load_dwordx4 v[160:163], v1, s[4:7], s48 offen offset:0 sc1
    buffer_load_dwordx4 v[164:167], v1, s[4:7], s48 offen offset:1024 sc1
    s_add_u32 s71, s71, 1
    v_add_u32 v12, 1, v12
    s_barrier
    ds_read_b128 v[64:67], v2 offset:0
    ds_read_b128 v[68:71], v2 offset:16384
    ds_read_b128 v[72:75], v2 offset:1024
    ds_read_b128 v[76:79], v2 offset:17408
    ds_read_b128 v[80:83], v2 offset:2048
    s_waitcnt vmcnt(9) lgkmcnt(3)
    v_mfma_f32_32x32x16_bf16 v[16:31], v[64:67], v[128:131], 0
    ds_read_b128 v[84:87], v2 offset:18432
    v_mfma_f32_32x32x16_bf16 v[32:47], v[68:71], v[128:131], 0
    buffer_load_dwordx4 v[168:171], v1, s[4:7], s48 offen offset:2048 sc1
    ds_read_b128 v[64:67], v2 offset:3072
    s_waitcnt vmcnt(9) lgkmcnt(3)
    v_mfma_f32_32x32x16_bf16 v[16:31], v[72:75], v[132:135], v[16:31]
    ds_read_b128 v[68:71], v2 offset:19456
    v_mov_b32 v89, 0
    v_mov_b32 v90, 0
    v_mov_b32 v91, 0
    v_min_u32 v124, 20, v3
    v_mfma_f32_32x32x16_bf16 v[32:47], v[76:79], v[132:135], v[32:47]
    buffer_load_dwordx4 v[172:175], v1, s[4:7], s48 offen offset:3072 sc1
    ds_read_b128 v[72:75], v121 offset:0
    s_waitcnt vmcnt(9) lgkmcnt(3)
    v_mfma_f32_32x32x16_bf16 v[16:31], v[80:83], v[136:139], v[16:31]
    ds_read_b128 v[76:79], v2 offset:4096
    v_mfma_f32_32x32x16_bf16 v[32:47], v[84:87], v[136:139], v[32:47]
    s_xor_b32 s48, s91, 12288
    buffer_load_dwordx4 v[176:179], v1, s[4:7], s48 offen offset:0 sc1
    ds_read_b128 v[80:83], v2 offset:20480
    s_waitcnt vmcnt(9) lgkmcnt(3)
    v_mfma_f32_32x32x16_bf16 v[16:31], v[64:67], v[140:143], v[16:31]
    ds_read_b128 v[84:87], v2 offset:5120
    v_mfma_f32_32x32x16_bf16 v[32:47], v[68:71], v[140:143], v[32:47]
    buffer_load_dwordx4 v[180:183], v1, s[4:7], s48 offen offset:1024 sc1
    ds_read_b128 v[64:67], v2 offset:21504
    s_waitcnt lgkmcnt(3)
    v_mfma_f32_32x32x16_bf16 v[48:63], v[72:75], v[128:131], 0
    ds_read_b128 v[68:71], v2 offset:6144
    s_waitcnt vmcnt(9)
    v_mfma_f32_32x32x16_bf16 v[16:31], v[76:79], v[144:147], v[16:31]
    buffer_load_dwordx4 v[184:187], v1, s[4:7], s48 offen offset:2048 sc1
    ds_read_b128 v[72:75], v2 offset:22528
    s_waitcnt lgkmcnt(3)
    v_mfma_f32_32x32x16_bf16 v[32:47], v[80:83], v[144:147], v[32:47]
    ds_read_b128 v[76:79], v121 offset:1024
    s_waitcnt vmcnt(9)
    v_mfma_f32_32x32x16_bf16 v[16:31], v[84:87], v[148:151], v[16:31]
    buffer_load_dwordx4 v[188:191], v1, s[4:7], s48 offen offset:3072 sc1
    ds_read_b128 v[80:83], v2 offset:7168
    s_waitcnt lgkmcnt(3)
    v_mfma_f32_32x32x16_bf16 v[32:47], v[64:67], v[148:151], v[32:47]
    ds_read_b128 v[84:87], v2 offset:23552
    s_waitcnt vmcnt(9)
    v_mfma_f32_32x32x16_bf16 v[16:31], v[68:71], v[152:155], v[16:31]
    s_xor_b32 s48, s91, 16384
    buffer_load_dwordx4 v[192:195], v1, s[4:7], s48 offen offset:0 sc1
    ds_read_b128 v[64:67], v2 offset:8192
    s_waitcnt lgkmcnt(3)
    v_mfma_f32_32x32x16_bf16 v[32:47], v[72:75], v[152:155], v[32:47]
    ds_read_b128 v[68:71], v2 offset:24576
    v_mfma_f32_32x32x16_bf16 v[48:63], v[76:79], v[132:135], v[48:63]
    buffer_load_dwordx4 v[196:199], v1, s[4:7], s48 offen offset:1024 sc1
    ds_read_b128 v[72:75], v2 offset:9216
    s_waitcnt vmcnt(10) lgkmcnt(3)
    v_mfma_f32_32x32x16_bf16 v[16:31], v[80:83], v[156:159], v[16:31]
    ds_read_b128 v[76:79], v2 offset:25600
    v_mfma_f32_32x32x16_bf16 v[32:47], v[84:87], v[156:159], v[32:47]
    buffer_load_dwordx4 v[200:203], v1, s[4:7], s48 offen offset:2048 sc1
    ds_read_b128 v[80:83], v121 offset:2048
    s_waitcnt vmcnt(10) lgkmcnt(3)
    v_mfma_f32_32x32x16_bf16 v[16:31], v[64:67], v[160:163], v[16:31]
    ds_read_b128 v[84:87], v2 offset:10240
    v_mfma_f32_32x32x16_bf16 v[32:47], v[68:71], v[160:163], v[32:47]
    buffer_load_dwordx4 v[204:207], v1, s[4:7], s48 offen offset:3072 sc1
    ds_read_b128 v[64:67], v2 offset:26624
    s_waitcnt vmcnt(10) lgkmcnt(3)
    v_mfma_f32_32x32x16_bf16 v[16:31], v[72:75], v[164:167], v[16:31]
    ds_read_b128 v[68:71], v2 offset:11264
    v_mfma_f32_32x32x16_bf16 v[32:47], v[76:79], v[164:167], v[32:47]
    buffer_load_dwordx4 v[96:99], v15, s[4:7], s75 offen offset:0 sc1
    buffer_load_dwordx4 v[100:103], v15, s[4:7], s75 offen offset:512 sc1
    buffer_load_dwordx4 v[104:107], v15, s[4:7], s75 offen offset:1024 sc1
    buffer_load_dwordx4 v[108:111], v15, s[4:7], s75 offen offset:1536 sc1
    ds_read_b128 v[72:75], v2 offset:27648
    s_waitcnt lgkmcnt(3)
    v_mfma_f32_32x32x16_bf16 v[48:63], v[80:83], v[136:139], v[48:63]
    ds_read_b128 v[76:79], v2 offset:12288
    s_waitcnt vmcnt(13)
    v_mfma_f32_32x32x16_bf16 v[16:31], v[84:87], v[168:171], v[16:31]
    s_xor_b32 s48, s91, 20480
    buffer_load_dwordx4 v[208:211], v1, s[4:7], s48 offen offset:0 sc1
    ds_read_b128 v[80:83], v2 offset:28672
    s_waitcnt lgkmcnt(3)
    v_mfma_f32_32x32x16_bf16 v[32:47], v[64:67], v[168:171], v[32:47]
    ds_read_b128 v[84:87], v121 offset:3072
    s_waitcnt vmcnt(13)
    v_mfma_f32_32x32x16_bf16 v[16:31], v[68:71], v[172:175], v[16:31]
    buffer_load_dwordx4 v[212:215], v1, s[4:7], s48 offen offset:1024 sc1
    ds_read_b128 v[64:67], v2 offset:13312
    s_waitcnt lgkmcnt(3)
    v_mfma_f32_32x32x16_bf16 v[32:47], v[72:75], v[172:175], v[32:47]
    ds_read_b128 v[68:71], v2 offset:29696
    s_waitcnt vmcnt(13)
    v_mfma_f32_32x32x16_bf16 v[16:31], v[76:79], v[176:179], v[16:31]
    buffer_load_dwordx4 v[216:219], v1, s[4:7], s48 offen offset:2048 sc1
    ds_read_b128 v[72:75], v2 offset:14336
    s_waitcnt lgkmcnt(3)
    v_mfma_f32_32x32x16_bf16 v[32:47], v[80:83], v[176:179], v[32:47]
    ds_read_b128 v[76:79], v2 offset:30720
    v_mfma_f32_32x32x16_bf16 v[48:63], v[84:87], v[140:143], v[48:63]
    buffer_load_dwordx4 v[220:223], v1, s[4:7], s48 offen offset:3072 sc1
    ds_read_b128 v[80:83], v2 offset:15360
    s_waitcnt vmcnt(14) lgkmcnt(3)
    v_mfma_f32_32x32x16_bf16 v[16:31], v[64:67], v[180:183], v[16:31]
    ds_read_b128 v[84:87], v2 offset:31744
    v_mfma_f32_32x32x16_bf16 v[32:47], v[68:71], v[180:183], v[32:47]
    s_xor_b32 s48, s91, 24576
    buffer_load_dwordx4 v[224:227], v1, s[4:7], s48 offen offset:0 sc1
    ds_read_b128 v[64:67], v121 offset:4096
    s_waitcnt vmcnt(14) lgkmcnt(3)
    v_mfma_f32_32x32x16_bf16 v[16:31], v[72:75], v[184:187], v[16:31]
    s_add_u32 s44, s44, 32768
    s_and_b32 s44, s44, 131071
    v_add_u32 v2, s44, v1
    ds_read_b128 v[68:71], v2 offset:0
    v_mfma_f32_32x32x16_bf16 v[32:47], v[76:79], v[184:187], v[32:47]
    buffer_load_dwordx4 v[228:231], v1, s[4:7], s48 offen offset:1024 sc1
    ds_read_b128 v[72:75], v2 offset:16384
    s_waitcnt vmcnt(14) lgkmcnt(3)
    v_mfma_f32_32x32x16_bf16 v[16:31], v[80:83], v[188:191], v[16:31]
    ds_read_b128 v[76:79], v2 offset:1024
    v_mfma_f32_32x32x16_bf16 v[32:47], v[84:87], v[188:191], v[32:47]
    buffer_load_dwordx4 v[232:235], v1, s[4:7], s48 offen offset:2048 sc1
    ds_read_b128 v[80:83], v2 offset:17408
    s_waitcnt lgkmcnt(3)
    v_mfma_f32_32x32x16_bf16 v[48:63], v[64:67], v[144:147], v[48:63]
    ds_read_b128 v[84:87], v2 offset:2048
    s_waitcnt vmcnt(14)
    v_mfma_f32_32x32x16_bf16 v[16:31], v[68:71], v[192:195], v[16:31]
    buffer_load_dwordx4 v[236:239], v1, s[4:7], s48 offen offset:3072 sc1
    ds_read_b128 v[64:67], v2 offset:18432
    s_waitcnt lgkmcnt(3)
    v_mfma_f32_32x32x16_bf16 v[32:47], v[72:75], v[192:195], v[32:47]
    ds_read_b128 v[68:71], v2 offset:3072
    s_waitcnt vmcnt(14)
    v_mfma_f32_32x32x16_bf16 v[16:31], v[76:79], v[196:199], v[16:31]
    s_xor_b32 s48, s91, 28672
    buffer_load_dwordx4 v[240:243], v1, s[4:7], s48 offen offset:0 sc1
    s_barrier
    ds_read_b128 v[72:75], v2 offset:19456
    s_waitcnt lgkmcnt(3)
    v_mfma_f32_32x32x16_bf16 v[32:47], v[80:83], v[196:199], v[32:47]
    ds_read_b128 v[76:79], v121 offset:5120
    s_waitcnt vmcnt(14)
    v_mfma_f32_32x32x16_bf16 v[16:31], v[84:87], v[200:203], v[16:31]
    buffer_load_dwordx4 v[244:247], v1, s[4:7], s48 offen offset:1024 sc1
    ds_read_b128 v[80:83], v2 offset:4096
    s_waitcnt lgkmcnt(3)
    v_mfma_f32_32x32x16_bf16 v[32:47], v[64:67], v[200:203], v[32:47]
    ds_read_b128 v[84:87], v2 offset:20480
    s_waitcnt vmcnt(14)
    v_mfma_f32_32x32x16_bf16 v[16:31], v[68:71], v[204:207], v[16:31]
    buffer_load_dwordx4 v[248:251], v1, s[4:7], s48 offen offset:2048 sc1
    ds_read_b128 v[64:67], v2 offset:5120
    s_waitcnt lgkmcnt(3)
    v_mfma_f32_32x32x16_bf16 v[32:47], v[72:75], v[204:207], v[32:47]
    ds_read_b128 v[68:71], v2 offset:21504
    v_mfma_f32_32x32x16_bf16 v[48:63], v[76:79], v[148:151], v[48:63]
    buffer_load_dwordx4 v[252:255], v1, s[4:7], s48 offen offset:3072 sc1
    ds_read_b128 v[72:75], v2 offset:6144
    s_waitcnt vmcnt(11) lgkmcnt(3)
    v_mfma_f32_32x32x16_bf16 v[16:31], v[80:83], v[208:211], v[16:31]
    ds_read_b128 v[76:79], v2 offset:22528
    v_mfma_f32_32x32x16_bf16 v[32:47], v[84:87], v[208:211], v[32:47]
    ds_read_b128 v[80:83], v121 offset:6144
    s_waitcnt vmcnt(10) lgkmcnt(3)
    v_mfma_f32_32x32x16_bf16 v[16:31], v[64:67], v[212:215], v[16:31]
    ds_read_b128 v[84:87], v2 offset:7168
    v_mfma_f32_32x32x16_bf16 v[32:47], v[68:71], v[212:215], v[32:47]
    ds_read_b128 v[64:67], v2 offset:23552
    s_waitcnt vmcnt(9) lgkmcnt(3)
    v_mfma_f32_32x32x16_bf16 v[16:31], v[72:75], v[216:219], v[16:31]
    ds_read_b128 v[68:71], v2 offset:8192
    v_add_f32 v96, v96, v100
    v_add_f32 v97, v97, v101
    v_add_f32 v98, v98, v102
    v_add_f32 v99, v99, v103
    v_add_f32 v104, v104, v108
    v_mfma_f32_32x32x16_bf16 v[32:47], v[76:79], v[216:219], v[32:47]
    ds_read_b128 v[72:75], v2 offset:24576
    v_add_f32 v105, v105, v109
    v_add_f32 v106, v106, v110
    v_add_f32 v107, v107, v111
    v_add_f32 v96, v96, v104
    s_waitcnt lgkmcnt(3)
    v_mfma_f32_32x32x16_bf16 v[48:63], v[80:83], v[152:155], v[48:63]
    ds_read_b128 v[76:79], v2 offset:9216
    v_add_f32 v97, v97, v105
    v_add_f32 v98, v98, v106
    v_add_f32 v99, v99, v107
    v_add_f32 v96, v96, v98
    v_add_f32 v97, v97, v99
    s_waitcnt vmcnt(8)
    v_mfma_f32_32x32x16_bf16 v[16:31], v[84:87], v[220:223], v[16:31]
    ds_read_b128 v[80:83], v2 offset:25600
    v_mov_b32 v98, v96
    v_mov_b32 v99, v97
    s_nop 0
    v_permlane32_swap_b32 v96, v98
    v_permlane32_swap_b32 v97, v99
    s_waitcnt lgkmcnt(3)
    v_mfma_f32_32x32x16_bf16 v[32:47], v[64:67], v[220:223], v[32:47]
    ds_read_b128 v[84:87], v121 offset:7168
    v_add_f32 v96, v96, v98
    v_add_f32 v97, v97, v99
    v_mul_f32 v95, 0xbb000000, v96
    v_mul_f32 v97, 0x3b000000, v97
    v_fma_f32 v94, -v95, v95, v97
    s_waitcnt vmcnt(7)
    v_mfma_f32_32x32x16_bf16 v[16:31], v[68:71], v[224:227], v[16:31]
    ds_read_b128 v[64:67], v2 offset:10240
    v_max_f32 v94, 0, v94
    v_add_f32 v94, 0x3727c5ac, v94
    v_rsq_f32 v92, v94
    s_waitcnt lgkmcnt(3)
    v_mfma_f32_32x32x16_bf16 v[32:47], v[72:75], v[224:227], v[32:47]
    ds_read_b128 v[68:71], v2 offset:26624
    v_and_b32 v14, 4294901760, v95
    v_sub_f32 v95, v95, v14
    v_cndmask_b32 v14, v14, v95, s[60:61]
    v_cvt_pk_bf16_f32 v88, v14, v14
    v_mul_f32 v93, v92, v92
    s_waitcnt vmcnt(6)
    v_mfma_f32_32x32x16_bf16 v[16:31], v[76:79], v[228:231], v[16:31]
    ds_read_b128 v[72:75], v2 offset:11264
    v_mul_f32 v92, 0xc0135761, v92
    v_mul_f32 v93, 0x3d372713, v93
    v_mul_f32 v93, v93, v92
    s_waitcnt lgkmcnt(3)
    v_mfma_f32_32x32x16_bf16 v[32:47], v[80:83], v[228:231], v[32:47]
    ds_read_b128 v[76:79], v2 offset:27648
    v_mfma_f32_32x32x16_bf16 v[48:63], v[84:87], v[156:159], v[48:63]
    ds_read_b128 v[80:83], v2 offset:12288
    s_waitcnt vmcnt(5) lgkmcnt(3)
    v_mfma_f32_32x32x16_bf16 v[16:31], v[64:67], v[232:235], v[16:31]
    ds_read_b128 v[84:87], v2 offset:28672
    v_mfma_f32_32x32x16_bf16 v[32:47], v[68:71], v[232:235], v[32:47]
    ds_read_b128 v[64:67], v121 offset:8192
    s_waitcnt vmcnt(4) lgkmcnt(3)
    v_mfma_f32_32x32x16_bf16 v[16:31], v[72:75], v[236:239], v[16:31]
    ds_read_b128 v[68:71], v2 offset:13312
    v_mfma_f32_32x32x16_bf16 v[32:47], v[76:79], v[236:239], v[32:47]
    ds_read_b128 v[72:75], v2 offset:29696
    s_waitcnt vmcnt(3) lgkmcnt(3)
    v_mfma_f32_32x32x16_bf16 v[16:31], v[80:83], v[240:243], v[16:31]
    ds_read_b128 v[76:79], v2 offset:14336
    v_mfma_f32_32x32x16_bf16 v[32:47], v[84:87], v[240:243], v[32:47]
    ds_read_b128 v[80:83], v2 offset:30720
    s_waitcnt lgkmcnt(3)
    v_mfma_f32_32x32x16_bf16 v[48:63], v[64:67], v[160:163], v[48:63]
    ds_read_b128 v[84:87], v2 offset:15360
    s_waitcnt vmcnt(2)
    v_mfma_f32_32x32x16_bf16 v[16:31], v[68:71], v[244:247], v[16:31]
    ds_read_b128 v[64:67], v2 offset:31744
    s_waitcnt lgkmcnt(3)
    v_mfma_f32_32x32x16_bf16 v[32:47], v[72:75], v[244:247], v[32:47]
    ds_read_b128 v[68:71], v121 offset:9216
    s_waitcnt vmcnt(1)
    v_mfma_f32_32x32x16_bf16 v[16:31], v[76:79], v[248:251], v[16:31]
    ds_read_b32 v72, v120 offset:0
    s_waitcnt lgkmcnt(3)
    v_mfma_f32_32x32x16_bf16 v[32:47], v[80:83], v[248:251], v[32:47]
    ds_read_b32 v76, v120 offset:128
    s_waitcnt vmcnt(0)
    v_mfma_f32_32x32x16_bf16 v[16:31], v[84:87], v[252:255], v[16:31]
    ds_read_b128 v[80:83], v121 offset:10240
    s_waitcnt lgkmcnt(3)
    v_mfma_f32_32x32x16_bf16 v[32:47], v[64:67], v[252:255], v[32:47]
    ds_read_b128 v[84:87], v121 offset:11264
    v_mfma_f32_32x32x16_bf16 v[48:63], v[68:71], v[164:167], v[48:63]
    ds_read_b128 v[64:67], v121 offset:12288
    s_waitcnt lgkmcnt(3)
    v_mfma_f32_32x32x16_bf16 v[16:31], v[72:75], v[88:91], v[16:31]
    ds_read_b128 v[68:71], v121 offset:13312
    v_mfma_f32_32x32x16_bf16 v[32:47], v[76:79], v[88:91], v[32:47]
    s_barrier
    ds_read_b128 v[72:75], v121 offset:14336
    s_waitcnt lgkmcnt(3)
    v_mfma_f32_32x32x16_bf16 v[48:63], v[80:83], v[168:171], v[48:63]
    ds_read_b128 v[76:79], v121 offset:15360
    v_mfma_f32_32x32x16_bf16 v[48:63], v[84:87], v[172:175], v[48:63]
    ds_read_b128 v[80:83], v121 offset:16384
    s_waitcnt lgkmcnt(3)
    v_mfma_f32_32x32x16_bf16 v[48:63], v[64:67], v[176:179], v[48:63]
    ds_read_b128 v[84:87], v121 offset:17408
    v_mul_f32 v112, v16, v16
    v_mul_f32 v24, v16, v24
    v_mul_f32 v113, v17, v17
    v_fma_f32 v112, v112, v93, v92
    v_mul_f32 v25, v17, v25
    v_mfma_f32_32x32x16_bf16 v[48:63], v[68:71], v[180:183], v[48:63]
    ds_read_b128 v[64:67], v121 offset:18432
    v_mul_f32 v114, v18, v18
    v_fma_f32 v113, v113, v93, v92
    v_mul_f32 v26, v18, v26
    v_mul_f32 v16, v112, v16
    s_waitcnt lgkmcnt(3)
    v_mfma_f32_32x32x16_bf16 v[48:63], v[72:75], v[184:187], v[48:63]
    ds_read_b128 v[68:71], v121 offset:19456
    v_exp_f32 v16, v16
    v_mul_f32 v115, v19, v19
    v_fma_f32 v114, v114, v93, v92
    v_mul_f32 v27, v19, v27
    v_mfma_f32_32x32x16_bf16 v[48:63], v[76:79], v[188:191], v[48:63]
    ds_read_b128 v[72:75], v121 offset:20480
    v_mul_f32 v17, v113, v17
    v_exp_f32 v17, v17
    v_mul_f32 v112, v20, v20
    s_waitcnt lgkmcnt(3)
    v_mfma_f32_32x32x16_bf16 v[48:63], v[80:83], v[192:195], v[48:63]
    ds_read_b128 v[76:79], v121 offset:21504
    v_fma_f32 v115, v115, v93, v92
    v_mul_f32 v28, v20, v28
    v_mul_f32 v18, v114, v18
    v_fma_f32 v16, v16, v94, v94
    v_mfma_f32_32x32x16_bf16 v[48:63], v[84:87], v[196:199], v[48:63]
    ds_read_b128 v[80:83], v121 offset:22528
    v_exp_f32 v18, v18
    v_mul_f32 v113, v21, v21
    v_fma_f32 v112, v112, v93, v92
    v_mul_f32 v29, v21, v29
    s_waitcnt lgkmcnt(3)
    v_mfma_f32_32x32x16_bf16 v[48:63], v[64:67], v[200:203], v[48:63]
    ds_read_b128 v[84:87], v121 offset:23552
    v_rcp_f32 v16, v16
    v_mul_f32 v19, v115, v19
    v_fma_f32 v17, v17, v94, v94
    v_mfma_f32_32x32x16_bf16 v[48:63], v[68:71], v[204:207], v[48:63]
    ds_read_b128 v[64:67], v121 offset:24576
    v_exp_f32 v19, v19
    v_mul_f32 v114, v22, v22
    v_fma_f32 v113, v113, v93, v92
    v_mul_f32 v30, v22, v30
    s_waitcnt lgkmcnt(3)
    v_mfma_f32_32x32x16_bf16 v[48:63], v[72:75], v[208:211], v[48:63]
    ds_read_b128 v[68:71], v121 offset:25600
    v_rcp_f32 v17, v17
    v_mul_f32 v20, v112, v20
    v_fma_f32 v18, v18, v94, v94
    v_mul_f32 v16, v16, v24
    v_mfma_f32_32x32x16_bf16 v[48:63], v[76:79], v[212:215], v[48:63]
    ds_read_b128 v[72:75], v121 offset:26624
    v_exp_f32 v20, v20
    v_mul_f32 v115, v23, v23
    v_fma_f32 v114, v114, v93, v92
    s_waitcnt lgkmcnt(3)
    v_mfma_f32_32x32x16_bf16 v[48:63], v[80:83], v[216:219], v[48:63]
    ds_read_b128 v[76:79], v121 offset:27648
    v_mul_f32 v31, v23, v31
    v_rcp_f32 v18, v18
    v_mul_f32 v21, v113, v21
    v_fma_f32 v19, v19, v94, v94
    v_mfma_f32_32x32x16_bf16 v[48:63], v[84:87], v[220:223], v[48:63]
    ds_read_b128 v[80:83], v121 offset:28672
    v_mul_f32 v17, v17, v25
    v_exp_f32 v21, v21
    v_fma_f32 v115, v115, v93, v92
    s_waitcnt lgkmcnt(3)
    v_mfma_f32_32x32x16_bf16 v[48:63], v[64:67], v[224:227], v[48:63]
    ds_read_b128 v[84:87], v121 offset:29696
    v_rcp_f32 v19, v19
    v_mul_f32 v22, v114, v22
    v_fma_f32 v20, v20, v94, v94
    v_mul_f32 v18, v18, v26
    v_mfma_f32_32x32x16_bf16 v[48:63], v[68:71], v[228:231], v[48:63]
    ds_read_b128 v[64:67], v121 offset:30720
    v_cvt_pk_bf16_f32 v24, v16, v17
    v_exp_f32 v22, v22
    s_waitcnt lgkmcnt(3)
    v_mfma_f32_32x32x16_bf16 v[48:63], v[72:75], v[232:235], v[48:63]
    ds_read_b128 v[68:71], v121 offset:31744
    v_rcp_f32 v20, v20
    v_mul_f32 v23, v115, v23
    v_fma_f32 v21, v21, v94, v94
    v_mul_f32 v19, v19, v27
    v_mfma_f32_32x32x16_bf16 v[48:63], v[76:79], v[236:239], v[48:63]
    ds_read_b32 v72, v120 offset:256
    v_exp_f32 v23, v23
    v_rcp_f32 v21, v21
    v_fma_f32 v22, v22, v94, v94
    s_waitcnt lgkmcnt(3)
    v_mfma_f32_32x32x16_bf16 v[48:63], v[80:83], v[240:243], v[48:63]
    s_add_u32 s44, s44, 65536
    s_and_b32 s44, s44, 131071
    v_add_u32 v2, s44, v1
    ds_read_b128 v[76:79], v2 offset:0
    v_mul_f32 v20, v20, v28
    v_cvt_pk_bf16_f32 v25, v18, v19
    v_mfma_f32_32x32x16_bf16 v[48:63], v[84:87], v[244:247], v[48:63]
    ds_read_b128 v[80:83], v2 offset:1024
    v_rcp_f32 v22, v22
    v_fma_f32 v23, v23, v94, v94
    v_mul_f32 v21, v21, v29
    s_waitcnt lgkmcnt(3)
    v_mfma_f32_32x32x16_bf16 v[48:63], v[64:67], v[248:251], v[48:63]
    ds_read_b128 v[84:87], v2 offset:2048
    v_rcp_f32 v23, v23
    v_mul_f32 v22, v22, v30
    v_cvt_pk_bf16_f32 v26, v20, v21
    s_add_u32 s41, s85, 0
    v_mfma_f32_32x32x16_bf16 v[48:63], v[68:71], v[252:255], v[48:63]
    ds_read_b128 v[64:67], v2 offset:3072
    v_mul_f32 v23, v23, v31
    v_cvt_pk_bf16_f32 v27, v22, v23
    buffer_store_dwordx4 v[24:27], v1, s[4:7], s41 offen sc1
    v_mul_f32 v112, v32, v32
    s_waitcnt lgkmcnt(3)
    v_mfma_f32_32x32x16_bf16 v[48:63], v[72:75], v[88:91], v[48:63]
    s_barrier
    ds_read_b128 v[68:71], v2 offset:4096
    v_mul_f32 v40, v32, v40
    v_mul_f32 v113, v33, v33
    v_fma_f32 v112, v112, v93, v92
    v_mul_f32 v41, v33, v41
    v_mfma_f32_32x32x16_bf16 v[96:111], v[76:79], v[128:131], 0
    ds_read_b128 v[72:75], v2 offset:5120
    v_mul_f32 v114, v34, v34
    v_fma_f32 v113, v113, v93, v92
    v_mul_f32 v42, v34, v42
    v_mul_f32 v32, v112, v32
    s_waitcnt lgkmcnt(3)
    v_mfma_f32_32x32x16_bf16 v[96:111], v[80:83], v[132:135], v[96:111]
    ds_read_b128 v[76:79], v2 offset:6144
    v_exp_f32 v32, v32
    v_mul_f32 v115, v35, v35
    v_fma_f32 v114, v114, v93, v92
    v_mul_f32 v43, v35, v43
    v_mfma_f32_32x32x16_bf16 v[96:111], v[84:87], v[136:139], v[96:111]
    ds_read_b128 v[80:83], v2 offset:7168
    v_mul_f32 v33, v113, v33
    v_exp_f32 v33, v33
    v_mul_f32 v112, v36, v36
    s_waitcnt lgkmcnt(3)
    v_mfma_f32_32x32x16_bf16 v[96:111], v[64:67], v[140:143], v[96:111]
    ds_read_b128 v[84:87], v2 offset:8192
    v_fma_f32 v115, v115, v93, v92
    v_mul_f32 v44, v36, v44
    v_mul_f32 v34, v114, v34
    v_fma_f32 v32, v32, v94, v94
    v_mfma_f32_32x32x16_bf16 v[96:111], v[68:71], v[144:147], v[96:111]
    ds_read_b128 v[64:67], v2 offset:9216
    v_exp_f32 v34, v34
    v_mul_f32 v113, v37, v37
    v_fma_f32 v112, v112, v93, v92
    v_mul_f32 v45, v37, v45
    s_waitcnt lgkmcnt(3)
    v_mfma_f32_32x32x16_bf16 v[96:111], v[72:75], v[148:151], v[96:111]
    ds_read_b128 v[68:71], v2 offset:10240
    v_rcp_f32 v32, v32
    v_mul_f32 v35, v115, v35
    v_fma_f32 v33, v33, v94, v94
    v_mfma_f32_32x32x16_bf16 v[96:111], v[76:79], v[152:155], v[96:111]
    ds_read_b128 v[72:75], v2 offset:11264
    v_exp_f32 v35, v35
    v_mul_f32 v114, v38, v38
    v_fma_f32 v113, v113, v93, v92
    v_mul_f32 v46, v38, v46
    s_waitcnt lgkmcnt(3)
    v_mfma_f32_32x32x16_bf16 v[96:111], v[80:83], v[156:159], v[96:111]
    ds_read_b128 v[76:79], v2 offset:12288
    v_rcp_f32 v33, v33
    v_mul_f32 v36, v112, v36
    v_fma_f32 v34, v34, v94, v94
    v_mul_f32 v32, v32, v40
    v_mfma_f32_32x32x16_bf16 v[96:111], v[84:87], v[160:163], v[96:111]
    ds_read_b128 v[80:83], v2 offset:13312
    v_exp_f32 v36, v36
    v_mul_f32 v115, v39, v39
    v_fma_f32 v114, v114, v93, v92
    s_waitcnt lgkmcnt(3)
    v_mfma_f32_32x32x16_bf16 v[96:111], v[64:67], v[164:167], v[96:111]
    ds_read_b128 v[84:87], v2 offset:14336
    v_mul_f32 v47, v39, v47
    v_rcp_f32 v34, v34
    v_mul_f32 v37, v113, v37
    v_fma_f32 v35, v35, v94, v94
    v_mfma_f32_32x32x16_bf16 v[96:111], v[68:71], v[168:171], v[96:111]
    ds_read_b128 v[64:67], v2 offset:15360
    v_mul_f32 v33, v33, v41
    v_exp_f32 v37, v37
    v_fma_f32 v115, v115, v93, v92
    s_waitcnt lgkmcnt(3)
    v_mfma_f32_32x32x16_bf16 v[96:111], v[72:75], v[172:175], v[96:111]
    ds_read_b128 v[68:71], v2 offset:16384
    v_rcp_f32 v35, v35
    v_mul_f32 v38, v114, v38
    v_fma_f32 v36, v36, v94, v94
    v_mul_f32 v34, v34, v42
    v_mfma_f32_32x32x16_bf16 v[96:111], v[76:79], v[176:179], v[96:111]
    ds_read_b128 v[72:75], v2 offset:17408
    v_cvt_pk_bf16_f32 v40, v32, v33
    v_exp_f32 v38, v38
    s_waitcnt lgkmcnt(3)
    v_mfma_f32_32x32x16_bf16 v[96:111], v[80:83], v[180:183], v[96:111]
    ds_read_b128 v[76:79], v2 offset:18432
    v_rcp_f32 v36, v36
    v_mul_f32 v39, v115, v39
    v_fma_f32 v37, v37, v94, v94
    v_mul_f32 v35, v35, v43
    v_mfma_f32_32x32x16_bf16 v[96:111], v[84:87], v[184:187], v[96:111]
    ds_read_b128 v[80:83], v2 offset:19456
    v_exp_f32 v39, v39
    v_rcp_f32 v37, v37
    v_fma_f32 v38, v38, v94, v94
    s_waitcnt lgkmcnt(3)
    v_mfma_f32_32x32x16_bf16 v[96:111], v[64:67], v[188:191], v[96:111]
    ds_read_b128 v[84:87], v2 offset:20480
    v_mul_f32 v36, v36, v44
    v_cvt_pk_bf16_f32 v41, v34, v35
    v_rcp_f32 v38, v38
    v_fma_f32 v39, v39, v94, v94
    v_mfma_f32_32x32x16_bf16 v[96:111], v[68:71], v[192:195], v[96:111]
    ds_read_b128 v[64:67], v2 offset:21504
    v_mul_f32 v37, v37, v45
    v_rcp_f32 v39, v39
    v_mul_f32 v38, v38, v46
    s_waitcnt lgkmcnt(3)
    v_mfma_f32_32x32x16_bf16 v[96:111], v[72:75], v[196:199], v[96:111]
    ds_read_b128 v[68:71], v2 offset:22528
    v_cvt_pk_bf16_f32 v42, v36, v37
    s_add_u32 s41, s85, 16384
    v_mul_f32 v39, v39, v47
    v_cvt_pk_bf16_f32 v43, v38, v39
    buffer_store_dwordx4 v[40:43], v1, s[4:7], s41 offen sc1
    v_mfma_f32_32x32x16_bf16 v[96:111], v[76:79], v[200:203], v[96:111]
    ds_read_b128 v[72:75], v2 offset:23552
    v_mul_f32 v112, v48, v48
    v_mul_f32 v56, v48, v56
    v_mul_f32 v113, v49, v49
    v_fma_f32 v112, v112, v93, v92
    s_waitcnt lgkmcnt(3)
    v_mfma_f32_32x32x16_bf16 v[96:111], v[80:83], v[204:207], v[96:111]
    ds_read_b128 v[76:79], v2 offset:24576
    v_mul_f32 v57, v49, v57
    v_mul_f32 v114, v50, v50
    v_fma_f32 v113, v113, v93, v92
    v_mul_f32 v58, v50, v58
    v_mul_f32 v48, v112, v48
    v_mfma_f32_32x32x16_bf16 v[96:111], v[84:87], v[208:211], v[96:111]
    ds_read_b128 v[80:83], v2 offset:25600
    v_exp_f32 v48, v48
    v_mul_f32 v115, v51, v51
    v_fma_f32 v114, v114, v93, v92
    s_waitcnt lgkmcnt(3)
    v_mfma_f32_32x32x16_bf16 v[96:111], v[64:67], v[212:215], v[96:111]
    ds_read_b128 v[84:87], v2 offset:26624
    v_mul_f32 v59, v51, v59
    v_mul_f32 v49, v113, v49
    v_exp_f32 v49, v49
    v_mul_f32 v112, v52, v52
    v_mfma_f32_32x32x16_bf16 v[96:111], v[68:71], v[216:219], v[96:111]
    ds_read_b128 v[64:67], v2 offset:27648
    v_fma_f32 v115, v115, v93, v92
    v_mul_f32 v60, v52, v60
    v_mul_f32 v50, v114, v50
    v_fma_f32 v48, v48, v94, v94
    s_waitcnt lgkmcnt(3)
    v_mfma_f32_32x32x16_bf16 v[96:111], v[72:75], v[220:223], v[96:111]
    ds_read_b128 v[68:71], v2 offset:28672
    v_exp_f32 v50, v50
    v_mul_f32 v113, v53, v53
    v_fma_f32 v112, v112, v93, v92
    v_mul_f32 v61, v53, v61
    v_mfma_f32_32x32x16_bf16 v[96:111], v[76:79], v[224:227], v[96:111]
    ds_read_b128 v[72:75], v2 offset:29696
    v_rcp_f32 v48, v48
    v_mul_f32 v51, v115, v51
    v_fma_f32 v49, v49, v94, v94
    s_waitcnt lgkmcnt(3)
    v_mfma_f32_32x32x16_bf16 v[96:111], v[80:83], v[228:231], v[96:111]
    ds_read_b128 v[76:79], v2 offset:30720
    v_exp_f32 v51, v51
    v_mul_f32 v114, v54, v54
    v_fma_f32 v113, v113, v93, v92
    v_mul_f32 v62, v54, v62
    v_mfma_f32_32x32x16_bf16 v[96:111], v[84:87], v[232:235], v[96:111]
    ds_read_b128 v[80:83], v2 offset:31744
    v_rcp_f32 v49, v49
    v_mul_f32 v52, v112, v52
    v_fma_f32 v50, v50, v94, v94
    s_waitcnt lgkmcnt(3)
    v_mfma_f32_32x32x16_bf16 v[96:111], v[64:67], v[236:239], v[96:111]
    ds_read_b32 v84, v120 offset:384
    v_mul_f32 v48, v48, v56
    v_exp_f32 v52, v52
    v_mul_f32 v115, v55, v55
    v_fma_f32 v114, v114, v93, v92
    v_mfma_f32_32x32x16_bf16 v[96:111], v[68:71], v[240:243], v[96:111]
    s_add_u32 s44, s44, 32768
    s_and_b32 s44, s44, 131071
    v_add_u32 v2, s44, v1
    ds_read_b128 v[64:67], v2 offset:0
    v_mul_f32 v63, v55, v63
    s_waitcnt lgkmcnt(3)
    v_mfma_f32_32x32x16_bf16 v[96:111], v[72:75], v[244:247], v[96:111]
    ds_read_b128 v[68:71], v2 offset:1024
    v_rcp_f32 v50, v50
    v_mul_f32 v53, v113, v53
    v_fma_f32 v51, v51, v94, v94
    v_mul_f32 v49, v49, v57
    v_mfma_f32_32x32x16_bf16 v[96:111], v[76:79], v[248:251], v[96:111]
    ds_read_b128 v[72:75], v2 offset:2048
    v_exp_f32 v53, v53
    v_fma_f32 v115, v115, v93, v92
    s_waitcnt lgkmcnt(3)
    v_mfma_f32_32x32x16_bf16 v[96:111], v[80:83], v[252:255], v[96:111]
    ds_read_b128 v[76:79], v2 offset:3072
    v_rcp_f32 v51, v51
    v_mul_f32 v54, v114, v54
    v_fma_f32 v52, v52, v94, v94
    v_mul_f32 v50, v50, v58
    v_cvt_pk_bf16_f32 v56, v48, v49
    v_mfma_f32_32x32x16_bf16 v[96:111], v[84:87], v[88:91], v[96:111]
    s_barrier
    ds_read_b128 v[80:83], v2 offset:4096
    v_exp_f32 v54, v54
    s_waitcnt lgkmcnt(3)
    v_mfma_f32_32x32x16_bf16 v[16:31], v[64:67], v[128:131], 0
    ds_read_b128 v[84:87], v2 offset:5120
    v_rcp_f32 v52, v52
    v_mul_f32 v55, v115, v55
    v_fma_f32 v53, v53, v94, v94
    v_mul_f32 v51, v51, v59
    v_mfma_f32_32x32x16_bf16 v[16:31], v[68:71], v[132:135], v[16:31]
    ds_read_b128 v[64:67], v2 offset:6144
    v_exp_f32 v55, v55
    v_rcp_f32 v53, v53
    v_fma_f32 v54, v54, v94, v94
    s_waitcnt lgkmcnt(3)
    v_mfma_f32_32x32x16_bf16 v[16:31], v[72:75], v[136:139], v[16:31]
    ds_read_b128 v[68:71], v2 offset:7168
    v_mul_f32 v52, v52, v60
    v_cvt_pk_bf16_f32 v57, v50, v51
    v_rcp_f32 v54, v54
    v_fma_f32 v55, v55, v94, v94
    v_mfma_f32_32x32x16_bf16 v[16:31], v[76:79], v[140:143], v[16:31]
    s_waitcnt vmcnt(1)
    buffer_store_dword v12, off, s[4:7], s82 offset:256 sc1
    ds_read_b128 v[72:75], v2 offset:8192
    v_mul_f32 v53, v53, v61
    v_rcp_f32 v55, v55
    s_waitcnt lgkmcnt(3)
    v_mfma_f32_32x32x16_bf16 v[16:31], v[80:83], v[144:147], v[16:31]
    s_waitcnt vmcnt(1)
    buffer_store_dword v12, off, s[4:7], s82 offset:320 sc1
    ds_read_b128 v[76:79], v2 offset:9216
    v_mul_f32 v54, v54, v62
    v_cvt_pk_bf16_f32 v58, v52, v53
    s_add_u32 s41, s85, 32768
    v_mul_f32 v55, v55, v63
    v_mfma_f32_32x32x16_bf16 v[16:31], v[84:87], v[148:151], v[16:31]
    ds_read_b128 v[80:83], v2 offset:10240
    v_cvt_pk_bf16_f32 v59, v54, v55
    buffer_store_dwordx4 v[56:59], v1, s[4:7], s41 offen sc1
    v_mul_f32 v112, v96, v96
    v_mul_f32 v104, v96, v104
    s_waitcnt lgkmcnt(3)
    v_mfma_f32_32x32x16_bf16 v[16:31], v[64:67], v[152:155], v[16:31]
    ds_read_b128 v[84:87], v2 offset:11264
    v_mul_f32 v113, v97, v97
    v_fma_f32 v112, v112, v93, v92
    v_mul_f32 v105, v97, v105
    v_mul_f32 v114, v98, v98
    v_fma_f32 v113, v113, v93, v92
    v_mfma_f32_32x32x16_bf16 v[16:31], v[68:71], v[156:159], v[16:31]
    ds_read_b128 v[64:67], v2 offset:12288
    v_mul_f32 v106, v98, v106
    v_mul_f32 v96, v112, v96
    v_exp_f32 v96, v96
    s_waitcnt lgkmcnt(3)
    v_mfma_f32_32x32x16_bf16 v[16:31], v[72:75], v[160:163], v[16:31]
    ds_read_b128 v[68:71], v2 offset:13312
    v_mul_f32 v115, v99, v99
    v_fma_f32 v114, v114, v93, v92
    v_mul_f32 v107, v99, v107
    v_mul_f32 v97, v113, v97
    v_mfma_f32_32x32x16_bf16 v[16:31], v[76:79], v[164:167], v[16:31]
    ds_read_b128 v[72:75], v2 offset:14336
    v_exp_f32 v97, v97
    v_mul_f32 v112, v100, v100
    v_fma_f32 v115, v115, v93, v92
    v_mul_f32 v108, v100, v108
    s_waitcnt lgkmcnt(3)
    v_mfma_f32_32x32x16_bf16 v[16:31], v[80:83], v[168:171], v[16:31]
    ds_read_b128 v[76:79], v2 offset:15360
    v_mul_f32 v98, v114, v98
    v_fma_f32 v96, v96, v94, v94
    v_exp_f32 v98, v98
    v_mul_f32 v113, v101, v101
    v_mfma_f32_32x32x16_bf16 v[16:31], v[84:87], v[172:175], v[16:31]
    ds_read_b128 v[80:83], v2 offset:16384
    v_fma_f32 v112, v112, v93, v92
    v_mul_f32 v109, v101, v109
    v_rcp_f32 v96, v96
    s_waitcnt lgkmcnt(3)
    v_mfma_f32_32x32x16_bf16 v[16:31], v[64:67], v[176:179], v[16:31]
    ds_read_b128 v[84:87], v2 offset:17408
    v_mul_f32 v99, v115, v99
    v_fma_f32 v97, v97, v94, v94
    v_exp_f32 v99, v99
    v_mul_f32 v114, v102, v102
    v_mfma_f32_32x32x16_bf16 v[16:31], v[68:71], v[180:183], v[16:31]
    ds_read_b128 v[64:67], v2 offset:18432
    v_fma_f32 v113, v113, v93, v92
    v_mul_f32 v110, v102, v110
    v_rcp_f32 v97, v97
    s_waitcnt lgkmcnt(3)
    v_mfma_f32_32x32x16_bf16 v[16:31], v[72:75], v[184:187], v[16:31]
    ds_read_b128 v[68:71], v2 offset:19456
    v_mul_f32 v100, v112, v100
    v_fma_f32 v98, v98, v94, v94
    v_mul_f32 v96, v96, v104
    v_exp_f32 v100, v100
    v_mfma_f32_32x32x16_bf16 v[16:31], v[76:79], v[188:191], v[16:31]
    ds_read_b128 v[72:75], v2 offset:20480
    v_mul_f32 v115, v103, v103
    v_fma_f32 v114, v114, v93, v92
    v_mul_f32 v111, v103, v111
    s_waitcnt lgkmcnt(3)
    v_mfma_f32_32x32x16_bf16 v[16:31], v[80:83], v[192:195], v[16:31]
    ds_read_b128 v[76:79], v2 offset:21504
    v_rcp_f32 v98, v98
    v_mul_f32 v101, v113, v101
    v_fma_f32 v99, v99, v94, v94
    v_mul_f32 v97, v97, v105
    v_mfma_f32_32x32x16_bf16 v[16:31], v[84:87], v[196:199], v[16:31]
    ds_read_b128 v[80:83], v2 offset:22528
    v_exp_f32 v101, v101
    v_fma_f32 v115, v115, v93, v92
    v_rcp_f32 v99, v99
    s_waitcnt lgkmcnt(3)
    v_mfma_f32_32x32x16_bf16 v[16:31], v[64:67], v[200:203], v[16:31]
    ds_read_b128 v[84:87], v2 offset:23552
    v_mul_f32 v102, v114, v102
    v_fma_f32 v100, v100, v94, v94
    v_mul_f32 v98, v98, v106
    v_cvt_pk_bf16_f32 v104, v96, v97
    v_mfma_f32_32x32x16_bf16 v[16:31], v[68:71], v[204:207], v[16:31]
    ds_read_b128 v[64:67], v2 offset:24576
    v_exp_f32 v102, v102
    v_rcp_f32 v100, v100
    v_mul_f32 v103, v115, v103
    s_waitcnt lgkmcnt(3)
    v_mfma_f32_32x32x16_bf16 v[16:31], v[72:75], v[208:211], v[16:31]
    ds_read_b128 v[68:71], v2 offset:25600
    v_fma_f32 v101, v101, v94, v94
    v_mul_f32 v99, v99, v107
    v_exp_f32 v103, v103
    v_mfma_f32_32x32x16_bf16 v[16:31], v[76:79], v[212:215], v[16:31]
    ds_read_b128 v[72:75], v2 offset:26624
    v_rcp_f32 v101, v101
    v_fma_f32 v102, v102, v94, v94
    v_mul_f32 v100, v100, v108
    v_cvt_pk_bf16_f32 v105, v98, v99
    s_waitcnt lgkmcnt(3)
    v_mfma_f32_32x32x16_bf16 v[16:31], v[80:83], v[216:219], v[16:31]
    ds_read_b128 v[76:79], v2 offset:27648
    v_rcp_f32 v102, v102
    v_fma_f32 v103, v103, v94, v94
    v_mul_f32 v101, v101, v109
    v_mfma_f32_32x32x16_bf16 v[16:31], v[84:87], v[220:223], v[16:31]
    ds_read_b128 v[80:83], v2 offset:28672
    v_rcp_f32 v103, v103
    v_mul_f32 v102, v102, v110
    v_cvt_pk_bf16_f32 v106, v100, v101
    s_add_u32 s41, s85, 49152
    s_waitcnt lgkmcnt(3)
    v_mfma_f32_32x32x16_bf16 v[16:31], v[64:67], v[224:227], v[16:31]
    ds_read_b128 v[84:87], v2 offset:29696
    v_mul_f32 v103, v103, v111
    v_cvt_pk_bf16_f32 v107, v102, v103
    buffer_store_dwordx4 v[104:107], v1, s[4:7], s41 offen sc1
    v_lshlrev_b32 v48, 16, v4
    v_and_b32 v49, 4294901760, v4
    v_mfma_f32_32x32x16_bf16 v[16:31], v[68:71], v[228:231], v[16:31]
    s_waitcnt vmcnt(1)
    buffer_store_dword v12, off, s[4:7], s82 offset:384 sc1
    ds_read_b128 v[64:67], v2 offset:30720
    v_lshlrev_b32 v50, 16, v5
    v_and_b32 v51, 4294901760, v5
    v_lshlrev_b32 v52, 16, v6
    s_waitcnt lgkmcnt(3)
    v_mfma_f32_32x32x16_bf16 v[16:31], v[72:75], v[232:235], v[16:31]
    ds_read_b128 v[68:71], v2 offset:31744
    v_and_b32 v53, 4294901760, v6
    v_lshlrev_b32 v54, 16, v7
    v_and_b32 v55, 4294901760, v7
    v_lshlrev_b32 v56, 16, v8
    v_and_b32 v57, 4294901760, v8
    v_mfma_f32_32x32x16_bf16 v[16:31], v[76:79], v[236:239], v[16:31]
    ds_read_b32 v72, v120 offset:512
    v_lshlrev_b32 v58, 16, v9
    v_and_b32 v59, 4294901760, v9
    v_lshlrev_b32 v60, 16, v10
    v_and_b32 v61, 4294901760, v10
    s_waitcnt lgkmcnt(3)
    v_mfma_f32_32x32x16_bf16 v[16:31], v[80:83], v[240:243], v[16:31]
    s_add_u32 s44, s44, 32768
    s_and_b32 s44, s44, 131071
    v_add_u32 v2, s44, v1
    ds_read_b128 v[76:79], v2 offset:0
    v_lshlrev_b32 v62, 16, v11
    v_and_b32 v63, 4294901760, v11
    v_mfma_f32_32x32x16_bf16 v[16:31], v[84:87], v[244:247], v[16:31]
    ds_read_b128 v[80:83], v2 offset:1024
    s_waitcnt lgkmcnt(3)
    v_mfma_f32_32x32x16_bf16 v[16:31], v[64:67], v[248:251], v[16:31]
    v_and_b32 v15, 31, v0
    v_lshlrev_b32 v15, 2, v15
    ds_read_b128 v[84:87], v2 offset:2048
    v_mfma_f32_32x32x16_bf16 v[16:31], v[68:71], v[252:255], v[16:31]
    buffer_load_dword v125, v15, s[4:7], s81 offen offset:256 sc1
    ds_read_b128 v[64:67], v2 offset:3072
    s_waitcnt lgkmcnt(3)
    v_mfma_f32_32x32x16_bf16 v[16:31], v[72:75], v[88:91], v[16:31]
    s_barrier
    ds_read_b128 v[68:71], v2 offset:4096
    v_mfma_f32_32x32x16_bf16 v[32:47], v[76:79], v[128:131], 0
    ds_read_b128 v[72:75], v2 offset:5120
    s_waitcnt lgkmcnt(3)
    v_mfma_f32_32x32x16_bf16 v[32:47], v[80:83], v[132:135], v[32:47]
    ds_read_b128 v[76:79], v2 offset:6144
    v_mfma_f32_32x32x16_bf16 v[32:47], v[84:87], v[136:139], v[32:47]
    ds_read_b128 v[80:83], v2 offset:7168
    s_nop 2
    v_mul_f32 v112, v16, v16
    v_mul_f32 v24, v16, v24
    v_mul_f32 v113, v17, v17
    v_fma_f32 v112, v112, v93, v92
    s_waitcnt lgkmcnt(3)
    v_mfma_f32_32x32x16_bf16 v[32:47], v[64:67], v[140:143], v[32:47]
    ds_read_b128 v[84:87], v2 offset:8192
    v_mul_f32 v25, v17, v25
    v_mul_f32 v114, v18, v18
    v_fma_f32 v113, v113, v93, v92
    v_mul_f32 v26, v18, v26
    v_mul_f32 v16, v112, v16
    v_mfma_f32_32x32x16_bf16 v[32:47], v[68:71], v[144:147], v[32:47]
    ds_read_b128 v[64:67], v2 offset:9216
    v_exp_f32 v16, v16
    v_mul_f32 v115, v19, v19
    v_fma_f32 v114, v114, v93, v92
    s_waitcnt lgkmcnt(3)
    v_mfma_f32_32x32x16_bf16 v[32:47], v[72:75], v[148:151], v[32:47]
    ds_read_b128 v[68:71], v2 offset:10240
    v_mul_f32 v27, v19, v27
    v_mul_f32 v17, v113, v17
    v_exp_f32 v17, v17
    v_mul_f32 v112, v20, v20
    v_mfma_f32_32x32x16_bf16 v[32:47], v[76:79], v[152:155], v[32:47]
    ds_read_b128 v[72:75], v2 offset:11264
    v_fma_f32 v115, v115, v93, v92
    v_mul_f32 v28, v20, v28
    v_mul_f32 v18, v114, v18
    v_fma_f32 v16, v16, v94, v94
    s_waitcnt lgkmcnt(3)
    v_mfma_f32_32x32x16_bf16 v[32:47], v[80:83], v[156:159], v[32:47]
    ds_read_b128 v[76:79], v2 offset:12288
    v_exp_f32 v18, v18
    v_mul_f32 v113, v21, v21
    v_fma_f32 v112, v112, v93, v92
    v_mul_f32 v29, v21, v29
    v_mfma_f32_32x32x16_bf16 v[32:47], v[84:87], v[160:163], v[32:47]
    ds_read_b128 v[80:83], v2 offset:13312
    v_rcp_f32 v16, v16
    v_mul_f32 v19, v115, v19
    v_fma_f32 v17, v17, v94, v94
    s_waitcnt lgkmcnt(3)
    v_mfma_f32_32x32x16_bf16 v[32:47], v[64:67], v[164:167], v[32:47]
    s_waitcnt vmcnt(2)
    buffer_store_dword v12, off, s[4:7], s82 offset:448 sc1
    ds_read_b128 v[84:87], v2 offset:14336
    v_exp_f32 v19, v19
    v_mul_f32 v114, v22, v22
    v_fma_f32 v113, v113, v93, v92
    v_mfma_f32_32x32x16_bf16 v[32:47], v[68:71], v[168:171], v[32:47]
    s_waitcnt vmcnt(1)
    v_cmp_ne_u32 vcc, s71, v125
    s_cbranch_vccnz .Lsoftx_129
.Lsoft_128:
    ds_read_b128 v[64:67], v2 offset:15360
    v_mul_f32 v30, v22, v30
    s_waitcnt lgkmcnt(3)
    v_mfma_f32_32x32x16_bf16 v[32:47], v[72:75], v[172:175], v[32:47]
    s_add_u32 s48, s84, 0
    buffer_load_dwordx4 v[128:131], v1, s[4:7], s48 offen offset:0 sc1
    ds_read_b128 v[68:71], v2 offset:16384
    v_rcp_f32 v17, v17
    v_mul_f32 v20, v112, v20
    v_fma_f32 v18, v18, v94, v94
    v_mfma_f32_32x32x16_bf16 v[32:47], v[76:79], v[176:179], v[32:47]
    ds_read_b128 v[72:75], v2 offset:17408
    v_mul_f32 v16, v16, v24
    v_exp_f32 v20, v20
    v_mul_f32 v115, v23, v23
    s_waitcnt lgkmcnt(3)
    v_mfma_f32_32x32x16_bf16 v[32:47], v[80:83], v[180:183], v[32:47]
    buffer_load_dwordx4 v[132:135], v1, s[4:7], s48 offen offset:2048 sc1
    ds_read_b128 v[76:79], v2 offset:18432
    v_fma_f32 v114, v114, v93, v92
    v_mul_f32 v31, v23, v31
    v_rcp_f32 v18, v18
    v_mfma_f32_32x32x16_bf16 v[32:47], v[84:87], v[184:187], v[32:47]
    ds_read_b128 v[80:83], v2 offset:19456
    v_mul_f32 v21, v113, v21
    v_fma_f32 v19, v19, v94, v94
    v_mul_f32 v17, v17, v25
    s_waitcnt lgkmcnt(3)
    v_mfma_f32_32x32x16_bf16 v[32:47], v[64:67], v[188:191], v[32:47]
    s_add_u32 s48, s84, 4096
    buffer_load_dwordx4 v[136:139], v1, s[4:7], s48 offen offset:0 sc1
    ds_read_b128 v[84:87], v2 offset:20480
    v_exp_f32 v21, v21
    v_fma_f32 v115, v115, v93, v92
    v_mfma_f32_32x32x16_bf16 v[32:47], v[68:71], v[192:195], v[32:47]
    ds_read_b128 v[64:67], v2 offset:21504
    v_rcp_f32 v19, v19
    v_mul_f32 v22, v114, v22
    v_fma_f32 v20, v20, v94, v94
    v_mul_f32 v18, v18, v26
    s_waitcnt lgkmcnt(3)
    v_mfma_f32_32x32x16_bf16 v[32:47], v[72:75], v[196:199], v[32:47]
    buffer_load_dwordx4 v[140:143], v1, s[4:7], s48 offen offset:2048 sc1
    ds_read_b128 v[68:71], v2 offset:22528
    v_cvt_pk_bf16_f32 v24, v16, v17
    v_exp_f32 v22, v22
    v_mfma_f32_32x32x16_bf16 v[32:47], v[76:79], v[200:203], v[32:47]
    ds_read_b128 v[72:75], v2 offset:23552
    v_rcp_f32 v20, v20
    v_mul_f32 v23, v115, v23
    v_fma_f32 v21, v21, v94, v94
    v_mul_f32 v19, v19, v27
    s_waitcnt lgkmcnt(3)
    v_mfma_f32_32x32x16_bf16 v[32:47], v[80:83], v[204:207], v[32:47]
    s_add_u32 s48, s84, 8192
    buffer_load_dwordx4 v[144:147], v1, s[4:7], s48 offen offset:0 sc1
    ds_read_b128 v[76:79], v2 offset:24576
    v_exp_f32 v23, v23
    v_mfma_f32_32x32x16_bf16 v[32:47], v[84:87], v[208:211], v[32:47]
    ds_read_b128 v[80:83], v2 offset:25600
    v_rcp_f32 v21, v21
    v_fma_f32 v22, v22, v94, v94
    v_mul_f32 v20, v20, v28
    v_cvt_pk_bf16_f32 v25, v18, v19
    s_waitcnt lgkmcnt(3)
    v_mfma_f32_32x32x16_bf16 v[32:47], v[64:67], v[212:215], v[32:47]
    buffer_load_dword v125, v3, s[4:7], s81 offen offset:384 sc1
    buffer_load_dwordx4 v[148:151], v1, s[4:7], s48 offen offset:2048 sc1
    ds_read_b128 v[84:87], v2 offset:26624
    v_rcp_f32 v22, v22
    v_fma_f32 v23, v23, v94, v94
    v_mfma_f32_32x32x16_bf16 v[32:47], v[68:71], v[216:219], v[32:47]
    ds_read_b128 v[64:67], v2 offset:27648
    v_mul_f32 v21, v21, v29
    v_rcp_f32 v23, v23
    v_mul_f32 v22, v22, v30
    s_waitcnt lgkmcnt(3)
    v_mfma_f32_32x32x16_bf16 v[32:47], v[72:75], v[220:223], v[32:47]
    s_add_u32 s48, s84, 12288
    buffer_load_dwordx4 v[152:155], v1, s[4:7], s48 offen offset:0 sc1
    ds_read_b128 v[68:71], v2 offset:28672
    v_cvt_pk_bf16_f32 v26, v20, v21
    s_add_u32 s41, s85, 65536
    v_mul_f32 v23, v23, v31
    v_mfma_f32_32x32x16_bf16 v[32:47], v[76:79], v[224:227], v[32:47]
    ds_read_b128 v[72:75], v2 offset:29696
    v_cvt_pk_bf16_f32 v27, v22, v23
    buffer_store_dwordx4 v[24:27], v1, s[4:7], s41 offen sc1
    s_waitcnt lgkmcnt(3)
    v_mfma_f32_32x32x16_bf16 v[32:47], v[80:83], v[228:231], v[32:47]
    buffer_load_dwordx4 v[156:159], v1, s[4:7], s48 offen offset:2048 sc1
    ds_read_b128 v[76:79], v2 offset:30720
    v_mfma_f32_32x32x16_bf16 v[32:47], v[84:87], v[232:235], v[32:47]
    ds_read_b128 v[80:83], v2 offset:31744
    s_waitcnt lgkmcnt(3)
    v_mfma_f32_32x32x16_bf16 v[32:47], v[64:67], v[236:239], v[32:47]
    s_add_u32 s48, s84, 16384
    buffer_load_dwordx4 v[160:163], v1, s[4:7], s48 offen offset:0 sc1
    ds_read_b32 v84, v120 offset:640
    v_mfma_f32_32x32x16_bf16 v[32:47], v[68:71], v[240:243], v[32:47]
    s_add_u32 s44, s44, 32768
    s_and_b32 s44, s44, 131071
    v_add_u32 v2, s44, v123
    v_xor_b32 v121, 64, v2
    ds_read_b64_tr_b16 v[64:65], v2 offset:0
    ds_read_b64_tr_b16 v[66:67], v2 offset:512
    s_waitcnt lgkmcnt(4)
    v_mfma_f32_32x32x16_bf16 v[32:47], v[72:75], v[244:247], v[32:47]
    buffer_load_dwordx4 v[164:167], v1, s[4:7], s48 offen offset:2048 sc1
    ds_read_b64_tr_b16 v[68:69], v121 offset:0
    ds_read_b64_tr_b16 v[70:71], v121 offset:512
    v_mfma_f32_32x32x16_bf16 v[32:47], v[76:79], v[248:251], v[32:47]
    ds_read_b64_tr_b16 v[72:73], v2 offset:4096
    ds_read_b64_tr_b16 v[74:75], v2 offset:4608
    s_waitcnt lgkmcnt(6)
    v_mfma_f32_32x32x16_bf16 v[32:47], v[80:83], v[252:255], v[32:47]
    s_add_u32 s48, s84, 20480
    buffer_load_dwordx4 v[168:171], v1, s[4:7], s48 offen offset:0 sc1
    ds_read_b64_tr_b16 v[76:77], v121 offset:4096
    ds_read_b64_tr_b16 v[78:79], v121 offset:4608
    v_mfma_f32_32x32x16_bf16 v[32:47], v[84:87], v[88:91], v[32:47]
    s_barrier
    ds_read_b64_tr_b16 v[80:81], v2 offset:8192
    ds_read_b64_tr_b16 v[82:83], v2 offset:8704
    s_waitcnt vmcnt(12) lgkmcnt(6)
    v_mfma_f32_32x32x16_bf16 v[48:63], v[64:67], v[128:131], v[48:63]
    s_waitcnt vmcnt(7)
    v_cmp_ne_u32 vcc, s71, v125
    s_cbranch_vccnz .Lsoftx_133
.Lsoft_132:
    buffer_load_dwordx4 v[172:175], v1, s[4:7], s48 offen offset:2048 sc1
    ds_read_b64_tr_b16 v[84:85], v121 offset:8192
    ds_read_b64_tr_b16 v[86:87], v121 offset:8704
    v_mfma_f32_32x32x16_bf16 v[96:111], v[68:71], v[128:131], 0
    ds_read_b64_tr_b16 v[64:65], v2 offset:12288
    ds_read_b64_tr_b16 v[66:67], v2 offset:12800
    s_waitcnt lgkmcnt(6)
    v_mfma_f32_32x32x16_bf16 v[48:63], v[72:75], v[132:135], v[48:63]
    s_add_u32 s48, s84, 24576
    buffer_load_dwordx4 v[176:179], v1, s[4:7], s48 offen offset:0 sc1
    ds_read_b64_tr_b16 v[68:69], v121 offset:12288
    ds_read_b64_tr_b16 v[70:71], v121 offset:12800
    v_mul_f32 v112, v32, v32
    v_mul_f32 v40, v32, v40
    v_mul_f32 v113, v33, v33
    v_mfma_f32_32x32x16_bf16 v[96:111], v[76:79], v[132:135], v[96:111]
    ds_read_b64_tr_b16 v[72:73], v2 offset:16384
    ds_read_b64_tr_b16 v[74:75], v2 offset:16896
    v_fma_f32 v112, v112, v93, v92
    v_mul_f32 v41, v33, v41
    v_mul_f32 v114, v34, v34
    v_fma_f32 v113, v113, v93, v92
    s_waitcnt lgkmcnt(6)
    v_mfma_f32_32x32x16_bf16 v[48:63], v[80:83], v[136:139], v[48:63]
    buffer_load_dword v125, v3, s[4:7], s81 offen offset:448 sc1
    buffer_load_dwordx4 v[180:183], v1, s[4:7], s48 offen offset:2048 sc1
    ds_read_b64_tr_b16 v[76:77], v121 offset:16384
    ds_read_b64_tr_b16 v[78:79], v121 offset:16896
    v_mul_f32 v42, v34, v42
    v_mul_f32 v32, v112, v32
    v_mfma_f32_32x32x16_bf16 v[96:111], v[84:87], v[136:139], v[96:111]
    ds_read_b64_tr_b16 v[80:81], v2 offset:20480
    ds_read_b64_tr_b16 v[82:83], v2 offset:20992
    v_exp_f32 v32, v32
    v_mul_f32 v115, v35, v35
    v_fma_f32 v114, v114, v93, v92
    v_mul_f32 v43, v35, v43
    s_waitcnt lgkmcnt(6)
    v_mfma_f32_32x32x16_bf16 v[48:63], v[64:67], v[140:143], v[48:63]
    s_add_u32 s48, s84, 28672
    buffer_load_dwordx4 v[184:187], v1, s[4:7], s48 offen offset:0 sc1
    ds_read_b64_tr_b16 v[84:85], v121 offset:20480
    ds_read_b64_tr_b16 v[86:87], v121 offset:20992
    v_mul_f32 v33, v113, v33
    v_exp_f32 v33, v33
    v_mfma_f32_32x32x16_bf16 v[96:111], v[68:71], v[140:143], v[96:111]
    s_waitcnt vmcnt(9)
    buffer_store_dword v12, off, s[4:7], s82 offset:512 sc1
    ds_read_b64_tr_b16 v[64:65], v2 offset:24576
    ds_read_b64_tr_b16 v[66:67], v2 offset:25088
    v_mul_f32 v112, v36, v36
    v_fma_f32 v115, v115, v93, v92
    v_mul_f32 v44, v36, v44
    s_waitcnt lgkmcnt(6)
    v_mfma_f32_32x32x16_bf16 v[48:63], v[72:75], v[144:147], v[48:63]
    buffer_load_dwordx4 v[188:191], v1, s[4:7], s48 offen offset:2048 sc1
    ds_read_b64_tr_b16 v[68:69], v121 offset:24576
    ds_read_b64_tr_b16 v[70:71], v121 offset:25088
    v_mul_f32 v34, v114, v34
    v_fma_f32 v32, v32, v94, v94
    v_exp_f32 v34, v34
    v_mfma_f32_32x32x16_bf16 v[96:111], v[76:79], v[144:147], v[96:111]
    ds_read_b64_tr_b16 v[72:73], v2 offset:28672
    ds_read_b64_tr_b16 v[74:75], v2 offset:29184
    v_mul_f32 v113, v37, v37
    v_fma_f32 v112, v112, v93, v92
    v_mul_f32 v45, v37, v45
    s_waitcnt lgkmcnt(6)
    v_mfma_f32_32x32x16_bf16 v[48:63], v[80:83], v[148:151], v[48:63]
    s_barrier
    s_add_u32 s48, s84, 32768
    buffer_load_dwordx4 v[192:195], v1, s[4:7], s48 offen offset:0 sc1
    ds_read_b64_tr_b16 v[76:77], v121 offset:28672
    ds_read_b64_tr_b16 v[78:79], v121 offset:29184
    v_rcp_f32 v32, v32
    v_mul_f32 v35, v115, v35
    v_mfma_f32_32x32x16_bf16 v[96:111], v[84:87], v[148:151], v[96:111]
    s_add_u32 s44, s44, 32768
    s_and_b32 s44, s44, 131071
    v_add_u32 v2, s44, v123
    v_xor_b32 v121, 64, v2
    ds_read_b64_tr_b16 v[80:81], v2 offset:0
    ds_read_b64_tr_b16 v[82:83], v2 offset:512
    s_waitcnt lgkmcnt(6)
    v_mfma_f32_32x32x16_bf16 v[48:63], v[64:67], v[152:155], v[48:63]
    buffer_load_dwordx4 v[196:199], v1, s[4:7], s48 offen offset:2048 sc1
    ds_read_b64_tr_b16 v[84:85], v121 offset:0
    ds_read_b64_tr_b16 v[86:87], v121 offset:512
    v_fma_f32 v33, v33, v94, v94
    v_exp_f32 v35, v35
    v_mul_f32 v114, v38, v38
    v_mfma_f32_32x32x16_bf16 v[96:111], v[68:71], v[152:155], v[96:111]
    ds_read_b64_tr_b16 v[64:65], v2 offset:4096
    ds_read_b64_tr_b16 v[66:67], v2 offset:4608
    v_fma_f32 v113, v113, v93, v92
    v_mul_f32 v46, v38, v46
    v_rcp_f32 v33, v33
    s_waitcnt vmcnt(12) lgkmcnt(6)
    v_mfma_f32_32x32x16_bf16 v[48:63], v[72:75], v[156:159], v[48:63]
    s_add_u32 s48, s84, 36864
    buffer_load_dwordx4 v[200:203], v1, s[4:7], s48 offen offset:0 sc1
    ds_read_b64_tr_b16 v[68:69], v121 offset:4096
    ds_read_b64_tr_b16 v[70:71], v121 offset:4608
    v_mul_f32 v36, v112, v36
    v_fma_f32 v34, v34, v94, v94
    v_mul_f32 v32, v32, v40
    v_mfma_f32_32x32x16_bf16 v[96:111], v[76:79], v[156:159], v[96:111]
    ds_read_b64_tr_b16 v[72:73], v2 offset:8192
    ds_read_b64_tr_b16 v[74:75], v2 offset:8704
    v_exp_f32 v36, v36
    v_mul_f32 v115, v39, v39
    v_fma_f32 v114, v114, v93, v92
    s_waitcnt vmcnt(12) lgkmcnt(6)
    v_mfma_f32_32x32x16_bf16 v[48:63], v[80:83], v[160:163], v[48:63]
    s_waitcnt vmcnt(7)
    v_cmp_ne_u32 vcc, s71, v125
    s_cbranch_vccnz .Lsoftx_137
.Lsoft_136:
    buffer_load_dwordx4 v[204:207], v1, s[4:7], s48 offen offset:2048 sc1
    ds_read_b64_tr_b16 v[76:77], v121 offset:8192
    ds_read_b64_tr_b16 v[78:79], v121 offset:8704
    v_mul_f32 v47, v39, v47
    v_mfma_f32_32x32x16_bf16 v[96:111], v[84:87], v[160:163], v[96:111]
    ds_read_b64_tr_b16 v[80:81], v2 offset:12288
    ds_read_b64_tr_b16 v[82:83], v2 offset:12800
    v_rcp_f32 v34, v34
    v_mul_f32 v37, v113, v37
    v_fma_f32 v35, v35, v94, v94
    v_mul_f32 v33, v33, v41
    s_waitcnt lgkmcnt(6)
    v_mfma_f32_32x32x16_bf16 v[48:63], v[64:67], v[164:167], v[48:63]
    s_add_u32 s48, s84, 40960
    buffer_load_dwordx4 v[208:211], v1, s[4:7], s48 offen offset:0 sc1
    ds_read_b64_tr_b16 v[84:85], v121 offset:12288
    ds_read_b64_tr_b16 v[86:87], v121 offset:12800
    v_exp_f32 v37, v37
    v_fma_f32 v115, v115, v93, v92
    v_mfma_f32_32x32x16_bf16 v[96:111], v[68:71], v[164:167], v[96:111]
    ds_read_b64_tr_b16 v[64:65], v2 offset:16384
    ds_read_b64_tr_b16 v[66:67], v2 offset:16896
    v_rcp_f32 v35, v35
    v_mul_f32 v38, v114, v38
    v_fma_f32 v36, v36, v94, v94
    s_waitcnt lgkmcnt(6)
    v_mfma_f32_32x32x16_bf16 v[48:63], v[72:75], v[168:171], v[48:63]
    buffer_load_dwordx4 v[212:215], v1, s[4:7], s48 offen offset:2048 sc1
    ds_read_b64_tr_b16 v[68:69], v121 offset:16384
    ds_read_b64_tr_b16 v[70:71], v121 offset:16896
    v_mul_f32 v34, v34, v42
    v_cvt_pk_bf16_f32 v40, v32, v33
    v_exp_f32 v38, v38
    v_mfma_f32_32x32x16_bf16 v[96:111], v[76:79], v[168:171], v[96:111]
    ds_read_b64_tr_b16 v[72:73], v2 offset:20480
    ds_read_b64_tr_b16 v[74:75], v2 offset:20992
    v_rcp_f32 v36, v36
    v_mul_f32 v39, v115, v39
    v_fma_f32 v37, v37, v94, v94
    s_waitcnt lgkmcnt(6)
    v_mfma_f32_32x32x16_bf16 v[48:63], v[80:83], v[172:175], v[48:63]
    s_add_u32 s48, s84, 45056
    buffer_load_dwordx4 v[216:219], v1, s[4:7], s48 offen offset:0 sc1
    ds_read_b64_tr_b16 v[76:77], v121 offset:20480
    ds_read_b64_tr_b16 v[78:79], v121 offset:20992
    v_mul_f32 v35, v35, v43
    v_exp_f32 v39, v39
    v_mfma_f32_32x32x16_bf16 v[96:111], v[84:87], v[172:175], v[96:111]
    ds_read_b64_tr_b16 v[80:81], v2 offset:24576
    ds_read_b64_tr_b16 v[82:83], v2 offset:25088
    v_rcp_f32 v37, v37
    v_fma_f32 v38, v38, v94, v94
    v_mul_f32 v36, v36, v44
    s_waitcnt lgkmcnt(6)
    v_mfma_f32_32x32x16_bf16 v[48:63], v[64:67], v[176:179], v[48:63]
    buffer_load_dwordx4 v[220:223], v1, s[4:7], s48 offen offset:2048 sc1
    ds_read_b64_tr_b16 v[84:85], v121 offset:24576
    ds_read_b64_tr_b16 v[86:87], v121 offset:25088
    v_cvt_pk_bf16_f32 v41, v34, v35
    v_rcp_f32 v38, v38
    v_fma_f32 v39, v39, v94, v94
    v_mfma_f32_32x32x16_bf16 v[96:111], v[68:71], v[176:179], v[96:111]
    ds_read_b64_tr_b16 v[64:65], v2 offset:28672
    ds_read_b64_tr_b16 v[66:67], v2 offset:29184
    v_mul_f32 v37, v37, v45
    v_rcp_f32 v39, v39
    v_mul_f32 v38, v38, v46
    s_waitcnt vmcnt(11) lgkmcnt(6)
    v_mfma_f32_32x32x16_bf16 v[48:63], v[72:75], v[180:183], v[48:63]
    s_barrier
    s_add_u32 s48, s84, 49152
    buffer_load_dwordx4 v[224:227], v1, s[4:7], s48 offen offset:0 sc1
    ds_read_b64_tr_b16 v[68:69], v121 offset:28672
    ds_read_b64_tr_b16 v[70:71], v121 offset:29184
    v_cvt_pk_bf16_f32 v42, v36, v37
    v_mul_f32 v39, v39, v47
    v_mfma_f32_32x32x16_bf16 v[96:111], v[76:79], v[180:183], v[96:111]
    s_add_u32 s44, s44, 32768
    s_and_b32 s44, s44, 131071
    v_add_u32 v2, s44, v123
    v_xor_b32 v121, 64, v2
    ds_read_b64_tr_b16 v[72:73], v2 offset:0
    ds_read_b64_tr_b16 v[74:75], v2 offset:512
    s_waitcnt vmcnt(11) lgkmcnt(6)
    v_mfma_f32_32x32x16_bf16 v[48:63], v[80:83], v[184:187], v[48:63]
    buffer_load_dwordx4 v[228:231], v1, s[4:7], s48 offen offset:2048 sc1
    ds_read_b64_tr_b16 v[76:77], v121 offset:0
    ds_read_b64_tr_b16 v[78:79], v121 offset:512
    v_cvt_pk_bf16_f32 v43, v38, v39
    buffer_store_dwordx4 v[40:43], v1, s[4:7], s49 offen sc1
    v_mfma_f32_32x32x16_bf16 v[96:111], v[84:87], v[184:187], v[96:111]
    ds_read_b64_tr_b16 v[80:81], v2 offset:4096
    ds_read_b64_tr_b16 v[82:83], v2 offset:4608
    s_waitcnt vmcnt(11) lgkmcnt(6)
    v_mfma_f32_32x32x16_bf16 v[48:63], v[64:67], v[188:191], v[48:63]
    buffer_load_dword v125, v3, s[4:7], s81 offen offset:512 sc1
    s_add_u32 s48, s84, 53248
    buffer_load_dwordx4 v[232:235], v1, s[4:7], s48 offen offset:0 sc1
    ds_read_b64_tr_b16 v[84:85], v121 offset:4096
    ds_read_b64_tr_b16 v[86:87], v121 offset:4608
    v_mfma_f32_32x32x16_bf16 v[96:111], v[68:71], v[188:191], v[96:111]
    ds_read_b64_tr_b16 v[64:65], v2 offset:8192
    ds_read_b64_tr_b16 v[66:67], v2 offset:8704
    s_waitcnt vmcnt(12) lgkmcnt(6)
    v_mfma_f32_32x32x16_bf16 v[48:63], v[72:75], v[192:195], v[48:63]
    buffer_load_dwordx4 v[236:239], v1, s[4:7], s48 offen offset:2048 sc1
    ds_read_b64_tr_b16 v[68:69], v121 offset:8192
    ds_read_b64_tr_b16 v[70:71], v121 offset:8704
    v_mfma_f32_32x32x16_bf16 v[96:111], v[76:79], v[192:195], v[96:111]
    ds_read_b64_tr_b16 v[72:73], v2 offset:12288
    ds_read_b64_tr_b16 v[74:75], v2 offset:12800
    s_waitcnt vmcnt(12) lgkmcnt(6)
    v_mfma_f32_32x32x16_bf16 v[48:63], v[80:83], v[196:199], v[48:63]
    s_add_u32 s48, s84, 57344
    buffer_load_dwordx4 v[240:243], v1, s[4:7], s48 offen offset:0 sc1
    ds_read_b64_tr_b16 v[76:77], v121 offset:12288
    ds_read_b64_tr_b16 v[78:79], v121 offset:12800
    v_mfma_f32_32x32x16_bf16 v[96:111], v[84:87], v[196:199], v[96:111]
    ds_read_b64_tr_b16 v[80:81], v2 offset:16384
    ds_read_b64_tr_b16 v[82:83], v2 offset:16896
    s_waitcnt vmcnt(12) lgkmcnt(6)
    v_mfma_f32_32x32x16_bf16 v[48:63], v[64:67], v[200:203], v[48:63]
    buffer_load_dwordx4 v[244:247], v1, s[4:7], s48 offen offset:2048 sc1
    ds_read_b64_tr_b16 v[84:85], v121 offset:16384
    ds_read_b64_tr_b16 v[86:87], v121 offset:16896
    v_mfma_f32_32x32x16_bf16 v[96:111], v[68:71], v[200:203], v[96:111]
    ds_read_b64_tr_b16 v[64:65], v2 offset:20480
    ds_read_b64_tr_b16 v[66:67], v2 offset:20992
    s_waitcnt vmcnt(12) lgkmcnt(6)
    v_mfma_f32_32x32x16_bf16 v[48:63], v[72:75], v[204:207], v[48:63]
    s_add_u32 s48, s84, 61440
    buffer_load_dwordx4 v[248:251], v1, s[4:7], s48 offen offset:0 sc1
    ds_read_b64_tr_b16 v[68:69], v121 offset:20480
    ds_read_b64_tr_b16 v[70:71], v121 offset:20992
    v_mfma_f32_32x32x16_bf16 v[96:111], v[76:79], v[204:207], v[96:111]
    ds_read_b64_tr_b16 v[72:73], v2 offset:24576
    ds_read_b64_tr_b16 v[74:75], v2 offset:25088
    s_waitcnt vmcnt(12) lgkmcnt(6)
    v_mfma_f32_32x32x16_bf16 v[48:63], v[80:83], v[208:211], v[48:63]
    buffer_load_dwordx4 v[252:255], v1, s[4:7], s48 offen offset:2048 sc1
    s_waitcnt vmcnt(7)
    buffer_store_dword v12, off, s[4:7], s83 offset:576 sc1
    ds_read_b64_tr_b16 v[76:77], v121 offset:24576
    ds_read_b64_tr_b16 v[78:79], v121 offset:25088
    v_mfma_f32_32x32x16_bf16 v[96:111], v[84:87], v[208:211], v[96:111]
    ds_read_b64_tr_b16 v[80:81], v2 offset:28672
    ds_read_b64_tr_b16 v[82:83], v2 offset:29184
    s_waitcnt lgkmcnt(6)
    v_mfma_f32_32x32x16_bf16 v[48:63], v[64:67], v[212:215], v[48:63]
    s_barrier
    s_waitcnt vmcnt(7)
    v_cmp_ne_u32 vcc, s71, v125
    s_cbranch_vccnz .Lsoftx_141
.Lsoft_140:
    s_add_u32 s48, s84, 65536
    buffer_load_dwordx4 v[16:19], v1, s[4:7], s48 offen offset:0 sc1
    ds_read_b64_tr_b16 v[84:85], v121 offset:28672
    ds_read_b64_tr_b16 v[86:87], v121 offset:29184
    v_mfma_f32_32x32x16_bf16 v[96:111], v[68:71], v[212:215], v[96:111]
    s_add_u32 s44, s44, 32768
    s_and_b32 s44, s44, 131071
    v_add_u32 v2, s44, v123
    v_xor_b32 v121, 64, v2
    ds_read_b64_tr_b16 v[64:65], v2 offset:0
    ds_read_b64_tr_b16 v[66:67], v2 offset:512
    s_waitcnt lgkmcnt(6)
    v_mfma_f32_32x32x16_bf16 v[48:63], v[72:75], v[216:219], v[48:63]
    buffer_load_dwordx4 v[20:23], v1, s[4:7], s48 offen offset:2048 sc1
    ds_read_b64_tr_b16 v[68:69], v121 offset:0
    ds_read_b64_tr_b16 v[70:71], v121 offset:512
    v_mfma_f32_32x32x16_bf16 v[96:111], v[76:79], v[216:219], v[96:111]
    ds_read_b64_tr_b16 v[72:73], v2 offset:4096
    ds_read_b64_tr_b16 v[74:75], v2 offset:4608
    s_waitcnt lgkmcnt(6)
    v_mfma_f32_32x32x16_bf16 v[48:63], v[80:83], v[220:223], v[48:63]
    s_add_u32 s48, s84, 69632
    buffer_load_dwordx4 v[24:27], v1, s[4:7], s48 offen offset:0 sc1
    ds_read_b64_tr_b16 v[76:77], v121 offset:4096
    ds_read_b64_tr_b16 v[78:79], v121 offset:4608
    v_mfma_f32_32x32x16_bf16 v[96:111], v[84:87], v[220:223], v[96:111]
    ds_read_b64_tr_b16 v[80:81], v2 offset:8192
    ds_read_b64_tr_b16 v[82:83], v2 offset:8704
    s_waitcnt lgkmcnt(6)
    v_mfma_f32_32x32x16_bf16 v[48:63], v[64:67], v[224:227], v[48:63]
    buffer_load_dwordx4 v[28:31], v1, s[4:7], s48 offen offset:2048 sc1
    ds_read_b64_tr_b16 v[84:85], v121 offset:8192
    ds_read_b64_tr_b16 v[86:87], v121 offset:8704
    v_mfma_f32_32x32x16_bf16 v[96:111], v[68:71], v[224:227], v[96:111]
    ds_read_b64_tr_b16 v[64:65], v2 offset:12288
    ds_read_b64_tr_b16 v[66:67], v2 offset:12800
    s_waitcnt lgkmcnt(6)
    v_mfma_f32_32x32x16_bf16 v[48:63], v[72:75], v[228:231], v[48:63]
    s_add_u32 s48, s84, 73728
    buffer_load_dwordx4 v[116:119], v1, s[4:7], s48 offen offset:0 sc1
    ds_read_b64_tr_b16 v[68:69], v121 offset:12288
    ds_read_b64_tr_b16 v[70:71], v121 offset:12800
    v_mfma_f32_32x32x16_bf16 v[96:111], v[76:79], v[228:231], v[96:111]
    ds_read_b64_tr_b16 v[72:73], v2 offset:16384
    ds_read_b64_tr_b16 v[74:75], v2 offset:16896
    s_waitcnt vmcnt(11) lgkmcnt(6)
    v_mfma_f32_32x32x16_bf16 v[48:63], v[80:83], v[232:235], v[48:63]
    buffer_load_dwordx4 v[88:91], v1, s[4:7], s48 offen offset:2048 sc1
    ds_read_b64_tr_b16 v[76:77], v121 offset:16384
    ds_read_b64_tr_b16 v[78:79], v121 offset:16896
    v_mfma_f32_32x32x16_bf16 v[96:111], v[84:87], v[232:235], v[96:111]
    buffer_load_dword v125, v124, s[4:7], s81 offen offset:576 sc1
    ds_read_b64_tr_b16 v[80:81], v2 offset:20480
    ds_read_b64_tr_b16 v[82:83], v2 offset:20992
    s_waitcnt vmcnt(12) lgkmcnt(6)
    v_mfma_f32_32x32x16_bf16 v[48:63], v[64:67], v[236:239], v[48:63]
    s_add_u32 s48, s84, 77824
    buffer_load_dwordx4 v[128:131], v1, s[4:7], s48 offen offset:0 sc1
    ds_read_b64_tr_b16 v[84:85], v121 offset:20480
    ds_read_b64_tr_b16 v[86:87], v121 offset:20992
    v_mfma_f32_32x32x16_bf16 v[96:111], v[68:71], v[236:239], v[96:111]
    ds_read_b64_tr_b16 v[64:65], v2 offset:24576
    ds_read_b64_tr_b16 v[66:67], v2 offset:25088
    s_waitcnt vmcnt(12) lgkmcnt(6)
    v_mfma_f32_32x32x16_bf16 v[48:63], v[72:75], v[240:243], v[48:63]
    buffer_load_dwordx4 v[132:135], v1, s[4:7], s48 offen offset:2048 sc1
    ds_read_b64_tr_b16 v[68:69], v121 offset:24576
    ds_read_b64_tr_b16 v[70:71], v121 offset:25088
    v_mfma_f32_32x32x16_bf16 v[96:111], v[76:79], v[240:243], v[96:111]
    ds_read_b64_tr_b16 v[72:73], v2 offset:28672
    ds_read_b64_tr_b16 v[74:75], v2 offset:29184
    s_waitcnt vmcnt(12) lgkmcnt(6)
    v_mfma_f32_32x32x16_bf16 v[48:63], v[80:83], v[244:247], v[48:63]
    s_barrier
    ds_read_b64_tr_b16 v[76:77], v121 offset:28672
    ds_read_b64_tr_b16 v[78:79], v121 offset:29184
    v_mfma_f32_32x32x16_bf16 v[96:111], v[84:87], v[244:247], v[96:111]
    s_add_u32 s44, s44, 32768
    s_and_b32 s44, s44, 131071
    v_add_u32 v2, s44, v123
    v_xor_b32 v121, 64, v2
    ds_read_b64_tr_b16 v[80:81], v2 offset:0
    ds_read_b64_tr_b16 v[82:83], v2 offset:512
    s_waitcnt vmcnt(11) lgkmcnt(6)
    v_mfma_f32_32x32x16_bf16 v[48:63], v[64:67], v[248:251], v[48:63]
    ds_read_b64_tr_b16 v[84:85], v121 offset:0
    ds_read_b64_tr_b16 v[86:87], v121 offset:512
    v_mfma_f32_32x32x16_bf16 v[96:111], v[68:71], v[248:251], v[96:111]
    ds_read_b64_tr_b16 v[64:65], v2 offset:4096
    ds_read_b64_tr_b16 v[66:67], v2 offset:4608
    s_waitcnt vmcnt(10) lgkmcnt(6)
    v_mfma_f32_32x32x16_bf16 v[48:63], v[72:75], v[252:255], v[48:63]
    ds_read_b64_tr_b16 v[68:69], v121 offset:4096
    ds_read_b64_tr_b16 v[70:71], v121 offset:4608
    v_mfma_f32_32x32x16_bf16 v[96:111], v[76:79], v[252:255], v[96:111]
    ds_read_b64_tr_b16 v[72:73], v2 offset:8192
    ds_read_b64_tr_b16 v[74:75], v2 offset:8704
    s_waitcnt vmcnt(8) lgkmcnt(6)
    v_mfma_f32_32x32x16_bf16 v[48:63], v[80:83], v[16:19], v[48:63]
    ds_read_b64_tr_b16 v[76:77], v121 offset:8192
    ds_read_b64_tr_b16 v[78:79], v121 offset:8704
    v_mfma_f32_32x32x16_bf16 v[96:111], v[84:87], v[16:19], v[96:111]
    s_waitcnt vmcnt(2)
    v_cmp_ne_u32 vcc, s71, v125
    s_cbranch_vccnz .Lsoftx_145
.Lsoft_144:
    s_add_u32 s71, s71, 1
    v_add_u32 v12, 1, v12
    s_add_u32 s48, s84, 81920
    buffer_load_dwordx4 v[32:35], v1, s[4:7], s48 offen offset:0 sc1
    buffer_load_dwordx4 v[36:39], v1, s[4:7], s48 offen offset:2048 sc1
    s_add_u32 s48, s84, 86016
    buffer_load_dwordx4 v[40:43], v1, s[4:7], s48 offen offset:0 sc1
    ds_read_b64_tr_b16 v[80:81], v2 offset:12288
    ds_read_b64_tr_b16 v[82:83], v2 offset:12800
    s_waitcnt lgkmcnt(6)
    v_mfma_f32_32x32x16_bf16 v[48:63], v[64:67], v[20:23], v[48:63]
    ds_read_b64_tr_b16 v[84:85], v121 offset:12288
    ds_read_b64_tr_b16 v[86:87], v121 offset:12800
    v_mfma_f32_32x32x16_bf16 v[96:111], v[68:71], v[20:23], v[96:111]
    ds_read_b64_tr_b16 v[64:65], v2 offset:16384
    ds_read_b64_tr_b16 v[66:67], v2 offset:16896
    s_waitcnt lgkmcnt(6)
    v_mfma_f32_32x32x16_bf16 v[48:63], v[72:75], v[24:27], v[48:63]
    ds_read_b64_tr_b16 v[68:69], v121 offset:16384
    ds_read_b64_tr_b16 v[70:71], v121 offset:16896
    v_mfma_f32_32x32x16_bf16 v[96:111], v[76:79], v[24:27], v[96:111]
    ds_read_b64_tr_b16 v[72:73], v2 offset:20480
    ds_read_b64_tr_b16 v[74:75], v2 offset:20992
    s_waitcnt lgkmcnt(6)
    v_mfma_f32_32x32x16_bf16 v[48:63], v[80:83], v[28:31], v[48:63]
    ds_read_b64_tr_b16 v[76:77], v121 offset:20480
    ds_read_b64_tr_b16 v[78:79], v121 offset:20992
    v_mfma_f32_32x32x16_bf16 v[96:111], v[84:87], v[28:31], v[96:111]
    ds_read_b64_tr_b16 v[80:81], v2 offset:24576
    ds_read_b64_tr_b16 v[82:83], v2 offset:25088
    s_waitcnt lgkmcnt(6)
    v_mfma_f32_32x32x16_bf16 v[48:63], v[64:67], v[116:119], v[48:63]
    ds_read_b64_tr_b16 v[84:85], v121 offset:24576
    ds_read_b64_tr_b16 v[86:87], v121 offset:25088
    v_mfma_f32_32x32x16_bf16 v[96:111], v[68:71], v[116:119], v[96:111]
    ds_read_b64_tr_b16 v[64:65], v2 offset:28672
    ds_read_b64_tr_b16 v[66:67], v2 offset:29184
    s_waitcnt lgkmcnt(6)
    v_mfma_f32_32x32x16_bf16 v[48:63], v[72:75], v[88:91], v[48:63]
    s_barrier
    ds_read_b64_tr_b16 v[68:69], v121 offset:28672
    ds_read_b64_tr_b16 v[70:71], v121 offset:29184
    v_mfma_f32_32x32x16_bf16 v[96:111], v[76:79], v[88:91], v[96:111]
    s_add_u32 s44, s44, 32768
    s_and_b32 s44, s44, 131071
    v_add_u32 v2, s44, v123
    v_xor_b32 v121, 64, v2
    ds_read_b64_tr_b16 v[72:73], v121 offset:0
    ds_read_b64_tr_b16 v[74:75], v121 offset:512
    s_waitcnt vmcnt(4) lgkmcnt(6)
    v_mfma_f32_32x32x16_bf16 v[48:63], v[80:83], v[128:131], v[48:63]
    ds_read_b64_tr_b16 v[76:77], v121 offset:4096
    ds_read_b64_tr_b16 v[78:79], v121 offset:4608
    v_mfma_f32_32x32x16_bf16 v[96:111], v[84:87], v[128:131], v[96:111]
    ds_read_b64_tr_b16 v[80:81], v121 offset:8192
    ds_read_b64_tr_b16 v[82:83], v121 offset:8704
    s_waitcnt vmcnt(3) lgkmcnt(6)
    v_mfma_f32_32x32x16_bf16 v[48:63], v[64:67], v[132:135], v[48:63]
    ds_read_b64_tr_b16 v[84:85], v2 offset:0
    ds_read_b64_tr_b16 v[86:87], v2 offset:512
    v_mfma_f32_32x32x16_bf16 v[96:111], v[68:71], v[132:135], v[96:111]
    ds_read_b64_tr_b16 v[64:65], v2 offset:4096
    ds_read_b64_tr_b16 v[66:67], v2 offset:4608
    s_waitcnt vmcnt(2) lgkmcnt(6)
    v_mfma_f32_32x32x16_bf16 v[96:111], v[72:75], v[32:35], v[96:111]
    ds_read_b64_tr_b16 v[68:69], v2 offset:8192
    ds_read_b64_tr_b16 v[70:71], v2 offset:8704
    s_waitcnt vmcnt(1)
    v_mfma_f32_32x32x16_bf16 v[96:111], v[76:79], v[36:39], v[96:111]
    s_waitcnt vmcnt(0) lgkmcnt(4)
    v_mfma_f32_32x32x16_bf16 v[96:111], v[80:83], v[40:43], v[96:111]
    v_mfma_f32_32x32x16_bf16 v[48:63], v[84:87], v[32:35], v[48:63]
    s_nop 10
    ds_write_b128 v126, v[96:99] offset:0
    ds_write_b128 v126, v[100:103] offset:1024
    ds_write_b128 v126, v[104:107] offset:2048
    ds_write_b128 v126, v[108:111] offset:3072
    s_waitcnt lgkmcnt(4)
    v_mfma_f32_32x32x16_bf16 v[48:63], v[64:67], v[36:39], v[48:63]
    v_mfma_f32_32x32x16_bf16 v[48:63], v[68:71], v[40:43], v[48:63]
    v_xor_b32 v126, 4096, v126
    s_waitcnt lgkmcnt(0)
    s_barrier
    ds_read_b128 v[16:19], v126 offset:0
    ds_read_b128 v[20:23], v126 offset:1024
    ds_read_b128 v[24:27], v126 offset:2048
    ds_read_b128 v[28:31], v126 offset:3072
    v_and_b32 v126, 31, v0
    v_lshlrev_b32 v126, 4, v126
    v_lshrrev_b32 v13, 5, v0
    v_lshl_add_u32 v126, v13, 2, v126
    s_waitcnt lgkmcnt(3)
    v_pk_add_f32 v[48:49], v[48:49], v[16:17] op_sel:[0,0] op_sel_hi:[1,1]
    v_pk_add_f32 v[50:51], v[50:51], v[18:19] op_sel:[0,0] op_sel_hi:[1,1]
    v_cvt_pk_bf16_f32 v4, v48, v49
    v_cvt_pk_bf16_f32 v5, v50, v51
    s_waitcnt lgkmcnt(2)
    v_pk_add_f32 v[52:53], v[52:53], v[20:21] op_sel:[0,0] op_sel_hi:[1,1]
    v_pk_add_f32 v[54:55], v[54:55], v[22:23] op_sel:[0,0] op_sel_hi:[1,1]
    v_cvt_pk_bf16_f32 v6, v52, v53
    v_cvt_pk_bf16_f32 v7, v54, v55
    s_waitcnt lgkmcnt(1)
    v_pk_add_f32 v[56:57], v[56:57], v[24:25] op_sel:[0,0] op_sel_hi:[1,1]
    v_pk_add_f32 v[58:59], v[58:59], v[26:27] op_sel:[0,0] op_sel_hi:[1,1]
    v_cvt_pk_bf16_f32 v8, v56, v57
    v_cvt_pk_bf16_f32 v9, v58, v59
    s_waitcnt lgkmcnt(0)
    v_pk_add_f32 v[60:61], v[60:61], v[28:29] op_sel:[0,0] op_sel_hi:[1,1]
    v_pk_add_f32 v[62:63], v[62:63], v[30:31] op_sel:[0,0] op_sel_hi:[1,1]
    v_cvt_pk_bf16_f32 v10, v60, v61
    v_cvt_pk_bf16_f32 v11, v62, v63
    s_cmp_eq_u32 s73, 1
    s_cbranch_scc1 .Lfin_148
    buffer_store_dwordx4 v[4:7], v1, s[4:7], s77 offen offset:0 sc1
    buffer_store_dwordx4 v[8:11], v1, s[4:7], s77 offen offset:1024 sc1
    v_dot2_f32_bf16 v48, v4, s97, 0
    v_dot2_f32_bf16 v49, v4, v4, 0
    v_dot2_f32_bf16 v50, v5, s97, 0
    v_dot2_f32_bf16 v51, v5, v5, 0
    v_dot2_f32_bf16 v48, v6, s97, v48
    v_dot2_f32_bf16 v49, v6, v6, v49
    v_dot2_f32_bf16 v50, v7, s97, v50
    v_dot2_f32_bf16 v51, v7, v7, v51
    v_dot2_f32_bf16 v48, v8, s97, v48
    v_dot2_f32_bf16 v49, v8, v8, v49
    v_dot2_f32_bf16 v50, v9, s97, v50
    v_dot2_f32_bf16 v51, v9, v9, v51
    v_dot2_f32_bf16 v48, v10, s97, v48
    v_dot2_f32_bf16 v49, v10, v10, v49
    v_dot2_f32_bf16 v50, v11, s97, v50
    v_dot2_f32_bf16 v51, v11, v11, v51
    s_nop 2
    v_pk_add_f32 v[48:49], v[48:49], v[50:51] op_sel:[0,0] op_sel_hi:[1,1]
    s_nop 1
    v_permlane32_swap_b32 v48, v49
    v_add_f32 v48, v48, v49
    buffer_store_dword v48, v126, s[4:7], s78 offen sc1
    s_add_u32 s44, s44, 32768
    s_and_b32 s44, s44, 131071
    v_add_u32 v2, s44, v122
    v_xor_b32 v121, 64, v2
    v_lshrrev_b32 v15, 5, v0
    v_lshlrev_b32 v15, 11, v15
    v_and_b32 v14, 31, v0
    v_lshl_add_u32 v15, v14, 4, v15
    s_waitcnt vmcnt(0)
    buffer_store_dword v12, off, s[4:7], s79 sc1
    s_mov_b32 s73, 1
    s_branch .Lpair_s
.Lfin_148:
    v_and_b32 v126, 31, v0
    v_lshlrev_b32 v126, 10, v126
    v_lshrrev_b32 v13, 5, v0
    v_lshl_add_u32 v126, v13, 4, v126
    buffer_store_dwordx4 v[4:7], v126, s[12:15], s98 offen
    buffer_store_dwordx4 v[8:11], v126, s[12:15], s98 offen offset:32
    s_or_b32 s92, s2, s3
    s_cmp_lg_u32 s92, 0
    s_cbranch_scc1 .Lend
    v_add_u32 v12, 22, v12
    buffer_store_dword v12, off, s[4:7], 0 offset:0 sc1
    s_branch .Lend
.Lkvx_10:
    s_sub_u32 s72, s72, 1
    s_cselect_b32 s72, 0, s72
    s_cbranch_scc1 .Lkvd_11
    s_mov_b32 s93, 0
    v_cmp_ne_u32 vcc, s95, v131
    s_cbranch_vccnz .Lkvm_13
.Lkvk_12:
    v_cmp_ne_u32 vcc, s95, v135
    s_cbranch_vccnz .Lkvm_15
.Lkvk_14:
    v_cmp_ne_u32 vcc, s95, v139
    s_cbranch_vccnz .Lkvm_17
.Lkvk_16:
    v_cmp_ne_u32 vcc, s95, v143
    s_cbranch_vccnz .Lkvm_19
.Lkvk_18:
    v_cmp_ne_u32 vcc, s95, v147
    s_cbranch_vccnz .Lkvm_21
.Lkvk_20:
    v_cmp_ne_u32 vcc, s95, v151
    s_cbranch_vccnz .Lkvm_23
.Lkvk_22:
    v_cmp_ne_u32 vcc, s95, v155
    s_cbranch_vccnz .Lkvm_25
.Lkvk_24:
    v_cmp_ne_u32 vcc, s95, v159
    s_cbranch_vccnz .Lkvm_27
.Lkvk_26:
    v_cmp_ne_u32 vcc, s95, v163
    s_cbranch_vccnz .Lkvm_29
.Lkvk_28:
    v_cmp_ne_u32 vcc, s95, v167
    s_cbranch_vccnz .Lkvm_31
.Lkvk_30:
    v_cmp_ne_u32 vcc, s95, v171
    s_cbranch_vccnz .Lkvm_33
.Lkvk_32:
    v_cmp_ne_u32 vcc, s95, v175
    s_cbranch_vccnz .Lkvm_35
.Lkvk_34:
    v_cmp_ne_u32 vcc, s95, v179
    s_cbranch_vccnz .Lkvm_37
.Lkvk_36:
    v_cmp_ne_u32 vcc, s95, v183
    s_cbranch_vccnz .Lkvm_39
.Lkvk_38:
    v_cmp_ne_u32 vcc, s95, v187
    s_cbranch_vccnz .Lkvm_41
.Lkvk_40:
    v_cmp_ne_u32 vcc, s95, v191
    s_cbranch_vccnz .Lkvm_43
.Lkvk_42:
    s_waitcnt vmcnt(0)
    s_branch .Lkvv_9
.Lkvm_13:
    buffer_load_dwordx4 v[128:131], v118, s[4:7], s89 offen offset:0 sc1
    s_mov_b32 s93, 1
    s_branch .Lkvk_12
.Lkvm_15:
    buffer_load_dwordx4 v[132:135], v118, s[4:7], s89 offen offset:768 sc1
    s_mov_b32 s93, 1
    s_branch .Lkvk_14
.Lkvm_17:
    buffer_load_dwordx4 v[136:139], v118, s[4:7], s89 offen offset:1536 sc1
    s_mov_b32 s93, 1
    s_branch .Lkvk_16
.Lkvm_19:
    buffer_load_dwordx4 v[140:143], v118, s[4:7], s89 offen offset:2304 sc1
    s_mov_b32 s93, 1
    s_branch .Lkvk_18
.Lkvm_21:
    s_add_u32 s92, s89, 3072
    buffer_load_dwordx4 v[144:147], v118, s[4:7], s92 offen offset:0 sc1
    s_mov_b32 s93, 1
    s_branch .Lkvk_20
.Lkvm_23:
    s_add_u32 s92, s89, 3072
    buffer_load_dwordx4 v[148:151], v118, s[4:7], s92 offen offset:768 sc1
    s_mov_b32 s93, 1
    s_branch .Lkvk_22
.Lkvm_25:
    s_add_u32 s92, s89, 3072
    buffer_load_dwordx4 v[152:155], v118, s[4:7], s92 offen offset:1536 sc1
    s_mov_b32 s93, 1
    s_branch .Lkvk_24
.Lkvm_27:
    s_add_u32 s92, s89, 3072
    buffer_load_dwordx4 v[156:159], v118, s[4:7], s92 offen offset:2304 sc1
    s_mov_b32 s93, 1
    s_branch .Lkvk_26
.Lkvm_29:
    s_add_u32 s92, s89, 6144
    buffer_load_dwordx4 v[160:163], v118, s[4:7], s92 offen offset:0 sc1
    s_mov_b32 s93, 1
    s_branch .Lkvk_28
.Lkvm_31:
    s_add_u32 s92, s89, 6144
    buffer_load_dwordx4 v[164:167], v118, s[4:7], s92 offen offset:768 sc1
    s_mov_b32 s93, 1
    s_branch .Lkvk_30
.Lkvm_33:
    s_add_u32 s92, s89, 6144
    buffer_load_dwordx4 v[168:171], v118, s[4:7], s92 offen offset:1536 sc1
    s_mov_b32 s93, 1
    s_branch .Lkvk_32
.Lkvm_35:
    s_add_u32 s92, s89, 6144
    buffer_load_dwordx4 v[172:175], v118, s[4:7], s92 offen offset:2304 sc1
    s_mov_b32 s93, 1
    s_branch .Lkvk_34
.Lkvm_37:
    s_add_u32 s92, s89, 9216
    buffer_load_dwordx4 v[176:179], v118, s[4:7], s92 offen offset:0 sc1
    s_mov_b32 s93, 1
    s_branch .Lkvk_36
.Lkvm_39:
    s_add_u32 s92, s89, 9216
    buffer_load_dwordx4 v[180:183], v118, s[4:7], s92 offen offset:768 sc1
    s_mov_b32 s93, 1
    s_branch .Lkvk_38
.Lkvm_41:
    s_add_u32 s92, s89, 9216
    buffer_load_dwordx4 v[184:187], v118, s[4:7], s92 offen offset:1536 sc1
    s_mov_b32 s93, 1
    s_branch .Lkvk_40
.Lkvm_43:
    s_add_u32 s92, s89, 9216
    buffer_load_dwordx4 v[188:191], v118, s[4:7], s92 offen offset:2304 sc1
    s_mov_b32 s93, 1
    s_branch .Lkvk_42
.Lsoftx_53:
.Lpoll_54:
    buffer_load_dword v13, v15, s[4:7], s81 offen offset:256 sc1
    s_waitcnt vmcnt(0)
    v_cmp_ne_u32 vcc, s71, v13
    s_cbranch_vccz .Lpdone_55
    s_sub_u32 s72, s72, 1
    s_cbranch_scc0 .Lpoll_54
    s_mov_b32 s72, 0
.Lpdone_55:
    s_branch .Lsoft_52
.Lsoftx_57:
.Lpoll_58:
    buffer_load_dword v13, v3, s[4:7], s81 offen offset:384 sc1
    s_waitcnt vmcnt(0)
    v_cmp_ne_u32 vcc, s71, v13
    s_cbranch_vccz .Lpdone_59
    s_sub_u32 s72, s72, 1
    s_cbranch_scc0 .Lpoll_58
    s_mov_b32 s72, 0
.Lpdone_59:
    s_branch .Lsoft_56
.Lsoftx_61:
.Lpoll_62:
    buffer_load_dword v13, v3, s[4:7], s81 offen offset:448 sc1
    s_waitcnt vmcnt(0)
    v_cmp_ne_u32 vcc, s71, v13
    s_cbranch_vccz .Lpdone_63
    s_sub_u32 s72, s72, 1
    s_cbranch_scc0 .Lpoll_62
    s_mov_b32 s72, 0
.Lpdone_63:
    s_branch .Lsoft_60
.Lsoftx_65:
.Lpoll_66:
    buffer_load_dword v13, v3, s[4:7], s81 offen offset:512 sc1
    s_waitcnt vmcnt(0)
    v_cmp_ne_u32 vcc, s71, v13
    s_cbranch_vccz .Lpdone_67
    s_sub_u32 s72, s72, 1
    s_cbranch_scc0 .Lpoll_66
    s_mov_b32 s72, 0
.Lpdone_67:
    s_branch .Lsoft_64
.Lsoftx_69:
.Lpoll_70:
    buffer_load_dword v13, v124, s[4:7], s81 offen offset:576 sc1
    s_waitcnt vmcnt(0)
    v_cmp_ne_u32 vcc, s71, v13
    s_cbranch_vccz .Lpdone_71
    s_sub_u32 s72, s72, 1
    s_cbranch_scc0 .Lpoll_70
    s_mov_b32 s72, 0
.Lpdone_71:
    s_branch .Lsoft_68
.Lkvx_89:
    s_sub_u32 s72, s72, 1
    s_cselect_b32 s72, 0, s72
    s_cbranch_scc1 .Lkvd_90
    s_mov_b32 s93, 0
    v_cmp_ne_u32 vcc, s95, v131
    s_cbranch_vccnz .Lkvm_92
.Lkvk_91:
    v_cmp_ne_u32 vcc, s95, v135
    s_cbranch_vccnz .Lkvm_94
.Lkvk_93:
    v_cmp_ne_u32 vcc, s95, v139
    s_cbranch_vccnz .Lkvm_96
.Lkvk_95:
    v_cmp_ne_u32 vcc, s95, v143
    s_cbranch_vccnz .Lkvm_98
.Lkvk_97:
    v_cmp_ne_u32 vcc, s95, v147
    s_cbranch_vccnz .Lkvm_100
.Lkvk_99:
    v_cmp_ne_u32 vcc, s95, v151
    s_cbranch_vccnz .Lkvm_102
.Lkvk_101:
    v_cmp_ne_u32 vcc, s95, v155
    s_cbranch_vccnz .Lkvm_104
.Lkvk_103:
    v_cmp_ne_u32 vcc, s95, v159
    s_cbranch_vccnz .Lkvm_106
.Lkvk_105:
    v_cmp_ne_u32 vcc, s95, v163
    s_cbranch_vccnz .Lkvm_108
.Lkvk_107:
    v_cmp_ne_u32 vcc, s95, v167
    s_cbranch_vccnz .Lkvm_110
.Lkvk_109:
    v_cmp_ne_u32 vcc, s95, v171
    s_cbranch_vccnz .Lkvm_112
.Lkvk_111:
    v_cmp_ne_u32 vcc, s95, v175
    s_cbranch_vccnz .Lkvm_114
.Lkvk_113:
    v_cmp_ne_u32 vcc, s95, v179
    s_cbranch_vccnz .Lkvm_116
.Lkvk_115:
    v_cmp_ne_u32 vcc, s95, v183
    s_cbranch_vccnz .Lkvm_118
.Lkvk_117:
    v_cmp_ne_u32 vcc, s95, v187
    s_cbranch_vccnz .Lkvm_120
.Lkvk_119:
    v_cmp_ne_u32 vcc, s95, v191
    s_cbranch_vccnz .Lkvm_122
.Lkvk_121:
    s_waitcnt vmcnt(0)
    s_branch .Lkvv_88
.Lkvm_92:
    buffer_load_dwordx4 v[128:131], v118, s[4:7], s89 offen offset:0 sc1
    s_mov_b32 s93, 1
    s_branch .Lkvk_91
.Lkvm_94:
    buffer_load_dwordx4 v[132:135], v118, s[4:7], s89 offen offset:768 sc1
    s_mov_b32 s93, 1
    s_branch .Lkvk_93
.Lkvm_96:
    buffer_load_dwordx4 v[136:139], v118, s[4:7], s89 offen offset:1536 sc1
    s_mov_b32 s93, 1
    s_branch .Lkvk_95
.Lkvm_98:
    buffer_load_dwordx4 v[140:143], v118, s[4:7], s89 offen offset:2304 sc1
    s_mov_b32 s93, 1
    s_branch .Lkvk_97
.Lkvm_100:
    s_add_u32 s92, s89, 3072
    buffer_load_dwordx4 v[144:147], v118, s[4:7], s92 offen offset:0 sc1
    s_mov_b32 s93, 1
    s_branch .Lkvk_99
.Lkvm_102:
    s_add_u32 s92, s89, 3072
    buffer_load_dwordx4 v[148:151], v118, s[4:7], s92 offen offset:768 sc1
    s_mov_b32 s93, 1
    s_branch .Lkvk_101
.Lkvm_104:
    s_add_u32 s92, s89, 3072
    buffer_load_dwordx4 v[152:155], v118, s[4:7], s92 offen offset:1536 sc1
    s_mov_b32 s93, 1
    s_branch .Lkvk_103
.Lkvm_106:
    s_add_u32 s92, s89, 3072
    buffer_load_dwordx4 v[156:159], v118, s[4:7], s92 offen offset:2304 sc1
    s_mov_b32 s93, 1
    s_branch .Lkvk_105
.Lkvm_108:
    s_add_u32 s92, s89, 6144
    buffer_load_dwordx4 v[160:163], v118, s[4:7], s92 offen offset:0 sc1
    s_mov_b32 s93, 1
    s_branch .Lkvk_107
.Lkvm_110:
    s_add_u32 s92, s89, 6144
    buffer_load_dwordx4 v[164:167], v118, s[4:7], s92 offen offset:768 sc1
    s_mov_b32 s93, 1
    s_branch .Lkvk_109
.Lkvm_112:
    s_add_u32 s92, s89, 6144
    buffer_load_dwordx4 v[168:171], v118, s[4:7], s92 offen offset:1536 sc1
    s_mov_b32 s93, 1
    s_branch .Lkvk_111
.Lkvm_114:
    s_add_u32 s92, s89, 6144
    buffer_load_dwordx4 v[172:175], v118, s[4:7], s92 offen offset:2304 sc1
    s_mov_b32 s93, 1
    s_branch .Lkvk_113
.Lkvm_116:
    s_add_u32 s92, s89, 9216
    buffer_load_dwordx4 v[176:179], v118, s[4:7], s92 offen offset:0 sc1
    s_mov_b32 s93, 1
    s_branch .Lkvk_115
.Lkvm_118:
    s_add_u32 s92, s89, 9216
    buffer_load_dwordx4 v[180:183], v118, s[4:7], s92 offen offset:768 sc1
    s_mov_b32 s93, 1
    s_branch .Lkvk_117
.Lkvm_120:
    s_add_u32 s92, s89, 9216
    buffer_load_dwordx4 v[184:187], v118, s[4:7], s92 offen offset:1536 sc1
    s_mov_b32 s93, 1
    s_branch .Lkvk_119
.Lkvm_122:
    s_add_u32 s92, s89, 9216
    buffer_load_dwordx4 v[188:191], v118, s[4:7], s92 offen offset:2304 sc1
    s_mov_b32 s93, 1
    s_branch .Lkvk_121
.Lsoftx_129:
.Lpoll_130:
    buffer_load_dword v13, v15, s[4:7], s81 offen offset:256 sc1
    s_waitcnt vmcnt(0)
    v_cmp_ne_u32 vcc, s71, v13
    s_cbranch_vccz .Lpdone_131
    s_sub_u32 s72, s72, 1
    s_cbranch_scc0 .Lpoll_130
    s_mov_b32 s72, 0
.Lpdone_131:
    s_branch .Lsoft_128
.Lsoftx_133:
.Lpoll_134:
    buffer_load_dword v13, v3, s[4:7], s81 offen offset:384 sc1
    s_waitcnt vmcnt(0)
    v_cmp_ne_u32 vcc, s71, v13
    s_cbranch_vccz .Lpdone_135
    s_sub_u32 s72, s72, 1
    s_cbranch_scc0 .Lpoll_134
    s_mov_b32 s72, 0
.Lpdone_135:
    s_branch .Lsoft_132
.Lsoftx_137:
.Lpoll_138:
    buffer_load_dword v13, v3, s[4:7], s81 offen offset:448 sc1
    s_waitcnt vmcnt(0)
    v_cmp_ne_u32 vcc, s71, v13
    s_cbranch_vccz .Lpdone_139
    s_sub_u32 s72, s72, 1
    s_cbranch_scc0 .Lpoll_138
    s_mov_b32 s72, 0
.Lpdone_139:
    s_branch .Lsoft_136
.Lsoftx_141:
.Lpoll_142:
    buffer_load_dword v13, v3, s[4:7], s81 offen offset:512 sc1
    s_waitcnt vmcnt(0)
    v_cmp_ne_u32 vcc, s71, v13
    s_cbranch_vccz .Lpdone_143
    s_sub_u32 s72, s72, 1
    s_cbranch_scc0 .Lpoll_142
    s_mov_b32 s72, 0
.Lpdone_143:
    s_branch .Lsoft_140
.Lsoftx_145:
.Lpoll_146:
    buffer_load_dword v13, v124, s[4:7], s81 offen offset:576 sc1
    s_waitcnt vmcnt(0)
    v_cmp_ne_u32 vcc, s71, v13
    s_cbranch_vccz .Lpdone_147
    s_sub_u32 s72, s72, 1
    s_cbranch_scc0 .Lpoll_146
    s_mov_b32 s72, 0
.Lpdone_147:
    s_branch .Lsoft_144
.Lend:
    s_endpgm
.section .rodata,"a"
.p2align 6
.amdhsa_kernel interleave_layers__linear_kernel_hedgehog__geglu_ffn__prompt_kernel
  .amdhsa_next_free_vgpr 256
  .amdhsa_next_free_sgpr 102
  .amdhsa_accum_offset 256
  .amdhsa_group_segment_fixed_size 0
  .amdhsa_kernarg_size 88
  .amdhsa_user_sgpr_count 2
  .amdhsa_user_sgpr_kernarg_segment_ptr 1
  .amdhsa_system_sgpr_workgroup_id_x 1
.end_amdhsa_kernel
```
